```python
import torch

def _softmax(x, axis=-1):
    return torch.softmax(x, dim=axis)
def _gelu(x):
    return torch.nn.functional.gelu(x, approximate="tanh")
def _silu(x):
    return torch.nn.functional.silu(x)
def _sigmoid(x):
    return torch.sigmoid(x)
def _layernorm(x, axis=-1, eps=1e-5):
    m = x.mean(dim=axis, keepdim=True)
    v = x.var(dim=axis, keepdim=True, unbiased=False)
    return (x - m) / torch.sqrt(v + eps)
def _scatter_add(tgt, idx, src, axis=0):
    return tgt.clone().index_add_(axis, idx, src)
def _segment_sum(src, seg, n):
    out = torch.zeros((n,) + src.shape[1:], dtype=src.dtype)
    return out.index_add_(0, seg, src)
def _pad(x, pw):
    flat = tuple(v for pair in reversed(pw) for v in pair)
    return torch.nn.functional.pad(x, flat)

kernel_name = 'standalone__gqa_block_cached__near_ridge'

def setup_inputs():

    _w = (lambda a: (lambda t: t.to(torch.bfloat16) if t.is_floating_point() else t)(torch.as_tensor(a)))
    B, Sq, D = 8, 192, 640
    Hq, Hkv, Sk, Dh = 32, 32, 1024, 192
    assert Hq % Hkv == 0, (Hq, Hkv)
    return {
        "x": _w((lambda *s: torch.randn(*s, dtype=torch.bfloat16) * 0.8)(B, Sq, D)),
        "k_cache": _w((lambda *s: torch.randn(*s, dtype=torch.bfloat16) * 0.8)(B, Hkv, Sk, Dh)),
        "v_cache": _w((lambda *s: torch.randn(*s, dtype=torch.bfloat16) * 0.05)(B, Hkv, Sk, Dh)),
        "wq": _w((lambda *s: torch.randn(*s, dtype=torch.bfloat16) * 0.8)(D, Hq * Dh) * (D ** -0.5)),
        "wo": _w((lambda *s: torch.randn(*s, dtype=torch.bfloat16) * 0.05)(Hq * Dh, D) * ((Hq * Dh) ** -0.5)),
    }

def reference(x, k_cache, v_cache, wq, wo):
    B, Sq, D = x.shape
    Hq, Dh = 32, 192
    Hkv = k_cache.shape[1]
    rep = Hq // Hkv
    q = (lambda x, *d: x.permute(*d))((x @ wq).reshape(B, Sq, Hq, Dh), 0, 2, 1, 3)
    k = (lambda x, n, axis: torch.repeat_interleave(x, n, dim=axis))(k_cache, rep, axis=1)
    v = (lambda x, n, axis: torch.repeat_interleave(x, n, dim=axis))(v_cache, rep, axis=1)
    scores = torch.einsum("bhqd,bhkd->bhqk", q, k) * (Dh ** -0.5)
    p = _softmax(scores, axis=-1)
    o = torch.einsum("bhqk,bhkd->bhqd", p, v)
    return (lambda x, *d: x.permute(*d))(o, 0, 2, 1, 3).reshape(B, Sq, Hq * Dh) @ wo
```

```asm
; @launch grid=(256,1,1) block=(256,1,1) lds=163840
.amdgcn_target "amdgcn-amd-amdhsa--gfx950"
.text
.globl standalone__gqa_block_cached__near_ridge_kernel
.p2align 8
.type standalone__gqa_block_cached__near_ridge_kernel,@function
standalone__gqa_block_cached__near_ridge_kernel:
    s_cmp_ge_u32 s2, 256
    s_cbranch_scc1 L_end
    s_load_dwordx4 s[4:7], s[0:1], 0
    s_load_dwordx4 s[28:31], s[0:1], 16
    s_load_dwordx4 s[88:91], s[0:1], 32
    s_load_dwordx4 s[92:95], s[0:1], 48
    s_memrealtime s[86:87]
    v_lshrrev_b32 v1, 6, v0
    v_and_b32 v12, 63, v0
    v_readfirstlane_b32 s3, v1
    s_and_b32 s80, s2, 7
    s_bfe_u32 s81, s2, 0x20003
    s_lshl_b32 s35, s80, 2
    s_add_u32 s35, s35, s81
    s_lshr_b32 s34, s2, 5
    s_mul_i32 s37, s3, 6144
    s_mov_b32 s36, s37
    s_mul_i32 s72, s3, 196608
    s_mul_i32 s73, s3, 61440
    v_add_u32 v13, 0, v12
    v_mul_u32_u24 v172, 2731, v13
    v_lshrrev_b32 v172, 16, v172
    v_mul_u32_u24 v15, 24, v172
    v_sub_u32 v173, v13, v15
    v_bfe_u32 v15, v172, 1, 1
    v_xor_b32 v15, v15, v173
    v_lshlrev_b32 v15, 4, v15
    v_mul_u32_u24 v14, 12288, v172
    v_add3_u32 v15, v15, v14, s72
    v_subrev_u32 v160, 0, v15
    v_xor_b32 v15, 64, v15
    v_add_u32 v163, 95232, v15
    v_add_u32 v13, 64, v12
    v_mul_u32_u24 v174, 2731, v13
    v_lshrrev_b32 v174, 16, v174
    v_mul_u32_u24 v15, 24, v174
    v_sub_u32 v175, v13, v15
    v_bfe_u32 v15, v174, 1, 1
    v_xor_b32 v15, v15, v175
    v_lshlrev_b32 v15, 4, v15
    v_mul_u32_u24 v14, 12288, v174
    v_add3_u32 v15, v15, v14, s72
    v_subrev_u32 v161, 1024, v15
    v_xor_b32 v15, 64, v15
    v_add_u32 v164, 98304, v15
    v_add_u32 v13, 128, v12
    v_mul_u32_u24 v176, 2731, v13
    v_lshrrev_b32 v176, 16, v176
    v_mul_u32_u24 v15, 24, v176
    v_sub_u32 v177, v13, v15
    v_bfe_u32 v15, v176, 1, 1
    v_xor_b32 v15, v15, v177
    v_lshlrev_b32 v15, 4, v15
    v_mul_u32_u24 v14, 12288, v176
    v_add3_u32 v15, v15, v14, s72
    v_subrev_u32 v162, 2048, v15
    v_xor_b32 v15, 64, v15
    v_add_u32 v165, 97280, v15
    s_mul_i32 s74, s35, 384
    s_mul_i32 s75, s34, 245760
    s_lshr_b32 s40, s34, 2
    s_mul_i32 s39, s40, 786432
    s_lshl_b32 s40, s40, 7
    s_waitcnt lgkmcnt(0)
    s_add_u32 s20, s30, s74
    s_addc_u32 s21, s31, 0
    s_and_b32 s21, s21, 0xffff
    s_sub_u32 s22, 0x780000, s74
    s_mov_b32 s23, 0x20000
    s_add_u32 m0, s36, 0
    s_nop 0
    buffer_load_dwordx4 v160, s[20:23], s39 offen offset:0 lds
    buffer_load_dwordx4 v161, s[20:23], s39 offen offset:1024 lds
    buffer_load_dwordx4 v162, s[20:23], s39 offen offset:2048 lds
    buffer_load_dwordx4 v163, s[20:23], s39 offen offset:3072 lds
    s_add_u32 m0, s36, 4096
    s_nop 0
    buffer_load_dwordx4 v164, s[20:23], s39 offen offset:0 lds
    buffer_load_dwordx4 v165, s[20:23], s39 offen offset:1024 lds
    s_add_u32 s39, s39, 786432
    v_lshrrev_b32 v14, 3, v12
    v_lshrrev_b32 v15, 4, v12
    v_and_b32 v13, 7, v12
    v_xor_b32 v15, v15, v13
    v_lshlrev_b32 v15, 4, v15
    v_mul_u32_u24 v14, 1280, v14
    v_add3_u32 v15, v15, v14, s73
    v_xor_b32 v14, 64, v15
    v_add_u32 v166, 0, v15
    v_add_u32 v167, 9216, v14
    v_add_u32 v168, 18432, v15
    v_add_u32 v169, 27648, v14
    v_add_u32 v170, 40960, v15
    v_add_u32 v171, 50176, v14
    s_add_u32 s8, s4, s75
    s_addc_u32 s9, s5, 0
    s_and_b32 s9, s9, 0xffff
    s_mov_b32 s10, 0x3c000
    s_mov_b32 s11, 0x20000
    s_add_u32 m0, s36, 24576
    s_nop 0
    buffer_load_dwordx4 v166, s[8:11], s40 offen offset:0 lds
    buffer_load_dwordx4 v167, s[8:11], s40 offen offset:1024 lds
    buffer_load_dwordx4 v168, s[8:11], s40 offen offset:2048 lds
    buffer_load_dwordx4 v169, s[8:11], s40 offen offset:3072 lds
    s_add_u32 m0, s36, 28672
    s_nop 0
    buffer_load_dwordx4 v170, s[8:11], s40 offen offset:0 lds
    buffer_load_dwordx4 v171, s[8:11], s40 offen offset:1024 lds
    s_add_u32 s40, s40, 128
    s_cmp_eq_u32 s40, 1280
    s_cselect_b32 s39, 0, s39
    s_cselect_b32 s40, 0, s40
    s_getpc_b64 s[72:73]
L_pc_head:
    v_lshlrev_b32 v254, 7, v0
    v_min_u32 v254, (L_q8 - L_head - 4), v254
    s_add_u32 s72, s72, (L_head - L_pc_head)
    s_addc_u32 s73, s73, 0
    v_mov_b32 v255, s73
    v_add_co_u32 v254, vcc, s72, v254
    s_nop 1
    v_addc_co_u32 v255, vcc, 0, v255, vcc
    global_load_dword v254, v[254:255], off
L_head:
    v_lshrrev_b32 v13, 4, v12
    v_bfe_u32 v14, v12, 2, 2
    v_lshl_add_u32 v15, v13, 3, v14
    v_mul_u32_u24 v15, 384, v15
    v_lshrrev_b32 v14, 1, v14
    v_and_b32 v13, 1, v13
    v_lshl_or_b32 v14, v13, 2, v14
    v_and_b32 v13, 2, v12
    v_xor_b32 v14, v14, v13
    v_lshl_add_u32 v15, v14, 4, v15
    v_and_b32 v13, 1, v12
    v_lshl_add_u32 v3, v13, 3, v15
    v_xor_b32 v4, 16, v3
    v_xor_b32 v5, 64, v3
    v_xor_b32 v6, 80, v3
    v_and_b32 v13, 15, v12
    v_lshrrev_b32 v14, 1, v13
    v_lshrrev_b32 v15, 4, v12
    v_xor_b32 v14, v14, v15
    v_lshlrev_b32 v14, 4, v14
    v_lshl_add_u32 v14, v13, 7, v14
    s_add_u32 s43, s37, 24576
    v_add_u32 v1, s43, v14
    v_xor_b32 v2, 64, v1
    s_add_u32 s36, s37, 49152
    s_add_u32 m0, s36, 0
    s_nop 0
    buffer_load_dwordx4 v160, s[20:23], s39 offen offset:0 lds
    buffer_load_dwordx4 v161, s[20:23], s39 offen offset:1024 lds
    buffer_load_dwordx4 v162, s[20:23], s39 offen offset:2048 lds
    buffer_load_dwordx4 v163, s[20:23], s39 offen offset:3072 lds
    s_add_u32 m0, s36, 4096
    s_nop 0
    buffer_load_dwordx4 v164, s[20:23], s39 offen offset:0 lds
    buffer_load_dwordx4 v165, s[20:23], s39 offen offset:1024 lds
    s_add_u32 s39, s39, 786432
    s_add_u32 m0, s36, 24576
    s_nop 0
    buffer_load_dwordx4 v166, s[8:11], s40 offen offset:0 lds
    buffer_load_dwordx4 v167, s[8:11], s40 offen offset:1024 lds
    buffer_load_dwordx4 v168, s[8:11], s40 offen offset:2048 lds
    buffer_load_dwordx4 v169, s[8:11], s40 offen offset:3072 lds
    s_add_u32 m0, s36, 28672
    s_nop 0
    buffer_load_dwordx4 v170, s[8:11], s40 offen offset:0 lds
    buffer_load_dwordx4 v171, s[8:11], s40 offen offset:1024 lds
    s_add_u32 s40, s40, 128
    s_cmp_eq_u32 s40, 1280
    s_cselect_b32 s39, 0, s39
    s_cselect_b32 s40, 0, s40
    s_mov_b32 s47, s37
    s_add_u32 s42, s37, 49152
    s_add_u32 s36, s37, 98304
    s_waitcnt vmcnt(12) lgkmcnt(0)
    s_barrier
    ds_read_b128 v[184:187], v1 offset:0
    ds_read_b128 v[188:191], v1 offset:2048
    ds_read_b128 v[192:195], v1 offset:4096
    ds_read_b64_tr_b16 a[0:1], v3 offset:0
    ds_read_b64_tr_b16 a[2:3], v3 offset:1536
    ds_read_b64_tr_b16 a[4:5], v4 offset:0
    ds_read_b64_tr_b16 a[6:7], v4 offset:1536
    ds_read_b64_tr_b16 a[8:9], v5 offset:0
    ds_read_b64_tr_b16 a[10:11], v5 offset:1536
    ds_read_b64_tr_b16 a[12:13], v6 offset:0
    ds_read_b64_tr_b16 a[14:15], v6 offset:1536
    ds_read_b64_tr_b16 a[16:17], v3 offset:128
    ds_read_b64_tr_b16 a[18:19], v3 offset:1664
    ds_read_b64_tr_b16 a[20:21], v4 offset:128
    ds_read_b64_tr_b16 a[22:23], v4 offset:1664
    s_add_u32 m0, s36, 0
    s_nop 0
    buffer_load_dwordx4 v160, s[20:23], s39 offen offset:0 lds
    buffer_load_dwordx4 v161, s[20:23], s39 offen offset:1024 lds
    s_waitcnt lgkmcnt(8)
    v_mfma_f32_16x16x32_bf16 v[16:19], a[0:3], v[184:187], 0
    ds_read_b64_tr_b16 a[24:25], v5 offset:128
    v_mfma_f32_16x16x32_bf16 v[28:31], a[4:7], v[184:187], 0
    ds_read_b128 v[196:199], v2 offset:0
    buffer_load_dwordx4 v162, s[20:23], s39 offen offset:2048 lds
    v_mfma_f32_16x16x32_bf16 v[32:35], a[4:7], v[188:191], 0
    ds_read_b64_tr_b16 a[26:27], v5 offset:1664
    s_cmp_lt_u32 s3, 2
    s_cselect_b32 s4, s6, s28
    s_cselect_b32 s5, s7, s29
    s_cselect_b32 s6, -1, 0
    s_cselect_b32 s7, 0, -1
    s_cselect_b32 s28, 64, 0
    s_cselect_b32 s38, 12288, 0
    s_lshl_b32 s43, s34, 5
    s_add_u32 s43, s43, s35
    s_mul_i32 s43, s43, 393216
    s_add_u32 s12, s4, s43
    s_addc_u32 s13, s5, 0
    s_and_b32 s13, s13, 0xffff
    s_mov_b32 s14, 0x60000
    s_mov_b32 s15, 0x20000
    s_mov_b32 s30, s37
    s_and_b32 s29, s3, 1
    s_mul_i32 s29, s29, 6144
    v_lshrrev_b32 v15, 1, v172
    v_and_b32 v15, s6, v15
    v_and_b32 v14, 2, v172
    v_lshlrev_b32 v14, 1, v14
    v_mfma_f32_16x16x32_bf16 v[20:23], a[0:3], v[188:191], 0
    ds_read_b64_tr_b16 a[28:29], v6 offset:128
    v_mfma_f32_16x16x32_bf16 v[24:27], a[0:3], v[192:195], 0
    v_mfma_f32_16x16x32_bf16 v[36:39], a[4:7], v[192:195], 0
    ds_read_b64_tr_b16 a[30:31], v6 offset:1664
    s_waitcnt lgkmcnt(9)
    v_mfma_f32_16x16x32_bf16 v[48:51], a[8:11], v[192:195], 0
    ds_read_b64_tr_b16 a[0:1], v3 offset:256
    buffer_load_dwordx4 v163, s[20:23], s39 offen offset:3072 lds
    v_mfma_f32_16x16x32_bf16 v[60:63], a[12:15], v[192:195], 0
    v_mfma_f32_16x16x32_bf16 v[56:59], a[12:15], v[188:191], 0
    ds_read_b64_tr_b16 a[2:3], v3 offset:1792
    v_mfma_f32_16x16x32_bf16 v[44:47], a[8:11], v[188:191], 0
    ds_read_b64_tr_b16 a[4:5], v4 offset:256
    v_mfma_f32_16x16x32_bf16 v[40:43], a[8:11], v[184:187], 0
    s_add_u32 m0, s36, 4096
    v_bfe_u32 v13, v172, 2, 1
    v_lshl_or_b32 v14, v13, 1, v14
    v_and_b32 v14, s7, v14
    v_or_b32 v15, v15, v14
    v_xor_b32 v15, v15, v173
    v_lshlrev_b32 v15, 4, v15
    v_mul_u32_u24 v14, 384, v172
    v_add3_u32 v15, v15, v14, s29
    v_subrev_u32 v244, 0, v15
    v_xor_b32 v15, s28, v15
    v_add_u32 v247, 0, v15
    v_lshrrev_b32 v15, 1, v174
    v_and_b32 v15, s6, v15
    v_and_b32 v14, 2, v174
    v_lshlrev_b32 v14, 1, v14
    v_mfma_f32_16x16x32_bf16 v[52:55], a[12:15], v[184:187], 0
    ds_read_b64_tr_b16 a[6:7], v4 offset:1792
    buffer_load_dwordx4 v164, s[20:23], s39 offen offset:0 lds
    s_waitcnt lgkmcnt(9)
    v_mfma_f32_16x16x32_bf16 v[64:67], a[16:19], v[184:187], 0
    ds_read_b64_tr_b16 a[8:9], v5 offset:256
    v_mfma_f32_16x16x32_bf16 v[76:79], a[20:23], v[184:187], 0
    ds_read_b128 v[200:203], v2 offset:2048
    v_mfma_f32_16x16x32_bf16 v[80:83], a[20:23], v[188:191], 0
    ds_read_b64_tr_b16 a[10:11], v5 offset:1792
    v_mfma_f32_16x16x32_bf16 v[68:71], a[16:19], v[188:191], 0
    ds_read_b64_tr_b16 a[12:13], v6 offset:256
    v_mfma_f32_16x16x32_bf16 v[72:75], a[16:19], v[192:195], 0
    buffer_load_dwordx4 v165, s[20:23], s39 offen offset:1024 lds
    v_mfma_f32_16x16x32_bf16 v[84:87], a[20:23], v[192:195], 0
    ds_read_b64_tr_b16 a[14:15], v6 offset:1792
    s_waitcnt lgkmcnt(9)
    v_mfma_f32_16x16x32_bf16 v[96:99], a[24:27], v[192:195], 0
    ds_read_b64_tr_b16 a[16:17], v3 offset:12288
    v_bfe_u32 v13, v174, 2, 1
    v_lshl_or_b32 v14, v13, 1, v14
    v_and_b32 v14, s7, v14
    v_or_b32 v15, v15, v14
    v_xor_b32 v15, v15, v175
    v_lshlrev_b32 v15, 4, v15
    v_mul_u32_u24 v14, 384, v174
    v_add3_u32 v15, v15, v14, s29
    v_subrev_u32 v245, 1024, v15
    v_xor_b32 v15, s28, v15
    v_add_u32 v248, 3072, v15
    v_lshrrev_b32 v15, 1, v176
    v_and_b32 v15, s6, v15
    v_and_b32 v14, 2, v176
    v_lshlrev_b32 v14, 1, v14
    v_mfma_f32_16x16x32_bf16 v[108:111], a[28:31], v[192:195], 0
    s_add_u32 s39, s39, 786432
    v_mfma_f32_16x16x32_bf16 v[104:107], a[28:31], v[188:191], 0
    ds_read_b64_tr_b16 a[18:19], v3 offset:13824
    s_add_u32 m0, s36, 24576
    v_mfma_f32_16x16x32_bf16 v[92:95], a[24:27], v[188:191], 0
    ds_read_b64_tr_b16 a[20:21], v4 offset:12288
    buffer_load_dwordx4 v166, s[8:11], s40 offen offset:0 lds
    v_mfma_f32_16x16x32_bf16 v[88:91], a[24:27], v[184:187], 0
    v_mfma_f32_16x16x32_bf16 v[100:103], a[28:31], v[184:187], 0
    ds_read_b64_tr_b16 a[22:23], v4 offset:13824
    s_waitcnt lgkmcnt(9)
    v_mfma_f32_16x16x32_bf16 v[112:115], a[0:3], v[184:187], 0
    ds_read_b64_tr_b16 a[24:25], v5 offset:12288
    v_mfma_f32_16x16x32_bf16 v[124:127], a[4:7], v[184:187], 0
    ds_read_b128 v[204:207], v2 offset:4096
    v_mfma_f32_16x16x32_bf16 v[128:131], a[4:7], v[188:191], 0
    ds_read_b64_tr_b16 a[26:27], v5 offset:13824
    buffer_load_dwordx4 v167, s[8:11], s40 offen offset:1024 lds
    v_bfe_u32 v13, v176, 2, 1
    v_lshl_or_b32 v14, v13, 1, v14
    v_and_b32 v14, s7, v14
    v_or_b32 v15, v15, v14
    v_xor_b32 v15, v15, v177
    v_lshlrev_b32 v15, 4, v15
    v_mul_u32_u24 v14, 384, v176
    v_add3_u32 v15, v15, v14, s29
    v_subrev_u32 v246, 2048, v15
    v_xor_b32 v15, s28, v15
    v_add_u32 v249, 2048, v15
    s_mov_b32 s24, s94
    s_and_b32 s25, s95, 0xffff
    s_mov_b32 s26, 0x18000000
    s_mov_b32 s27, 0x20000
    v_mfma_f32_16x16x32_bf16 v[116:119], a[0:3], v[188:191], 0
    ds_read_b64_tr_b16 a[28:29], v6 offset:12288
    v_mfma_f32_16x16x32_bf16 v[120:123], a[0:3], v[192:195], 0
    v_mfma_f32_16x16x32_bf16 v[132:135], a[4:7], v[192:195], 0
    ds_read_b64_tr_b16 a[30:31], v6 offset:13824
    s_waitcnt lgkmcnt(9)
    v_mfma_f32_16x16x32_bf16 v[144:147], a[8:11], v[192:195], 0
    ds_read_b64_tr_b16 a[0:1], v3 offset:12416
    v_mfma_f32_16x16x32_bf16 v[156:159], a[12:15], v[192:195], 0
    buffer_load_dwordx4 v168, s[8:11], s40 offen offset:2048 lds
    v_mfma_f32_16x16x32_bf16 v[152:155], a[12:15], v[188:191], 0
    ds_read_b64_tr_b16 a[2:3], v3 offset:13952
    v_mfma_f32_16x16x32_bf16 v[140:143], a[8:11], v[188:191], 0
    ds_read_b64_tr_b16 a[4:5], v4 offset:12416
    v_mfma_f32_16x16x32_bf16 v[136:139], a[8:11], v[184:187], 0
    s_mov_b32 s76, s92
    s_and_b32 s77, s93, 0xffff
    s_mov_b32 s78, 0x100
    s_mov_b32 s79, 0x20000
    s_mov_b32 s44, 0x3dd53b95
    s_mov_b32 s45, 0x3dd53b95
    s_mov_b32 s85, 0
    s_mul_i32 s72, s80, 983040
    s_add_u32 s96, s88, s72
    s_addc_u32 s97, s89, 0
    s_and_b32 s97, s97, 0xffff
    s_mov_b32 s98, 0xf0000
    s_mov_b32 s99, 0x20000
    s_lshr_b32 s101, s2, 3
    s_lshl_b32 s101, s101, 2
    s_add_u32 s101, s101, s3
    v_mfma_f32_16x16x32_bf16 v[148:151], a[12:15], v[184:187], 0
    ds_read_b64_tr_b16 a[6:7], v4 offset:13952
    s_waitcnt lgkmcnt(7)
    v_mfma_f32_16x16x32_bf16 v[16:19], a[16:19], v[196:199], v[16:19]
    ds_read_b64_tr_b16 a[8:9], v5 offset:12416
    buffer_load_dwordx4 v169, s[8:11], s40 offen offset:3072 lds
    v_mfma_f32_16x16x32_bf16 v[28:31], a[20:23], v[196:199], v[28:31]
    v_mfma_f32_16x16x32_bf16 v[32:35], a[20:23], v[200:203], v[32:35]
    ds_read_b64_tr_b16 a[10:11], v5 offset:13952
    v_mfma_f32_16x16x32_bf16 v[20:23], a[16:19], v[200:203], v[20:23]
    ds_read_b64_tr_b16 a[12:13], v6 offset:12416
    v_mfma_f32_16x16x32_bf16 v[24:27], a[16:19], v[204:207], v[24:27]
    s_add_u32 m0, s36, 28672
    v_mfma_f32_16x16x32_bf16 v[36:39], a[20:23], v[204:207], v[36:39]
    ds_read_b64_tr_b16 a[14:15], v6 offset:13952
    buffer_load_dwordx4 v170, s[8:11], s40 offen offset:0 lds
    s_waitcnt lgkmcnt(8)
    v_mfma_f32_16x16x32_bf16 v[48:51], a[24:27], v[204:207], v[48:51]
    ds_read_b64_tr_b16 a[16:17], v3 offset:12544
    s_mul_i32 s101, s101, 7680
    v_lshlrev_b32 v13, 7, v12
    v_cmp_gt_u32 vcc, 60, v12
    v_mov_b32 v253, 0x40000000
    s_nop 0
    v_cndmask_b32 v253, v253, v13, vcc
    v_and_b32 v12, 63, v0
    v_and_b32 v13, 15, v12
    v_lshrrev_b32 v14, 1, v13
    v_lshrrev_b32 v15, 4, v12
    v_xor_b32 v14, v14, v15
    v_mul_u32_u24 v13, 384, v13
    v_lshl_add_u32 v10, v14, 4, v13
    v_add_u32 v10, 147456, v10
    v_xor_b32 v11, 64, v10
    v_mov_b32 v7, 0
    v_mfma_f32_16x16x32_bf16 v[60:63], a[28:31], v[204:207], v[60:63]
    v_mfma_f32_16x16x32_bf16 v[56:59], a[28:31], v[200:203], v[56:59]
    ds_read_b64_tr_b16 a[18:19], v3 offset:14080
    v_mfma_f32_16x16x32_bf16 v[44:47], a[24:27], v[200:203], v[44:47]
    ds_read_b64_tr_b16 a[20:21], v4 offset:12544
    v_mfma_f32_16x16x32_bf16 v[40:43], a[24:27], v[196:199], v[40:43]
    buffer_load_dwordx4 v171, s[8:11], s40 offen offset:1024 lds
    v_mfma_f32_16x16x32_bf16 v[52:55], a[28:31], v[196:199], v[52:55]
    ds_read_b64_tr_b16 a[22:23], v4 offset:14080
    s_add_u32 s40, s40, 128
    s_waitcnt lgkmcnt(8)
    v_mfma_f32_16x16x32_bf16 v[64:67], a[0:3], v[196:199], v[64:67]
    ds_read_b64_tr_b16 a[24:25], v5 offset:12544
    s_cmp_eq_u32 s40, 1280
    s_cselect_b32 s39, 0, s39
    s_cselect_b32 s40, 0, s40
    v_mfma_f32_16x16x32_bf16 v[76:79], a[4:7], v[196:199], v[76:79]
    s_sub_u32 s46, s42, s47
    v_mfma_f32_16x16x32_bf16 v[80:83], a[4:7], v[200:203], v[80:83]
    ds_read_b64_tr_b16 a[26:27], v5 offset:14080
    v_mov_b32 v8, 0
    v_mov_b32 v9, 0
    s_lshl_b32 s43, s2, 2
    s_add_u32 s43, s43, s3
    s_cmp_lg_u32 s43, 3
    s_cbranch_scc1 L_no_nonce
    s_or_b32 s43, s86, 1
    v_mov_b32 v13, s43
    buffer_store_dword v13, off, s[76:79], 0 sc1
L_no_nonce:
    v_and_b32 v12, 63, v0
    s_mov_b32 s64, s90
    s_and_b32 s65, s91, 0xffff
    s_mov_b32 s66, 0x1e0000
    s_mov_b32 s67, 0x20000
    s_mul_i32 s72, s80, 983040
    s_mul_i32 s43, s81, 320
    s_add_u32 s72, s72, s43
    s_add_u32 s16, s88, s72
    s_addc_u32 s17, s89, 0
    s_and_b32 s17, s17, 0xffff
    s_sub_u32 s18, 0x780000, s72
    s_mov_b32 s19, 0x20000
    v_mfma_f32_16x16x32_bf16 v[68:71], a[0:3], v[200:203], v[68:71]
    ds_read_b64_tr_b16 a[28:29], v6 offset:12544
    s_mov_b32 s42, s36
    v_mfma_f32_16x16x32_bf16 v[72:75], a[0:3], v[204:207], v[72:75]
    v_mfma_f32_16x16x32_bf16 v[84:87], a[4:7], v[204:207], v[84:87]
    ds_read_b64_tr_b16 a[30:31], v6 offset:14080
    s_waitcnt lgkmcnt(8)
    v_mfma_f32_16x16x32_bf16 v[96:99], a[8:11], v[204:207], v[96:99]
    s_mov_b32 s36, s47
    v_mfma_f32_16x16x32_bf16 v[108:111], a[12:15], v[204:207], v[108:111]
    s_add_u32 s47, s47, s46
    v_mfma_f32_16x16x32_bf16 v[104:107], a[12:15], v[200:203], v[104:107]
    v_add_u32 v1, s46, v1
    v_add_u32 v2, s46, v2
    v_mfma_f32_16x16x32_bf16 v[92:95], a[8:11], v[200:203], v[92:95]
    v_add_u32 v3, s46, v3
    v_add_u32 v4, s46, v4
    v_mfma_f32_16x16x32_bf16 v[88:91], a[8:11], v[196:199], v[88:91]
    v_add_u32 v5, s46, v5
    v_add_u32 v6, s46, v6
    s_mul_i32 s49, s3, 10240
    s_mul_i32 s51, s81, 6
    s_cmp_eq_u32 s3, 1
    s_cselect_b32 s50, 0x3ba35421, 0
    s_cmp_eq_u32 s3, 2
    s_cselect_b32 s50, 0xe5e7c42, s50
    s_cmp_eq_u32 s3, 3
    s_cselect_b32 s50, 0x3f08503, s50
    s_xor_b32 s50, s50, 0x2cf44880
    v_add_u32 v13, 0, v12
    v_mul_u32_u24 v14, 3277, v13
    v_lshrrev_b32 v14, 16, v14
    v_mul_u32_u24 v15, 20, v14
    v_sub_u32 v13, v13, v15
    v_bfe_u32 v15, v14, 2, 1
    v_xor_b32 v13, v13, v15
    v_lshlrev_b32 v13, 4, v13
    v_mfma_f32_16x16x32_bf16 v[100:103], a[12:15], v[196:199], v[100:103]
    s_waitcnt vmcnt(12) lgkmcnt(0)
    s_barrier
    s_cmp_ge_u32 s3, 2
    s_cbranch_scc1 L_skip_k0
    s_add_u32 m0, s30, 147456
    s_nop 0
    buffer_load_dwordx4 v244, s[12:15], 0 offen offset:0 nt lds
    buffer_load_dwordx4 v245, s[12:15], 0 offen offset:1024 nt lds
    buffer_load_dwordx4 v246, s[12:15], 0 offen offset:2048 nt lds
    buffer_load_dwordx4 v247, s[12:15], 0 offen offset:3072 nt lds
    s_add_u32 m0, s30, 151552
    s_nop 0
    buffer_load_dwordx4 v248, s[12:15], 0 offen offset:0 nt lds
    buffer_load_dwordx4 v249, s[12:15], 0 offen offset:1024 nt lds
L_skip_k0:
    v_mfma_f32_16x16x32_bf16 v[112:115], a[16:19], v[196:199], v[112:115]
    ds_read_b128 v[184:187], v1 offset:0
    v_mfma_f32_16x16x32_bf16 v[124:127], a[20:23], v[196:199], v[124:127]
    s_add_u32 m0, s36, 0
    ds_read_b128 v[188:191], v1 offset:2048
    v_mfma_f32_16x16x32_bf16 v[128:131], a[20:23], v[200:203], v[128:131]
    buffer_load_dwordx4 v160, s[20:23], s39 offen offset:0 lds
    ds_read_b128 v[192:195], v1 offset:4096
    v_mfma_f32_16x16x32_bf16 v[116:119], a[16:19], v[200:203], v[116:119]
    ds_read_b64_tr_b16 a[0:1], v3 offset:0
    v_mfma_f32_16x16x32_bf16 v[120:123], a[16:19], v[204:207], v[120:123]
    ds_read_b64_tr_b16 a[2:3], v3 offset:1536
    ds_read_b64_tr_b16 a[4:5], v4 offset:0
    v_mfma_f32_16x16x32_bf16 v[132:135], a[20:23], v[204:207], v[132:135]
    ds_read_b64_tr_b16 a[6:7], v4 offset:1536
    v_mfma_f32_16x16x32_bf16 v[144:147], a[24:27], v[204:207], v[144:147]
    ds_read_b64_tr_b16 a[8:9], v5 offset:0
    ds_read_b64_tr_b16 a[10:11], v5 offset:1536
    v_mfma_f32_16x16x32_bf16 v[156:159], a[28:31], v[204:207], v[156:159]
    ds_read_b64_tr_b16 a[12:13], v6 offset:0
    v_mfma_f32_16x16x32_bf16 v[152:155], a[28:31], v[200:203], v[152:155]
    buffer_load_dwordx4 v161, s[20:23], s39 offen offset:1024 lds
    ds_read_b64_tr_b16 a[14:15], v6 offset:1536
    v_mfma_f32_16x16x32_bf16 v[140:143], a[24:27], v[200:203], v[140:143]
    ds_read_b64_tr_b16 a[16:17], v3 offset:128
    ds_read_b64_tr_b16 a[18:19], v3 offset:1664
    v_mfma_f32_16x16x32_bf16 v[136:139], a[24:27], v[196:199], v[136:139]
    ds_read_b64_tr_b16 a[20:21], v4 offset:128
    v_mfma_f32_16x16x32_bf16 v[148:151], a[28:31], v[196:199], v[148:151]
    ds_read_b64_tr_b16 a[22:23], v4 offset:1664
    s_waitcnt lgkmcnt(8)
    v_mfma_f32_16x16x32_bf16 v[16:19], a[0:3], v[184:187], v[16:19]
    ds_read_b64_tr_b16 a[24:25], v5 offset:128
    v_mfma_f32_16x16x32_bf16 v[28:31], a[4:7], v[184:187], v[28:31]
    ds_read_b128 v[196:199], v2 offset:0
    buffer_load_dwordx4 v162, s[20:23], s39 offen offset:2048 lds
    v_mfma_f32_16x16x32_bf16 v[32:35], a[4:7], v[188:191], v[32:35]
    ds_read_b64_tr_b16 a[26:27], v5 offset:1664
    v_mul_u32_u24 v14, 1280, v14
    v_add_u32 v13, v13, v14
    v_subrev_u32 v232, 0, v13
    v_add_u32 v237, 19456, v13
    v_add_u32 v13, 64, v12
    v_mul_u32_u24 v14, 3277, v13
    v_lshrrev_b32 v14, 16, v14
    v_mul_u32_u24 v15, 20, v14
    v_sub_u32 v13, v13, v15
    v_bfe_u32 v15, v14, 2, 1
    v_xor_b32 v13, v13, v15
    v_lshlrev_b32 v13, 4, v13
    v_mul_u32_u24 v14, 1280, v14
    v_add_u32 v13, v13, v14
    v_subrev_u32 v233, 1024, v13
    v_mfma_f32_16x16x32_bf16 v[20:23], a[0:3], v[188:191], v[20:23]
    ds_read_b64_tr_b16 a[28:29], v6 offset:128
    v_mfma_f32_16x16x32_bf16 v[24:27], a[0:3], v[192:195], v[24:27]
    v_mfma_f32_16x16x32_bf16 v[36:39], a[4:7], v[192:195], v[36:39]
    ds_read_b64_tr_b16 a[30:31], v6 offset:1664
    s_waitcnt lgkmcnt(9)
    v_mfma_f32_16x16x32_bf16 v[48:51], a[8:11], v[192:195], v[48:51]
    ds_read_b64_tr_b16 a[0:1], v3 offset:256
    buffer_load_dwordx4 v163, s[20:23], s39 offen offset:3072 lds
    v_mfma_f32_16x16x32_bf16 v[60:63], a[12:15], v[192:195], v[60:63]
    v_mfma_f32_16x16x32_bf16 v[56:59], a[12:15], v[188:191], v[56:59]
    ds_read_b64_tr_b16 a[2:3], v3 offset:1792
    v_mfma_f32_16x16x32_bf16 v[44:47], a[8:11], v[188:191], v[44:47]
    ds_read_b64_tr_b16 a[4:5], v4 offset:256
    v_mfma_f32_16x16x32_bf16 v[40:43], a[8:11], v[184:187], v[40:43]
    s_add_u32 m0, s36, 4096
    v_mfma_f32_16x16x32_bf16 v[52:55], a[12:15], v[184:187], v[52:55]
    ds_read_b64_tr_b16 a[6:7], v4 offset:1792
    buffer_load_dwordx4 v164, s[20:23], s39 offen offset:0 lds
    v_add_u32 v238, 18432, v13
    v_add_u32 v13, 128, v12
    v_mul_u32_u24 v14, 3277, v13
    v_lshrrev_b32 v14, 16, v14
    v_mul_u32_u24 v15, 20, v14
    v_sub_u32 v13, v13, v15
    v_bfe_u32 v15, v14, 2, 1
    v_xor_b32 v13, v13, v15
    v_lshlrev_b32 v13, 4, v13
    v_mul_u32_u24 v14, 1280, v14
    v_add_u32 v13, v13, v14
    v_subrev_u32 v234, 2048, v13
    v_add_u32 v239, 17408, v13
    v_add_u32 v13, 192, v12
    v_mul_u32_u24 v14, 3277, v13
    s_waitcnt lgkmcnt(9)
    v_mfma_f32_16x16x32_bf16 v[64:67], a[16:19], v[184:187], v[64:67]
    ds_read_b64_tr_b16 a[8:9], v5 offset:256
    v_mfma_f32_16x16x32_bf16 v[76:79], a[20:23], v[184:187], v[76:79]
    ds_read_b128 v[200:203], v2 offset:2048
    v_mfma_f32_16x16x32_bf16 v[80:83], a[20:23], v[188:191], v[80:83]
    ds_read_b64_tr_b16 a[10:11], v5 offset:1792
    v_mfma_f32_16x16x32_bf16 v[68:71], a[16:19], v[188:191], v[68:71]
    ds_read_b64_tr_b16 a[12:13], v6 offset:256
    v_mfma_f32_16x16x32_bf16 v[72:75], a[16:19], v[192:195], v[72:75]
    buffer_load_dwordx4 v165, s[20:23], s39 offen offset:1024 lds
    v_mfma_f32_16x16x32_bf16 v[84:87], a[20:23], v[192:195], v[84:87]
    ds_read_b64_tr_b16 a[14:15], v6 offset:1792
    s_waitcnt lgkmcnt(9)
    v_mfma_f32_16x16x32_bf16 v[96:99], a[24:27], v[192:195], v[96:99]
    ds_read_b64_tr_b16 a[16:17], v3 offset:12288
    v_mfma_f32_16x16x32_bf16 v[108:111], a[28:31], v[192:195], v[108:111]
    s_add_u32 s39, s39, 786432
    v_mfma_f32_16x16x32_bf16 v[104:107], a[28:31], v[188:191], v[104:107]
    ds_read_b64_tr_b16 a[18:19], v3 offset:13824
    s_add_u32 m0, s36, 24576
    v_mfma_f32_16x16x32_bf16 v[92:95], a[24:27], v[188:191], v[92:95]
    ds_read_b64_tr_b16 a[20:21], v4 offset:12288
    buffer_load_dwordx4 v166, s[8:11], s40 offen offset:0 lds
    v_lshrrev_b32 v14, 16, v14
    v_mul_u32_u24 v15, 20, v14
    v_sub_u32 v13, v13, v15
    v_bfe_u32 v15, v14, 2, 1
    v_xor_b32 v13, v13, v15
    v_lshlrev_b32 v13, 4, v13
    v_mul_u32_u24 v14, 1280, v14
    v_add_u32 v13, v13, v14
    v_subrev_u32 v235, 3072, v13
    v_add_u32 v240, 20480, v13
    v_add_u32 v13, 256, v12
    v_mul_u32_u24 v14, 3277, v13
    v_lshrrev_b32 v14, 16, v14
    v_mul_u32_u24 v15, 20, v14
    v_sub_u32 v13, v13, v15
    v_mfma_f32_16x16x32_bf16 v[88:91], a[24:27], v[184:187], v[88:91]
    v_mfma_f32_16x16x32_bf16 v[100:103], a[28:31], v[184:187], v[100:103]
    ds_read_b64_tr_b16 a[22:23], v4 offset:13824
    s_waitcnt lgkmcnt(9)
    v_mfma_f32_16x16x32_bf16 v[112:115], a[0:3], v[184:187], v[112:115]
    ds_read_b64_tr_b16 a[24:25], v5 offset:12288
    v_mfma_f32_16x16x32_bf16 v[124:127], a[4:7], v[184:187], v[124:127]
    ds_read_b128 v[204:207], v2 offset:4096
    v_mfma_f32_16x16x32_bf16 v[128:131], a[4:7], v[188:191], v[128:131]
    ds_read_b64_tr_b16 a[26:27], v5 offset:13824
    buffer_load_dwordx4 v167, s[8:11], s40 offen offset:1024 lds
    v_mfma_f32_16x16x32_bf16 v[116:119], a[0:3], v[188:191], v[116:119]
    ds_read_b64_tr_b16 a[28:29], v6 offset:12288
    v_mfma_f32_16x16x32_bf16 v[120:123], a[0:3], v[192:195], v[120:123]
    v_mfma_f32_16x16x32_bf16 v[132:135], a[4:7], v[192:195], v[132:135]
    ds_read_b64_tr_b16 a[30:31], v6 offset:13824
    s_waitcnt lgkmcnt(9)
    v_mfma_f32_16x16x32_bf16 v[144:147], a[8:11], v[192:195], v[144:147]
    ds_read_b64_tr_b16 a[0:1], v3 offset:12416
    v_mfma_f32_16x16x32_bf16 v[156:159], a[12:15], v[192:195], v[156:159]
    buffer_load_dwordx4 v168, s[8:11], s40 offen offset:2048 lds
    v_bfe_u32 v15, v14, 2, 1
    v_xor_b32 v13, v13, v15
    v_lshlrev_b32 v13, 4, v13
    v_mul_u32_u24 v14, 1280, v14
    v_add_u32 v13, v13, v14
    v_subrev_u32 v236, 0, v13
    v_add_u32 v241, 19456, v13
    s_lshl_b32 s83, s34, 3
    s_add_u32 s83, s83, s80
    s_mul_i32 s83, s83, 303104
    s_add_u32 s100, s83, 294912
    s_mul_i32 s43, s3, 18432
    s_add_u32 s83, s83, s43
    v_min_u32 v13, 2, v12
    v_add3_u32 v13, v13, s81, 1
    v_mfma_f32_16x16x32_bf16 v[152:155], a[12:15], v[188:191], v[152:155]
    ds_read_b64_tr_b16 a[2:3], v3 offset:13952
    v_mfma_f32_16x16x32_bf16 v[140:143], a[8:11], v[188:191], v[140:143]
    ds_read_b64_tr_b16 a[4:5], v4 offset:12416
    v_mfma_f32_16x16x32_bf16 v[136:139], a[8:11], v[184:187], v[136:139]
    v_mfma_f32_16x16x32_bf16 v[148:151], a[12:15], v[184:187], v[148:151]
    ds_read_b64_tr_b16 a[6:7], v4 offset:13952
    s_waitcnt lgkmcnt(7)
    v_mfma_f32_16x16x32_bf16 v[16:19], a[16:19], v[196:199], v[16:19]
    ds_read_b64_tr_b16 a[8:9], v5 offset:12416
    buffer_load_dwordx4 v169, s[8:11], s40 offen offset:3072 lds
    v_mfma_f32_16x16x32_bf16 v[28:31], a[20:23], v[196:199], v[28:31]
    v_mfma_f32_16x16x32_bf16 v[32:35], a[20:23], v[200:203], v[32:35]
    ds_read_b64_tr_b16 a[10:11], v5 offset:13952
    v_mfma_f32_16x16x32_bf16 v[20:23], a[16:19], v[200:203], v[20:23]
    ds_read_b64_tr_b16 a[12:13], v6 offset:12416
    v_mfma_f32_16x16x32_bf16 v[24:27], a[16:19], v[204:207], v[24:27]
    s_add_u32 m0, s36, 28672
    v_mfma_f32_16x16x32_bf16 v[36:39], a[20:23], v[204:207], v[36:39]
    ds_read_b64_tr_b16 a[14:15], v6 offset:13952
    buffer_load_dwordx4 v170, s[8:11], s40 offen offset:0 lds
    v_and_b32 v13, 3, v13
    v_lshlrev_b32 v13, 7, v13
    v_add_u32 v242, s100, v13
    s_lshl_b32 s68, s34, 2
    s_add_u32 s68, s68, s81
    s_mul_i32 s68, s68, 499712
    s_add_u32 s68, s68, 0x2000000
    s_lshl_b32 s71, s80, 2
    s_add_u32 s71, s71, s3
    s_add_u32 s73, s80, 0
    s_mul_i32 s74, s73, 86
    s_lshr_b32 s74, s74, 8
    s_mul_i32 s75, s74, 3
    s_sub_u32 s75, s73, s75
    s_mul_i32 s69, s34, 12
    s_waitcnt lgkmcnt(8)
    v_mfma_f32_16x16x32_bf16 v[48:51], a[24:27], v[204:207], v[48:51]
    ds_read_b64_tr_b16 a[16:17], v3 offset:12544
    v_mfma_f32_16x16x32_bf16 v[60:63], a[28:31], v[204:207], v[60:63]
    v_mfma_f32_16x16x32_bf16 v[56:59], a[28:31], v[200:203], v[56:59]
    ds_read_b64_tr_b16 a[18:19], v3 offset:14080
    v_mfma_f32_16x16x32_bf16 v[44:47], a[24:27], v[200:203], v[44:47]
    ds_read_b64_tr_b16 a[20:21], v4 offset:12544
    v_mfma_f32_16x16x32_bf16 v[40:43], a[24:27], v[196:199], v[40:43]
    buffer_load_dwordx4 v171, s[8:11], s40 offen offset:1024 lds
    v_mfma_f32_16x16x32_bf16 v[52:55], a[28:31], v[196:199], v[52:55]
    ds_read_b64_tr_b16 a[22:23], v4 offset:14080
    s_add_u32 s40, s40, 128
    s_waitcnt lgkmcnt(8)
    v_mfma_f32_16x16x32_bf16 v[64:67], a[0:3], v[196:199], v[64:67]
    ds_read_b64_tr_b16 a[24:25], v5 offset:12544
    s_cmp_eq_u32 s40, 1280
    s_cselect_b32 s39, 0, s39
    s_cselect_b32 s40, 0, s40
    v_mfma_f32_16x16x32_bf16 v[76:79], a[4:7], v[196:199], v[76:79]
    s_sub_u32 s46, s42, s47
    v_mfma_f32_16x16x32_bf16 v[80:83], a[4:7], v[200:203], v[80:83]
    ds_read_b64_tr_b16 a[26:27], v5 offset:14080
    v_mfma_f32_16x16x32_bf16 v[68:71], a[0:3], v[200:203], v[68:71]
    ds_read_b64_tr_b16 a[28:29], v6 offset:12544
    s_mov_b32 s42, s36
    s_mul_i32 s72, s3, 3
    s_add_u32 s69, s69, s72
    s_add_u32 s69, s69, s75
    s_mul_i32 s69, s69, 20480
    s_mul_i32 s72, s81, 320
    s_add_u32 s69, s69, s72
    s_lshl_b32 s74, s74, 6
    s_add_u32 s69, s69, s74
    s_mul_i32 s72, s3, 15
    s_add_u32 s72, s72, s73
    s_lshl_b32 s72, s72, 10
    s_add_u32 s94, s72, s68
    s_add_u32 s73, s80, 8
    s_mul_i32 s74, s73, 86
    s_lshr_b32 s74, s74, 8
    v_mfma_f32_16x16x32_bf16 v[72:75], a[0:3], v[204:207], v[72:75]
    v_mfma_f32_16x16x32_bf16 v[84:87], a[4:7], v[204:207], v[84:87]
    ds_read_b64_tr_b16 a[30:31], v6 offset:14080
    s_waitcnt lgkmcnt(8)
    v_mfma_f32_16x16x32_bf16 v[96:99], a[8:11], v[204:207], v[96:99]
    s_mov_b32 s36, s47
    v_mfma_f32_16x16x32_bf16 v[108:111], a[12:15], v[204:207], v[108:111]
    s_add_u32 s47, s47, s46
    v_mfma_f32_16x16x32_bf16 v[104:107], a[12:15], v[200:203], v[104:107]
    v_add_u32 v1, s46, v1
    v_add_u32 v2, s46, v2
    v_mfma_f32_16x16x32_bf16 v[92:95], a[8:11], v[200:203], v[92:95]
    v_add_u32 v3, s46, v3
    v_add_u32 v4, s46, v4
    v_mfma_f32_16x16x32_bf16 v[88:91], a[8:11], v[196:199], v[88:91]
    v_add_u32 v5, s46, v5
    v_add_u32 v6, s46, v6
    v_mfma_f32_16x16x32_bf16 v[100:103], a[12:15], v[196:199], v[100:103]
    s_waitcnt vmcnt(12) lgkmcnt(0)
    s_barrier
    v_mfma_f32_16x16x32_bf16 v[112:115], a[16:19], v[196:199], v[112:115]
    ds_read_b128 v[184:187], v1 offset:0
    v_mfma_f32_16x16x32_bf16 v[124:127], a[20:23], v[196:199], v[124:127]
    s_add_u32 m0, s36, 0
    ds_read_b128 v[188:191], v1 offset:2048
    s_mul_i32 s75, s74, 3
    s_sub_u32 s75, s73, s75
    s_mul_i32 s70, s34, 12
    s_mul_i32 s72, s3, 3
    s_add_u32 s70, s70, s72
    s_add_u32 s70, s70, s75
    s_mul_i32 s70, s70, 20480
    s_mul_i32 s72, s81, 320
    s_add_u32 s70, s70, s72
    s_lshl_b32 s74, s74, 6
    s_add_u32 s70, s70, s74
    s_mul_i32 s72, s3, 15
    s_add_u32 s72, s72, s73
    s_lshl_b32 s72, s72, 10
    s_add_u32 s95, s72, s68
    v_mfma_f32_16x16x32_bf16 v[128:131], a[20:23], v[200:203], v[128:131]
    buffer_load_dwordx4 v160, s[20:23], s39 offen offset:0 lds
    ds_read_b128 v[192:195], v1 offset:4096
    v_mfma_f32_16x16x32_bf16 v[116:119], a[16:19], v[200:203], v[116:119]
    ds_read_b64_tr_b16 a[0:1], v3 offset:0
    v_mfma_f32_16x16x32_bf16 v[120:123], a[16:19], v[204:207], v[120:123]
    ds_read_b64_tr_b16 a[2:3], v3 offset:1536
    ds_read_b64_tr_b16 a[4:5], v4 offset:0
    v_mfma_f32_16x16x32_bf16 v[132:135], a[20:23], v[204:207], v[132:135]
    ds_read_b64_tr_b16 a[6:7], v4 offset:1536
    v_mfma_f32_16x16x32_bf16 v[144:147], a[24:27], v[204:207], v[144:147]
    ds_read_b64_tr_b16 a[8:9], v5 offset:0
    ds_read_b64_tr_b16 a[10:11], v5 offset:1536
    v_mfma_f32_16x16x32_bf16 v[156:159], a[28:31], v[204:207], v[156:159]
    ds_read_b64_tr_b16 a[12:13], v6 offset:0
    v_mfma_f32_16x16x32_bf16 v[152:155], a[28:31], v[200:203], v[152:155]
    buffer_load_dwordx4 v161, s[20:23], s39 offen offset:1024 lds
    ds_read_b64_tr_b16 a[14:15], v6 offset:1536
    v_mfma_f32_16x16x32_bf16 v[140:143], a[24:27], v[200:203], v[140:143]
    ds_read_b64_tr_b16 a[16:17], v3 offset:128
    ds_read_b64_tr_b16 a[18:19], v3 offset:1664
    v_mfma_f32_16x16x32_bf16 v[136:139], a[24:27], v[196:199], v[136:139]
    ds_read_b64_tr_b16 a[20:21], v4 offset:128
    v_mfma_f32_16x16x32_bf16 v[148:151], a[28:31], v[196:199], v[148:151]
    ds_read_b64_tr_b16 a[22:23], v4 offset:1664
    s_add_u32 s4, s81, 1
    s_and_b32 s4, s4, 3
    s_mul_i32 s4, s4, 73728
    s_add_u32 s4, s4, s83
    s_add_u32 s5, s4, 3072
    s_add_u32 s6, s81, 2
    s_and_b32 s6, s6, 3
    s_mul_i32 s6, s6, 73728
    s_add_u32 s6, s6, s83
    s_add_u32 s7, s6, 3072
    s_add_u32 s28, s81, 3
    s_and_b32 s28, s28, 3
    s_mul_i32 s28, s28, 73728
    s_add_u32 s28, s28, s83
    s_add_u32 s29, s28, 3072
    s_mov_b32 s41, 5
L_q_loop:
    s_waitcnt lgkmcnt(8)
    v_mfma_f32_16x16x32_bf16 v[16:19], a[0:3], v[184:187], v[16:19]
    ds_read_b64_tr_b16 a[24:25], v5 offset:128
    v_mfma_f32_16x16x32_bf16 v[28:31], a[4:7], v[184:187], v[28:31]
    ds_read_b128 v[196:199], v2 offset:0
    buffer_load_dwordx4 v162, s[20:23], s39 offen offset:2048 lds
    v_mfma_f32_16x16x32_bf16 v[32:35], a[4:7], v[188:191], v[32:35]
    ds_read_b64_tr_b16 a[26:27], v5 offset:1664
    v_mfma_f32_16x16x32_bf16 v[20:23], a[0:3], v[188:191], v[20:23]
    ds_read_b64_tr_b16 a[28:29], v6 offset:128
    v_mfma_f32_16x16x32_bf16 v[24:27], a[0:3], v[192:195], v[24:27]
    v_mfma_f32_16x16x32_bf16 v[36:39], a[4:7], v[192:195], v[36:39]
    ds_read_b64_tr_b16 a[30:31], v6 offset:1664
    s_waitcnt lgkmcnt(9)
    v_mfma_f32_16x16x32_bf16 v[48:51], a[8:11], v[192:195], v[48:51]
    ds_read_b64_tr_b16 a[0:1], v3 offset:256
    buffer_load_dwordx4 v163, s[20:23], s39 offen offset:3072 lds
    v_mfma_f32_16x16x32_bf16 v[60:63], a[12:15], v[192:195], v[60:63]
    v_mfma_f32_16x16x32_bf16 v[56:59], a[12:15], v[188:191], v[56:59]
    ds_read_b64_tr_b16 a[2:3], v3 offset:1792
    v_mfma_f32_16x16x32_bf16 v[44:47], a[8:11], v[188:191], v[44:47]
    ds_read_b64_tr_b16 a[4:5], v4 offset:256
    v_mfma_f32_16x16x32_bf16 v[40:43], a[8:11], v[184:187], v[40:43]
    s_add_u32 m0, s36, 4096
    v_mfma_f32_16x16x32_bf16 v[52:55], a[12:15], v[184:187], v[52:55]
    ds_read_b64_tr_b16 a[6:7], v4 offset:1792
    buffer_load_dwordx4 v164, s[20:23], s39 offen offset:0 lds
    s_waitcnt lgkmcnt(9)
    v_mfma_f32_16x16x32_bf16 v[64:67], a[16:19], v[184:187], v[64:67]
    ds_read_b64_tr_b16 a[8:9], v5 offset:256
    v_mfma_f32_16x16x32_bf16 v[76:79], a[20:23], v[184:187], v[76:79]
    ds_read_b128 v[200:203], v2 offset:2048
    v_mfma_f32_16x16x32_bf16 v[80:83], a[20:23], v[188:191], v[80:83]
    ds_read_b64_tr_b16 a[10:11], v5 offset:1792
    v_mfma_f32_16x16x32_bf16 v[68:71], a[16:19], v[188:191], v[68:71]
    ds_read_b64_tr_b16 a[12:13], v6 offset:256
    v_mfma_f32_16x16x32_bf16 v[72:75], a[16:19], v[192:195], v[72:75]
    buffer_load_dwordx4 v165, s[20:23], s39 offen offset:1024 lds
    v_mfma_f32_16x16x32_bf16 v[84:87], a[20:23], v[192:195], v[84:87]
    ds_read_b64_tr_b16 a[14:15], v6 offset:1792
    s_waitcnt lgkmcnt(9)
    v_mfma_f32_16x16x32_bf16 v[96:99], a[24:27], v[192:195], v[96:99]
    ds_read_b64_tr_b16 a[16:17], v3 offset:12288
    v_mfma_f32_16x16x32_bf16 v[108:111], a[28:31], v[192:195], v[108:111]
    s_add_u32 s39, s39, 786432
    v_mfma_f32_16x16x32_bf16 v[104:107], a[28:31], v[188:191], v[104:107]
    ds_read_b64_tr_b16 a[18:19], v3 offset:13824
    s_add_u32 m0, s36, 24576
    v_mfma_f32_16x16x32_bf16 v[92:95], a[24:27], v[188:191], v[92:95]
    ds_read_b64_tr_b16 a[20:21], v4 offset:12288
    buffer_load_dwordx4 v166, s[8:11], s40 offen offset:0 lds
    v_mfma_f32_16x16x32_bf16 v[88:91], a[24:27], v[184:187], v[88:91]
    v_mfma_f32_16x16x32_bf16 v[100:103], a[28:31], v[184:187], v[100:103]
    ds_read_b64_tr_b16 a[22:23], v4 offset:13824
    s_waitcnt lgkmcnt(9)
    v_mfma_f32_16x16x32_bf16 v[112:115], a[0:3], v[184:187], v[112:115]
    ds_read_b64_tr_b16 a[24:25], v5 offset:12288
    v_mfma_f32_16x16x32_bf16 v[124:127], a[4:7], v[184:187], v[124:127]
    ds_read_b128 v[204:207], v2 offset:4096
    v_mfma_f32_16x16x32_bf16 v[128:131], a[4:7], v[188:191], v[128:131]
    ds_read_b64_tr_b16 a[26:27], v5 offset:13824
    buffer_load_dwordx4 v167, s[8:11], s40 offen offset:1024 lds
    v_mfma_f32_16x16x32_bf16 v[116:119], a[0:3], v[188:191], v[116:119]
    ds_read_b64_tr_b16 a[28:29], v6 offset:12288
    v_mfma_f32_16x16x32_bf16 v[120:123], a[0:3], v[192:195], v[120:123]
    v_mfma_f32_16x16x32_bf16 v[132:135], a[4:7], v[192:195], v[132:135]
    ds_read_b64_tr_b16 a[30:31], v6 offset:13824
    s_waitcnt lgkmcnt(9)
    v_mfma_f32_16x16x32_bf16 v[144:147], a[8:11], v[192:195], v[144:147]
    ds_read_b64_tr_b16 a[0:1], v3 offset:12416
    v_mfma_f32_16x16x32_bf16 v[156:159], a[12:15], v[192:195], v[156:159]
    buffer_load_dwordx4 v168, s[8:11], s40 offen offset:2048 lds
    v_mfma_f32_16x16x32_bf16 v[152:155], a[12:15], v[188:191], v[152:155]
    ds_read_b64_tr_b16 a[2:3], v3 offset:13952
    v_mfma_f32_16x16x32_bf16 v[140:143], a[8:11], v[188:191], v[140:143]
    ds_read_b64_tr_b16 a[4:5], v4 offset:12416
    v_mfma_f32_16x16x32_bf16 v[136:139], a[8:11], v[184:187], v[136:139]
    v_mfma_f32_16x16x32_bf16 v[148:151], a[12:15], v[184:187], v[148:151]
    ds_read_b64_tr_b16 a[6:7], v4 offset:13952
    s_waitcnt lgkmcnt(7)
    v_mfma_f32_16x16x32_bf16 v[16:19], a[16:19], v[196:199], v[16:19]
    ds_read_b64_tr_b16 a[8:9], v5 offset:12416
    buffer_load_dwordx4 v169, s[8:11], s40 offen offset:3072 lds
    v_mfma_f32_16x16x32_bf16 v[28:31], a[20:23], v[196:199], v[28:31]
    v_mfma_f32_16x16x32_bf16 v[32:35], a[20:23], v[200:203], v[32:35]
    ds_read_b64_tr_b16 a[10:11], v5 offset:13952
    v_mfma_f32_16x16x32_bf16 v[20:23], a[16:19], v[200:203], v[20:23]
    ds_read_b64_tr_b16 a[12:13], v6 offset:12416
    v_mfma_f32_16x16x32_bf16 v[24:27], a[16:19], v[204:207], v[24:27]
    s_add_u32 m0, s36, 28672
    v_mfma_f32_16x16x32_bf16 v[36:39], a[20:23], v[204:207], v[36:39]
    ds_read_b64_tr_b16 a[14:15], v6 offset:13952
    buffer_load_dwordx4 v170, s[8:11], s40 offen offset:0 lds
    s_waitcnt lgkmcnt(8)
    v_mfma_f32_16x16x32_bf16 v[48:51], a[24:27], v[204:207], v[48:51]
    ds_read_b64_tr_b16 a[16:17], v3 offset:12544
    v_mfma_f32_16x16x32_bf16 v[60:63], a[28:31], v[204:207], v[60:63]
    v_mfma_f32_16x16x32_bf16 v[56:59], a[28:31], v[200:203], v[56:59]
    ds_read_b64_tr_b16 a[18:19], v3 offset:14080
    v_mfma_f32_16x16x32_bf16 v[44:47], a[24:27], v[200:203], v[44:47]
    ds_read_b64_tr_b16 a[20:21], v4 offset:12544
    v_mfma_f32_16x16x32_bf16 v[40:43], a[24:27], v[196:199], v[40:43]
    buffer_load_dwordx4 v171, s[8:11], s40 offen offset:1024 lds
    v_mfma_f32_16x16x32_bf16 v[52:55], a[28:31], v[196:199], v[52:55]
    ds_read_b64_tr_b16 a[22:23], v4 offset:14080
    s_add_u32 s40, s40, 128
    s_waitcnt lgkmcnt(8)
    v_mfma_f32_16x16x32_bf16 v[64:67], a[0:3], v[196:199], v[64:67]
    ds_read_b64_tr_b16 a[24:25], v5 offset:12544
    s_cmp_eq_u32 s40, 1280
    s_cselect_b32 s39, 0, s39
    s_cselect_b32 s40, 0, s40
    v_mfma_f32_16x16x32_bf16 v[76:79], a[4:7], v[196:199], v[76:79]
    s_sub_u32 s46, s42, s47
    v_mfma_f32_16x16x32_bf16 v[80:83], a[4:7], v[200:203], v[80:83]
    ds_read_b64_tr_b16 a[26:27], v5 offset:14080
    v_mfma_f32_16x16x32_bf16 v[68:71], a[0:3], v[200:203], v[68:71]
    ds_read_b64_tr_b16 a[28:29], v6 offset:12544
    s_mov_b32 s42, s36
    v_mfma_f32_16x16x32_bf16 v[72:75], a[0:3], v[204:207], v[72:75]
    v_mfma_f32_16x16x32_bf16 v[84:87], a[4:7], v[204:207], v[84:87]
    ds_read_b64_tr_b16 a[30:31], v6 offset:14080
    s_waitcnt lgkmcnt(8)
    v_mfma_f32_16x16x32_bf16 v[96:99], a[8:11], v[204:207], v[96:99]
    s_mov_b32 s36, s47
    v_mfma_f32_16x16x32_bf16 v[108:111], a[12:15], v[204:207], v[108:111]
    s_add_u32 s47, s47, s46
    v_mfma_f32_16x16x32_bf16 v[104:107], a[12:15], v[200:203], v[104:107]
    v_add_u32 v1, s46, v1
    v_add_u32 v2, s46, v2
    v_mfma_f32_16x16x32_bf16 v[92:95], a[8:11], v[200:203], v[92:95]
    v_add_u32 v3, s46, v3
    v_add_u32 v4, s46, v4
    v_mfma_f32_16x16x32_bf16 v[88:91], a[8:11], v[196:199], v[88:91]
    v_add_u32 v5, s46, v5
    v_add_u32 v6, s46, v6
    v_mfma_f32_16x16x32_bf16 v[100:103], a[12:15], v[196:199], v[100:103]
    s_waitcnt vmcnt(12) lgkmcnt(0)
    s_barrier
    v_mfma_f32_16x16x32_bf16 v[112:115], a[16:19], v[196:199], v[112:115]
    ds_read_b128 v[184:187], v1 offset:0
    v_mfma_f32_16x16x32_bf16 v[124:127], a[20:23], v[196:199], v[124:127]
    s_add_u32 m0, s36, 0
    ds_read_b128 v[188:191], v1 offset:2048
    v_mfma_f32_16x16x32_bf16 v[128:131], a[20:23], v[200:203], v[128:131]
    buffer_load_dwordx4 v160, s[20:23], s39 offen offset:0 lds
    ds_read_b128 v[192:195], v1 offset:4096
    v_mfma_f32_16x16x32_bf16 v[116:119], a[16:19], v[200:203], v[116:119]
    ds_read_b64_tr_b16 a[0:1], v3 offset:0
    v_mfma_f32_16x16x32_bf16 v[120:123], a[16:19], v[204:207], v[120:123]
    ds_read_b64_tr_b16 a[2:3], v3 offset:1536
    ds_read_b64_tr_b16 a[4:5], v4 offset:0
    v_mfma_f32_16x16x32_bf16 v[132:135], a[20:23], v[204:207], v[132:135]
    ds_read_b64_tr_b16 a[6:7], v4 offset:1536
    v_mfma_f32_16x16x32_bf16 v[144:147], a[24:27], v[204:207], v[144:147]
    ds_read_b64_tr_b16 a[8:9], v5 offset:0
    ds_read_b64_tr_b16 a[10:11], v5 offset:1536
    v_mfma_f32_16x16x32_bf16 v[156:159], a[28:31], v[204:207], v[156:159]
    ds_read_b64_tr_b16 a[12:13], v6 offset:0
    v_mfma_f32_16x16x32_bf16 v[152:155], a[28:31], v[200:203], v[152:155]
    buffer_load_dwordx4 v161, s[20:23], s39 offen offset:1024 lds
    ds_read_b64_tr_b16 a[14:15], v6 offset:1536
    v_mfma_f32_16x16x32_bf16 v[140:143], a[24:27], v[200:203], v[140:143]
    ds_read_b64_tr_b16 a[16:17], v3 offset:128
    ds_read_b64_tr_b16 a[18:19], v3 offset:1664
    v_mfma_f32_16x16x32_bf16 v[136:139], a[24:27], v[196:199], v[136:139]
    ds_read_b64_tr_b16 a[20:21], v4 offset:128
    v_mfma_f32_16x16x32_bf16 v[148:151], a[28:31], v[196:199], v[148:151]
    ds_read_b64_tr_b16 a[22:23], v4 offset:1664
    s_sub_u32 s41, s41, 1
    s_cmp_lg_u32 s41, 0
    s_cbranch_scc1 L_q_loop
    s_getpc_b64 s[72:73]
L_pc_mid:
    v_lshlrev_b32 v222, 7, v0
    v_min_u32 v222, (L_tail_begin - L_q8 - 4), v222
    s_add_u32 s72, s72, (L_q8 - L_pc_mid)
    s_addc_u32 s73, s73, 0
    v_mov_b32 v223, s73
    v_add_co_u32 v222, vcc, s72, v222
    s_nop 1
    v_addc_co_u32 v223, vcc, 0, v223, vcc
    global_load_dword v222, v[222:223], off
    s_waitcnt lgkmcnt(8)
    v_mfma_f32_16x16x32_bf16 v[16:19], a[0:3], v[184:187], v[16:19]
    ds_read_b64_tr_b16 a[24:25], v5 offset:128
    v_mfma_f32_16x16x32_bf16 v[28:31], a[4:7], v[184:187], v[28:31]
    ds_read_b128 v[196:199], v2 offset:0
    buffer_load_dwordx4 v162, s[20:23], s39 offen offset:2048 lds
    v_mfma_f32_16x16x32_bf16 v[32:35], a[4:7], v[188:191], v[32:35]
    ds_read_b64_tr_b16 a[26:27], v5 offset:1664
    v_mfma_f32_16x16x32_bf16 v[20:23], a[0:3], v[188:191], v[20:23]
    ds_read_b64_tr_b16 a[28:29], v6 offset:128
    v_mfma_f32_16x16x32_bf16 v[24:27], a[0:3], v[192:195], v[24:27]
    v_mfma_f32_16x16x32_bf16 v[36:39], a[4:7], v[192:195], v[36:39]
    ds_read_b64_tr_b16 a[30:31], v6 offset:1664
    s_waitcnt lgkmcnt(9)
    v_mfma_f32_16x16x32_bf16 v[48:51], a[8:11], v[192:195], v[48:51]
    ds_read_b64_tr_b16 a[0:1], v3 offset:256
    buffer_load_dwordx4 v163, s[20:23], s39 offen offset:3072 lds
    v_mfma_f32_16x16x32_bf16 v[60:63], a[12:15], v[192:195], v[60:63]
    v_mfma_f32_16x16x32_bf16 v[56:59], a[12:15], v[188:191], v[56:59]
    ds_read_b64_tr_b16 a[2:3], v3 offset:1792
    v_mfma_f32_16x16x32_bf16 v[44:47], a[8:11], v[188:191], v[44:47]
    ds_read_b64_tr_b16 a[4:5], v4 offset:256
    v_mfma_f32_16x16x32_bf16 v[40:43], a[8:11], v[184:187], v[40:43]
    s_add_u32 m0, s36, 4096
    v_mfma_f32_16x16x32_bf16 v[52:55], a[12:15], v[184:187], v[52:55]
    ds_read_b64_tr_b16 a[6:7], v4 offset:1792
    buffer_load_dwordx4 v164, s[20:23], s39 offen offset:0 lds
    s_waitcnt lgkmcnt(9)
    v_mfma_f32_16x16x32_bf16 v[64:67], a[16:19], v[184:187], v[64:67]
    ds_read_b64_tr_b16 a[8:9], v5 offset:256
    v_mfma_f32_16x16x32_bf16 v[76:79], a[20:23], v[184:187], v[76:79]
    ds_read_b128 v[200:203], v2 offset:2048
    v_mfma_f32_16x16x32_bf16 v[80:83], a[20:23], v[188:191], v[80:83]
    ds_read_b64_tr_b16 a[10:11], v5 offset:1792
    v_mfma_f32_16x16x32_bf16 v[68:71], a[16:19], v[188:191], v[68:71]
    ds_read_b64_tr_b16 a[12:13], v6 offset:256
    v_mfma_f32_16x16x32_bf16 v[72:75], a[16:19], v[192:195], v[72:75]
    buffer_load_dwordx4 v165, s[20:23], s39 offen offset:1024 lds
    v_mfma_f32_16x16x32_bf16 v[84:87], a[20:23], v[192:195], v[84:87]
    ds_read_b64_tr_b16 a[14:15], v6 offset:1792
    s_waitcnt lgkmcnt(9)
    v_mfma_f32_16x16x32_bf16 v[96:99], a[24:27], v[192:195], v[96:99]
    ds_read_b64_tr_b16 a[16:17], v3 offset:12288
    v_mfma_f32_16x16x32_bf16 v[108:111], a[28:31], v[192:195], v[108:111]
    s_add_u32 s39, s39, 786432
    v_mfma_f32_16x16x32_bf16 v[104:107], a[28:31], v[188:191], v[104:107]
    ds_read_b64_tr_b16 a[18:19], v3 offset:13824
    s_add_u32 m0, s36, 24576
    v_mfma_f32_16x16x32_bf16 v[92:95], a[24:27], v[188:191], v[92:95]
    ds_read_b64_tr_b16 a[20:21], v4 offset:12288
    buffer_load_dwordx4 v166, s[8:11], s40 offen offset:0 lds
    v_mfma_f32_16x16x32_bf16 v[88:91], a[24:27], v[184:187], v[88:91]
    v_mfma_f32_16x16x32_bf16 v[100:103], a[28:31], v[184:187], v[100:103]
    ds_read_b64_tr_b16 a[22:23], v4 offset:13824
    s_waitcnt lgkmcnt(9)
    v_mfma_f32_16x16x32_bf16 v[112:115], a[0:3], v[184:187], v[112:115]
    ds_read_b64_tr_b16 a[24:25], v5 offset:12288
    v_mfma_f32_16x16x32_bf16 v[124:127], a[4:7], v[184:187], v[124:127]
    ds_read_b128 v[204:207], v2 offset:4096
    v_mfma_f32_16x16x32_bf16 v[128:131], a[4:7], v[188:191], v[128:131]
    ds_read_b64_tr_b16 a[26:27], v5 offset:13824
    buffer_load_dwordx4 v167, s[8:11], s40 offen offset:1024 lds
    v_mfma_f32_16x16x32_bf16 v[116:119], a[0:3], v[188:191], v[116:119]
    ds_read_b64_tr_b16 a[28:29], v6 offset:12288
    v_mfma_f32_16x16x32_bf16 v[120:123], a[0:3], v[192:195], v[120:123]
    v_mfma_f32_16x16x32_bf16 v[132:135], a[4:7], v[192:195], v[132:135]
    ds_read_b64_tr_b16 a[30:31], v6 offset:13824
    s_waitcnt lgkmcnt(9)
    v_mfma_f32_16x16x32_bf16 v[144:147], a[8:11], v[192:195], v[144:147]
    ds_read_b64_tr_b16 a[0:1], v3 offset:12416
    v_mfma_f32_16x16x32_bf16 v[156:159], a[12:15], v[192:195], v[156:159]
    buffer_load_dwordx4 v168, s[8:11], s40 offen offset:2048 lds
    v_mfma_f32_16x16x32_bf16 v[152:155], a[12:15], v[188:191], v[152:155]
    ds_read_b64_tr_b16 a[2:3], v3 offset:13952
    v_mfma_f32_16x16x32_bf16 v[140:143], a[8:11], v[188:191], v[140:143]
    ds_read_b64_tr_b16 a[4:5], v4 offset:12416
    v_mfma_f32_16x16x32_bf16 v[136:139], a[8:11], v[184:187], v[136:139]
    v_mfma_f32_16x16x32_bf16 v[148:151], a[12:15], v[184:187], v[148:151]
    ds_read_b64_tr_b16 a[6:7], v4 offset:13952
    s_waitcnt lgkmcnt(7)
    v_mfma_f32_16x16x32_bf16 v[16:19], a[16:19], v[196:199], v[16:19]
    ds_read_b64_tr_b16 a[8:9], v5 offset:12416
    buffer_load_dwordx4 v169, s[8:11], s40 offen offset:3072 lds
    v_mfma_f32_16x16x32_bf16 v[28:31], a[20:23], v[196:199], v[28:31]
    v_mfma_f32_16x16x32_bf16 v[32:35], a[20:23], v[200:203], v[32:35]
    ds_read_b64_tr_b16 a[10:11], v5 offset:13952
    v_mfma_f32_16x16x32_bf16 v[20:23], a[16:19], v[200:203], v[20:23]
    ds_read_b64_tr_b16 a[12:13], v6 offset:12416
    v_mfma_f32_16x16x32_bf16 v[24:27], a[16:19], v[204:207], v[24:27]
    s_add_u32 m0, s36, 28672
    v_mfma_f32_16x16x32_bf16 v[36:39], a[20:23], v[204:207], v[36:39]
    ds_read_b64_tr_b16 a[14:15], v6 offset:13952
    buffer_load_dwordx4 v170, s[8:11], s40 offen offset:0 lds
    s_waitcnt lgkmcnt(8)
    v_mfma_f32_16x16x32_bf16 v[48:51], a[24:27], v[204:207], v[48:51]
    ds_read_b64_tr_b16 a[16:17], v3 offset:12544
    v_mfma_f32_16x16x32_bf16 v[60:63], a[28:31], v[204:207], v[60:63]
    v_mfma_f32_16x16x32_bf16 v[56:59], a[28:31], v[200:203], v[56:59]
    ds_read_b64_tr_b16 a[18:19], v3 offset:14080
    v_mfma_f32_16x16x32_bf16 v[44:47], a[24:27], v[200:203], v[44:47]
    ds_read_b64_tr_b16 a[20:21], v4 offset:12544
    v_mfma_f32_16x16x32_bf16 v[40:43], a[24:27], v[196:199], v[40:43]
    buffer_load_dwordx4 v171, s[8:11], s40 offen offset:1024 lds
    v_mfma_f32_16x16x32_bf16 v[52:55], a[28:31], v[196:199], v[52:55]
    ds_read_b64_tr_b16 a[22:23], v4 offset:14080
    s_add_u32 s40, s40, 128
    s_waitcnt lgkmcnt(8)
    v_mfma_f32_16x16x32_bf16 v[64:67], a[0:3], v[196:199], v[64:67]
    ds_read_b64_tr_b16 a[24:25], v5 offset:12544
    s_cmp_eq_u32 s40, 1280
    s_cselect_b32 s39, 0, s39
    s_cselect_b32 s40, 0, s40
    v_mfma_f32_16x16x32_bf16 v[76:79], a[4:7], v[196:199], v[76:79]
    s_sub_u32 s46, s42, s47
    v_mfma_f32_16x16x32_bf16 v[80:83], a[4:7], v[200:203], v[80:83]
    ds_read_b64_tr_b16 a[26:27], v5 offset:14080
    v_mfma_f32_16x16x32_bf16 v[68:71], a[0:3], v[200:203], v[68:71]
    ds_read_b64_tr_b16 a[28:29], v6 offset:12544
    s_mov_b32 s42, s36
    v_mfma_f32_16x16x32_bf16 v[72:75], a[0:3], v[204:207], v[72:75]
    v_mfma_f32_16x16x32_bf16 v[84:87], a[4:7], v[204:207], v[84:87]
    ds_read_b64_tr_b16 a[30:31], v6 offset:14080
    s_waitcnt lgkmcnt(8)
    v_mfma_f32_16x16x32_bf16 v[96:99], a[8:11], v[204:207], v[96:99]
    s_mov_b32 s36, s47
    v_mfma_f32_16x16x32_bf16 v[108:111], a[12:15], v[204:207], v[108:111]
    s_add_u32 s47, s47, s46
    v_mfma_f32_16x16x32_bf16 v[104:107], a[12:15], v[200:203], v[104:107]
    v_add_u32 v1, s46, v1
    v_add_u32 v2, s46, v2
    v_mfma_f32_16x16x32_bf16 v[92:95], a[8:11], v[200:203], v[92:95]
    v_add_u32 v3, s46, v3
    v_add_u32 v4, s46, v4
    v_mfma_f32_16x16x32_bf16 v[88:91], a[8:11], v[196:199], v[88:91]
    v_add_u32 v5, s46, v5
    v_add_u32 v6, s46, v6
    v_mfma_f32_16x16x32_bf16 v[100:103], a[12:15], v[196:199], v[100:103]
    s_waitcnt vmcnt(12) lgkmcnt(0)
    s_barrier
    v_mfma_f32_16x16x32_bf16 v[112:115], a[16:19], v[196:199], v[112:115]
    ds_read_b128 v[184:187], v1 offset:0
    v_mfma_f32_16x16x32_bf16 v[124:127], a[20:23], v[196:199], v[124:127]
    s_add_u32 m0, s36, 0
    ds_read_b128 v[188:191], v1 offset:2048
    v_mfma_f32_16x16x32_bf16 v[128:131], a[20:23], v[200:203], v[128:131]
    buffer_load_dwordx4 v244, s[12:15], s38 offen offset:0 nt lds
    ds_read_b128 v[192:195], v1 offset:4096
    v_mfma_f32_16x16x32_bf16 v[116:119], a[16:19], v[200:203], v[116:119]
    ds_read_b64_tr_b16 a[0:1], v3 offset:0
    v_mfma_f32_16x16x32_bf16 v[120:123], a[16:19], v[204:207], v[120:123]
    ds_read_b64_tr_b16 a[2:3], v3 offset:1536
    ds_read_b64_tr_b16 a[4:5], v4 offset:0
    v_mfma_f32_16x16x32_bf16 v[132:135], a[20:23], v[204:207], v[132:135]
    ds_read_b64_tr_b16 a[6:7], v4 offset:1536
    v_mfma_f32_16x16x32_bf16 v[144:147], a[24:27], v[204:207], v[144:147]
    ds_read_b64_tr_b16 a[8:9], v5 offset:0
    ds_read_b64_tr_b16 a[10:11], v5 offset:1536
    v_mfma_f32_16x16x32_bf16 v[156:159], a[28:31], v[204:207], v[156:159]
    ds_read_b64_tr_b16 a[12:13], v6 offset:0
    v_mfma_f32_16x16x32_bf16 v[152:155], a[28:31], v[200:203], v[152:155]
    buffer_load_dwordx4 v245, s[12:15], s38 offen offset:1024 nt lds
    ds_read_b64_tr_b16 a[14:15], v6 offset:1536
    v_mfma_f32_16x16x32_bf16 v[140:143], a[24:27], v[200:203], v[140:143]
    ds_read_b64_tr_b16 a[16:17], v3 offset:128
    ds_read_b64_tr_b16 a[18:19], v3 offset:1664
    v_mfma_f32_16x16x32_bf16 v[136:139], a[24:27], v[196:199], v[136:139]
    ds_read_b64_tr_b16 a[20:21], v4 offset:128
    v_mfma_f32_16x16x32_bf16 v[148:151], a[28:31], v[196:199], v[148:151]
    ds_read_b64_tr_b16 a[22:23], v4 offset:1664
L_q8:
    s_waitcnt lgkmcnt(8)
    v_mfma_f32_16x16x32_bf16 v[16:19], a[0:3], v[184:187], v[16:19]
    ds_read_b64_tr_b16 a[24:25], v5 offset:128
    v_mfma_f32_16x16x32_bf16 v[28:31], a[4:7], v[184:187], v[28:31]
    ds_read_b128 v[196:199], v2 offset:0
    buffer_load_dwordx4 v246, s[12:15], s38 offen offset:2048 nt lds
    v_mfma_f32_16x16x32_bf16 v[32:35], a[4:7], v[188:191], v[32:35]
    ds_read_b64_tr_b16 a[26:27], v5 offset:1664
    v_mfma_f32_16x16x32_bf16 v[20:23], a[0:3], v[188:191], v[20:23]
    ds_read_b64_tr_b16 a[28:29], v6 offset:128
    v_mfma_f32_16x16x32_bf16 v[24:27], a[0:3], v[192:195], v[24:27]
    v_mfma_f32_16x16x32_bf16 v[36:39], a[4:7], v[192:195], v[36:39]
    ds_read_b64_tr_b16 a[30:31], v6 offset:1664
    s_waitcnt lgkmcnt(9)
    v_mfma_f32_16x16x32_bf16 v[48:51], a[8:11], v[192:195], v[48:51]
    ds_read_b64_tr_b16 a[0:1], v3 offset:256
    buffer_load_dwordx4 v247, s[12:15], s38 offen offset:3072 nt lds
    v_mfma_f32_16x16x32_bf16 v[60:63], a[12:15], v[192:195], v[60:63]
    v_mfma_f32_16x16x32_bf16 v[56:59], a[12:15], v[188:191], v[56:59]
    ds_read_b64_tr_b16 a[2:3], v3 offset:1792
    v_mfma_f32_16x16x32_bf16 v[44:47], a[8:11], v[188:191], v[44:47]
    ds_read_b64_tr_b16 a[4:5], v4 offset:256
    v_mfma_f32_16x16x32_bf16 v[40:43], a[8:11], v[184:187], v[40:43]
    s_add_u32 m0, s36, 4096
    v_mfma_f32_16x16x32_bf16 v[52:55], a[12:15], v[184:187], v[52:55]
    ds_read_b64_tr_b16 a[6:7], v4 offset:1792
    buffer_load_dwordx4 v248, s[12:15], s38 offen offset:0 nt lds
    s_waitcnt lgkmcnt(9)
    v_mfma_f32_16x16x32_bf16 v[64:67], a[16:19], v[184:187], v[64:67]
    ds_read_b64_tr_b16 a[8:9], v5 offset:256
    v_mfma_f32_16x16x32_bf16 v[76:79], a[20:23], v[184:187], v[76:79]
    ds_read_b128 v[200:203], v2 offset:2048
    v_mfma_f32_16x16x32_bf16 v[80:83], a[20:23], v[188:191], v[80:83]
    ds_read_b64_tr_b16 a[10:11], v5 offset:1792
    v_mfma_f32_16x16x32_bf16 v[68:71], a[16:19], v[188:191], v[68:71]
    ds_read_b64_tr_b16 a[12:13], v6 offset:256
    v_mfma_f32_16x16x32_bf16 v[72:75], a[16:19], v[192:195], v[72:75]
    buffer_load_dwordx4 v249, s[12:15], s38 offen offset:1024 nt lds
    v_mfma_f32_16x16x32_bf16 v[84:87], a[20:23], v[192:195], v[84:87]
    ds_read_b64_tr_b16 a[14:15], v6 offset:1792
    s_waitcnt lgkmcnt(9)
    v_mfma_f32_16x16x32_bf16 v[96:99], a[24:27], v[192:195], v[96:99]
    ds_read_b64_tr_b16 a[16:17], v3 offset:12288
    v_mfma_f32_16x16x32_bf16 v[108:111], a[28:31], v[192:195], v[108:111]
    s_add_u32 s38, s38, 12288
    v_mfma_f32_16x16x32_bf16 v[104:107], a[28:31], v[188:191], v[104:107]
    ds_read_b64_tr_b16 a[18:19], v3 offset:13824
    s_add_u32 m0, s36, 24576
    v_mfma_f32_16x16x32_bf16 v[92:95], a[24:27], v[188:191], v[92:95]
    ds_read_b64_tr_b16 a[20:21], v4 offset:12288
    buffer_load_dwordx4 v244, s[12:15], s38 offen offset:0 nt lds
    v_mfma_f32_16x16x32_bf16 v[88:91], a[24:27], v[184:187], v[88:91]
    v_mfma_f32_16x16x32_bf16 v[100:103], a[28:31], v[184:187], v[100:103]
    ds_read_b64_tr_b16 a[22:23], v4 offset:13824
    s_waitcnt lgkmcnt(9)
    v_mfma_f32_16x16x32_bf16 v[112:115], a[0:3], v[184:187], v[112:115]
    ds_read_b64_tr_b16 a[24:25], v5 offset:12288
    v_mfma_f32_16x16x32_bf16 v[124:127], a[4:7], v[184:187], v[124:127]
    ds_read_b128 v[204:207], v2 offset:4096
    v_mfma_f32_16x16x32_bf16 v[128:131], a[4:7], v[188:191], v[128:131]
    ds_read_b64_tr_b16 a[26:27], v5 offset:13824
    buffer_load_dwordx4 v245, s[12:15], s38 offen offset:1024 nt lds
    v_mfma_f32_16x16x32_bf16 v[116:119], a[0:3], v[188:191], v[116:119]
    ds_read_b64_tr_b16 a[28:29], v6 offset:12288
    v_mfma_f32_16x16x32_bf16 v[120:123], a[0:3], v[192:195], v[120:123]
    v_mfma_f32_16x16x32_bf16 v[132:135], a[4:7], v[192:195], v[132:135]
    ds_read_b64_tr_b16 a[30:31], v6 offset:13824
    s_waitcnt lgkmcnt(9)
    v_mfma_f32_16x16x32_bf16 v[144:147], a[8:11], v[192:195], v[144:147]
    ds_read_b64_tr_b16 a[0:1], v3 offset:12416
    v_mfma_f32_16x16x32_bf16 v[156:159], a[12:15], v[192:195], v[156:159]
    buffer_load_dwordx4 v246, s[12:15], s38 offen offset:2048 nt lds
    v_mfma_f32_16x16x32_bf16 v[152:155], a[12:15], v[188:191], v[152:155]
    ds_read_b64_tr_b16 a[2:3], v3 offset:13952
    v_mfma_f32_16x16x32_bf16 v[140:143], a[8:11], v[188:191], v[140:143]
    ds_read_b64_tr_b16 a[4:5], v4 offset:12416
    v_mfma_f32_16x16x32_bf16 v[136:139], a[8:11], v[184:187], v[136:139]
    v_mfma_f32_16x16x32_bf16 v[148:151], a[12:15], v[184:187], v[148:151]
    ds_read_b64_tr_b16 a[6:7], v4 offset:13952
    s_waitcnt lgkmcnt(7)
    v_mfma_f32_16x16x32_bf16 v[16:19], a[16:19], v[196:199], v[16:19]
    ds_read_b64_tr_b16 a[8:9], v5 offset:12416
    buffer_load_dwordx4 v247, s[12:15], s38 offen offset:3072 nt lds
    v_mfma_f32_16x16x32_bf16 v[28:31], a[20:23], v[196:199], v[28:31]
    v_mfma_f32_16x16x32_bf16 v[32:35], a[20:23], v[200:203], v[32:35]
    ds_read_b64_tr_b16 a[10:11], v5 offset:13952
    v_mfma_f32_16x16x32_bf16 v[20:23], a[16:19], v[200:203], v[20:23]
    ds_read_b64_tr_b16 a[12:13], v6 offset:12416
    v_mfma_f32_16x16x32_bf16 v[24:27], a[16:19], v[204:207], v[24:27]
    s_add_u32 m0, s36, 28672
    v_mfma_f32_16x16x32_bf16 v[36:39], a[20:23], v[204:207], v[36:39]
    ds_read_b64_tr_b16 a[14:15], v6 offset:13952
    buffer_load_dwordx4 v248, s[12:15], s38 offen offset:0 nt lds
    s_waitcnt lgkmcnt(8)
    v_mfma_f32_16x16x32_bf16 v[48:51], a[24:27], v[204:207], v[48:51]
    ds_read_b64_tr_b16 a[16:17], v3 offset:12544
    v_mfma_f32_16x16x32_bf16 v[60:63], a[28:31], v[204:207], v[60:63]
    v_mfma_f32_16x16x32_bf16 v[56:59], a[28:31], v[200:203], v[56:59]
    ds_read_b64_tr_b16 a[18:19], v3 offset:14080
    v_mfma_f32_16x16x32_bf16 v[44:47], a[24:27], v[200:203], v[44:47]
    ds_read_b64_tr_b16 a[20:21], v4 offset:12544
    v_mfma_f32_16x16x32_bf16 v[40:43], a[24:27], v[196:199], v[40:43]
    buffer_load_dwordx4 v249, s[12:15], s38 offen offset:1024 nt lds
    v_mfma_f32_16x16x32_bf16 v[52:55], a[28:31], v[196:199], v[52:55]
    ds_read_b64_tr_b16 a[22:23], v4 offset:14080
    s_add_u32 s38, s38, 12288
    s_waitcnt lgkmcnt(8)
    v_mfma_f32_16x16x32_bf16 v[64:67], a[0:3], v[196:199], v[64:67]
    ds_read_b64_tr_b16 a[24:25], v5 offset:12544
    v_mfma_f32_16x16x32_bf16 v[76:79], a[4:7], v[196:199], v[76:79]
    s_sub_u32 s46, s42, s47
    v_mfma_f32_16x16x32_bf16 v[80:83], a[4:7], v[200:203], v[80:83]
    ds_read_b64_tr_b16 a[26:27], v5 offset:14080
    v_mfma_f32_16x16x32_bf16 v[68:71], a[0:3], v[200:203], v[68:71]
    ds_read_b64_tr_b16 a[28:29], v6 offset:12544
    s_mov_b32 s42, s36
    v_mfma_f32_16x16x32_bf16 v[72:75], a[0:3], v[204:207], v[72:75]
    s_mov_b32 s36, s47
    v_mfma_f32_16x16x32_bf16 v[84:87], a[4:7], v[204:207], v[84:87]
    ds_read_b64_tr_b16 a[30:31], v6 offset:14080
    s_waitcnt lgkmcnt(8)
    v_mfma_f32_16x16x32_bf16 v[96:99], a[8:11], v[204:207], v[96:99]
    v_mfma_f32_16x16x32_bf16 v[108:111], a[12:15], v[204:207], v[108:111]
    s_add_u32 s47, s47, s46
    v_mfma_f32_16x16x32_bf16 v[104:107], a[12:15], v[200:203], v[104:107]
    v_add_u32 v1, s46, v1
    v_add_u32 v2, s46, v2
    v_mfma_f32_16x16x32_bf16 v[92:95], a[8:11], v[200:203], v[92:95]
    v_add_u32 v3, s46, v3
    v_add_u32 v4, s46, v4
    v_mfma_f32_16x16x32_bf16 v[88:91], a[8:11], v[196:199], v[88:91]
    v_add_u32 v5, s46, v5
    v_add_u32 v6, s46, v6
    v_mfma_f32_16x16x32_bf16 v[100:103], a[12:15], v[196:199], v[100:103]
    s_waitcnt vmcnt(12) lgkmcnt(0)
    s_barrier
    v_mfma_f32_16x16x32_bf16 v[112:115], a[16:19], v[196:199], v[112:115]
    ds_read_b128 v[184:187], v1 offset:0
    ds_read_b128 v[188:191], v1 offset:2048
    v_mfma_f32_16x16x32_bf16 v[124:127], a[20:23], v[196:199], v[124:127]
    ds_read_b128 v[192:195], v1 offset:4096
    v_mfma_f32_16x16x32_bf16 v[128:131], a[20:23], v[200:203], v[128:131]
    ds_read_b64_tr_b16 a[0:1], v3 offset:0
    ds_read_b64_tr_b16 a[2:3], v3 offset:1536
    v_mfma_f32_16x16x32_bf16 v[116:119], a[16:19], v[200:203], v[116:119]
    ds_read_b64_tr_b16 a[4:5], v4 offset:0
    v_mfma_f32_16x16x32_bf16 v[120:123], a[16:19], v[204:207], v[120:123]
    ds_read_b64_tr_b16 a[6:7], v4 offset:1536
    ds_read_b128 v[208:211], v2 offset:0
    v_mfma_f32_16x16x32_bf16 v[132:135], a[20:23], v[204:207], v[132:135]
    ds_read_b128 v[212:215], v2 offset:2048
    v_mfma_f32_16x16x32_bf16 v[144:147], a[24:27], v[204:207], v[144:147]
    ds_read_b128 v[216:219], v2 offset:4096
    ds_read_b64_tr_b16 a[8:9], v3 offset:12288
    v_mfma_f32_16x16x32_bf16 v[156:159], a[28:31], v[204:207], v[156:159]
    ds_read_b64_tr_b16 a[10:11], v3 offset:13824
    ds_read_b64_tr_b16 a[12:13], v4 offset:12288
    v_mfma_f32_16x16x32_bf16 v[152:155], a[28:31], v[200:203], v[152:155]
    ds_read_b64_tr_b16 a[14:15], v4 offset:13824
    v_mfma_f32_16x16x32_bf16 v[140:143], a[24:27], v[200:203], v[140:143]
    ds_read_b64_tr_b16 a[16:17], v5 offset:0
    s_waitcnt lgkmcnt(14)
    ds_read_b64_tr_b16 a[18:19], v5 offset:1536
    v_mfma_f32_16x16x32_bf16 v[136:139], a[24:27], v[196:199], v[136:139]
    s_waitcnt lgkmcnt(14)
    ds_read_b64_tr_b16 a[20:21], v6 offset:0
    v_mfma_f32_16x16x32_bf16 v[148:151], a[28:31], v[196:199], v[148:151]
    s_waitcnt lgkmcnt(14)
    ds_read_b64_tr_b16 a[22:23], v6 offset:1536
    s_waitcnt lgkmcnt(11)
    v_mfma_f32_16x16x32_bf16 v[16:19], a[0:3], v[184:187], v[16:19]
    ds_read_b64_tr_b16 a[24:25], v5 offset:12288
    v_mfma_f32_16x16x32_bf16 v[28:31], a[4:7], v[184:187], v[28:31]
    v_mfma_f32_16x16x32_bf16 v[32:35], a[4:7], v[188:191], v[32:35]
    ds_read_b64_tr_b16 a[26:27], v5 offset:13824
    v_mfma_f32_16x16x32_bf16 v[20:23], a[0:3], v[188:191], v[20:23]
    ds_read_b64_tr_b16 a[28:29], v6 offset:12288
    v_mfma_f32_16x16x32_bf16 v[24:27], a[0:3], v[192:195], v[24:27]
    v_mfma_f32_16x16x32_bf16 v[36:39], a[4:7], v[192:195], v[36:39]
    ds_read_b64_tr_b16 a[30:31], v6 offset:13824
    s_waitcnt lgkmcnt(8)
    v_mfma_f32_16x16x32_bf16 v[24:27], a[8:11], v[216:219], v[24:27]
    ds_read_b64_tr_b16 a[0:1], v3 offset:128
    v_mfma_f32_16x16x32_bf16 v[36:39], a[12:15], v[216:219], v[36:39]
    v_mfma_f32_16x16x32_bf16 v[32:35], a[12:15], v[212:215], v[32:35]
    ds_read_b64_tr_b16 a[2:3], v3 offset:1664
    v_mfma_f32_16x16x32_bf16 v[20:23], a[8:11], v[212:215], v[20:23]
    ds_read_b64_tr_b16 a[4:5], v4 offset:128
    v_mfma_f32_16x16x32_bf16 v[16:19], a[8:11], v[208:211], v[16:19]
    v_mfma_f32_16x16x32_bf16 v[28:31], a[12:15], v[208:211], v[28:31]
    ds_read_b64_tr_b16 a[6:7], v4 offset:1664
    s_waitcnt lgkmcnt(8)
    v_mfma_f32_16x16x32_bf16 v[40:43], a[16:19], v[184:187], v[40:43]
    ds_read_b64_tr_b16 a[8:9], v3 offset:12416
    v_mfma_f32_16x16x32_bf16 v[52:55], a[20:23], v[184:187], v[52:55]
    v_mfma_f32_16x16x32_bf16 v[56:59], a[20:23], v[188:191], v[56:59]
    ds_read_b64_tr_b16 a[10:11], v3 offset:13952
    v_mfma_f32_16x16x32_bf16 v[44:47], a[16:19], v[188:191], v[44:47]
    ds_read_b64_tr_b16 a[12:13], v4 offset:12416
    v_mfma_f32_16x16x32_bf16 v[48:51], a[16:19], v[192:195], v[48:51]
    v_mul_f32 v16, s44, v16
    v_mul_f32 v17, s44, v17
    v_mul_f32 v18, s44, v18
    v_mfma_f32_16x16x32_bf16 v[60:63], a[20:23], v[192:195], v[60:63]
    ds_read_b64_tr_b16 a[14:15], v4 offset:13952
    v_mul_f32 v19, s44, v19
    s_waitcnt lgkmcnt(8)
    v_mfma_f32_16x16x32_bf16 v[48:51], a[24:27], v[216:219], v[48:51]
    ds_read_b64_tr_b16 a[16:17], v5 offset:128
    v_mul_f32 v28, s44, v28
    v_mul_f32 v29, s44, v29
    v_mul_f32 v30, s44, v30
    v_mfma_f32_16x16x32_bf16 v[60:63], a[28:31], v[216:219], v[60:63]
    v_mul_f32 v31, s44, v31
    v_mul_f32 v20, s44, v20
    v_mul_f32 v21, s44, v21
    v_mfma_f32_16x16x32_bf16 v[56:59], a[28:31], v[212:215], v[56:59]
    ds_read_b64_tr_b16 a[18:19], v5 offset:1664
    v_mul_f32 v22, s44, v22
    v_mul_f32 v23, s44, v23
    v_mul_f32 v32, s44, v32
    v_mfma_f32_16x16x32_bf16 v[44:47], a[24:27], v[212:215], v[44:47]
    ds_read_b64_tr_b16 a[20:21], v6 offset:128
    v_mul_f32 v33, s44, v33
    v_mul_f32 v34, s44, v34
    v_mul_f32 v35, s44, v35
    v_mfma_f32_16x16x32_bf16 v[40:43], a[24:27], v[208:211], v[40:43]
    v_mul_f32 v24, s44, v24
    v_mul_f32 v25, s44, v25
    v_mul_f32 v26, s44, v26
    v_mul_f32 v27, s44, v27
    v_mfma_f32_16x16x32_bf16 v[52:55], a[28:31], v[208:211], v[52:55]
    ds_read_b64_tr_b16 a[22:23], v6 offset:1664
    v_mul_f32 v36, s44, v36
    v_mul_f32 v37, s44, v37
    s_waitcnt lgkmcnt(8)
    v_mfma_f32_16x16x32_bf16 v[64:67], a[0:3], v[184:187], v[64:67]
    ds_read_b64_tr_b16 a[24:25], v5 offset:12416
    v_mul_f32 v38, s44, v38
    v_mul_f32 v39, s44, v39
    v_cvt_pk_bf16_f32 v16, v16, v17
    v_mfma_f32_16x16x32_bf16 v[76:79], a[4:7], v[184:187], v[76:79]
    v_cvt_pk_bf16_f32 v17, v18, v19
    v_cvt_pk_bf16_f32 v18, v28, v29
    v_cvt_pk_bf16_f32 v19, v30, v31
    v_cvt_pk_bf16_f32 v20, v20, v21
    v_mfma_f32_16x16x32_bf16 v[80:83], a[4:7], v[188:191], v[80:83]
    ds_read_b64_tr_b16 a[26:27], v5 offset:13952
    v_cvt_pk_bf16_f32 v21, v22, v23
    v_cvt_pk_bf16_f32 v22, v32, v33
    v_mfma_f32_16x16x32_bf16 v[68:71], a[0:3], v[188:191], v[68:71]
    ds_read_b64_tr_b16 a[28:29], v6 offset:12416
    v_cvt_pk_bf16_f32 v23, v34, v35
    v_cvt_pk_bf16_f32 v24, v24, v25
    v_cvt_pk_bf16_f32 v25, v26, v27
    v_mfma_f32_16x16x32_bf16 v[72:75], a[0:3], v[192:195], v[72:75]
    v_cvt_pk_bf16_f32 v26, v36, v37
    v_cvt_pk_bf16_f32 v27, v38, v39
    v_permlane16_swap_b32 v16, v18
    v_permlane16_swap_b32 v17, v19
    v_permlane16_swap_b32 v20, v22
    v_mfma_f32_16x16x32_bf16 v[84:87], a[4:7], v[192:195], v[84:87]
    ds_read_b64_tr_b16 a[30:31], v6 offset:13952
    v_permlane16_swap_b32 v21, v23
    v_permlane16_swap_b32 v24, v26
    v_permlane16_swap_b32 v25, v27
    s_waitcnt lgkmcnt(8)
    v_mfma_f32_16x16x32_bf16 v[72:75], a[8:11], v[216:219], v[72:75]
    ds_read_b64_tr_b16 a[0:1], v3 offset:256
    v_mul_f32 v40, s44, v40
    v_mul_f32 v41, s44, v41
    v_mfma_f32_16x16x32_bf16 v[84:87], a[12:15], v[216:219], v[84:87]
    v_mul_f32 v42, s44, v42
    v_mul_f32 v43, s44, v43
    v_mul_f32 v52, s44, v52
    v_mfma_f32_16x16x32_bf16 v[80:83], a[12:15], v[212:215], v[80:83]
    ds_read_b64_tr_b16 a[2:3], v3 offset:1792
    v_mul_f32 v53, s44, v53
    v_mul_f32 v54, s44, v54
    v_mfma_f32_16x16x32_bf16 v[68:71], a[8:11], v[212:215], v[68:71]
    ds_read_b64_tr_b16 a[4:5], v4 offset:256
    v_mul_f32 v55, s44, v55
    v_mul_f32 v44, s44, v44
    v_mul_f32 v45, s44, v45
    v_mfma_f32_16x16x32_bf16 v[64:67], a[8:11], v[208:211], v[64:67]
    v_mul_f32 v46, s44, v46
    v_mul_f32 v47, s44, v47
    v_mul_f32 v56, s44, v56
    v_mul_f32 v57, s44, v57
    v_mfma_f32_16x16x32_bf16 v[76:79], a[12:15], v[208:211], v[76:79]
    ds_read_b64_tr_b16 a[6:7], v4 offset:1792
    v_mul_f32 v58, s44, v58
    v_mul_f32 v59, s44, v59
    s_waitcnt lgkmcnt(8)
    v_mfma_f32_16x16x32_bf16 v[88:91], a[16:19], v[184:187], v[88:91]
    ds_read_b64_tr_b16 a[8:9], v3 offset:12544
    v_mul_f32 v48, s44, v48
    v_mul_f32 v49, s44, v49
    v_mfma_f32_16x16x32_bf16 v[100:103], a[20:23], v[184:187], v[100:103]
    v_mul_f32 v50, s44, v50
    v_mul_f32 v51, s44, v51
    v_mul_f32 v60, s44, v60
    v_mul_f32 v61, s44, v61
    v_mfma_f32_16x16x32_bf16 v[104:107], a[20:23], v[188:191], v[104:107]
    ds_read_b64_tr_b16 a[10:11], v3 offset:14080
    v_mul_f32 v62, s44, v62
    v_mul_f32 v63, s44, v63
    v_cvt_pk_bf16_f32 v40, v40, v41
    v_mfma_f32_16x16x32_bf16 v[92:95], a[16:19], v[188:191], v[92:95]
    ds_read_b64_tr_b16 a[12:13], v4 offset:12544
    v_cvt_pk_bf16_f32 v41, v42, v43
    v_cvt_pk_bf16_f32 v42, v52, v53
    v_cvt_pk_bf16_f32 v43, v54, v55
    v_mfma_f32_16x16x32_bf16 v[96:99], a[16:19], v[192:195], v[96:99]
    v_cvt_pk_bf16_f32 v44, v44, v45
    v_cvt_pk_bf16_f32 v45, v46, v47
    v_cvt_pk_bf16_f32 v46, v56, v57
    v_cvt_pk_bf16_f32 v47, v58, v59
    v_mfma_f32_16x16x32_bf16 v[108:111], a[20:23], v[192:195], v[108:111]
    ds_read_b64_tr_b16 a[14:15], v4 offset:14080
    v_cvt_pk_bf16_f32 v48, v48, v49
    v_cvt_pk_bf16_f32 v49, v50, v51
    s_waitcnt lgkmcnt(8)
    v_mfma_f32_16x16x32_bf16 v[96:99], a[24:27], v[216:219], v[96:99]
    ds_read_b64_tr_b16 a[16:17], v5 offset:256
    v_cvt_pk_bf16_f32 v50, v60, v61
    v_cvt_pk_bf16_f32 v51, v62, v63
    v_permlane16_swap_b32 v40, v42
    v_mfma_f32_16x16x32_bf16 v[108:111], a[28:31], v[216:219], v[108:111]
    v_permlane16_swap_b32 v41, v43
    v_permlane16_swap_b32 v44, v46
    v_permlane16_swap_b32 v45, v47
    v_permlane16_swap_b32 v48, v50
    v_permlane16_swap_b32 v49, v51
    v_mfma_f32_16x16x32_bf16 v[104:107], a[28:31], v[212:215], v[104:107]
    ds_read_b64_tr_b16 a[18:19], v5 offset:1792
    v_mul_f32 v64, s44, v64
    v_mul_f32 v65, s44, v65
    v_mfma_f32_16x16x32_bf16 v[92:95], a[24:27], v[212:215], v[92:95]
    ds_read_b64_tr_b16 a[20:21], v6 offset:256
    v_mul_f32 v66, s44, v66
    v_mul_f32 v67, s44, v67
    v_mfma_f32_16x16x32_bf16 v[88:91], a[24:27], v[208:211], v[88:91]
    v_mul_f32 v76, s44, v76
    v_mul_f32 v77, s44, v77
    v_mul_f32 v78, s44, v78
    v_mul_f32 v79, s44, v79
    v_mfma_f32_16x16x32_bf16 v[100:103], a[28:31], v[208:211], v[100:103]
    ds_read_b64_tr_b16 a[22:23], v6 offset:1792
    v_mul_f32 v68, s44, v68
    v_mul_f32 v69, s44, v69
    s_waitcnt lgkmcnt(8)
    v_mfma_f32_16x16x32_bf16 v[112:115], a[0:3], v[184:187], v[112:115]
    ds_read_b64_tr_b16 a[24:25], v5 offset:12544
    v_mul_f32 v70, s44, v70
    v_mul_f32 v71, s44, v71
    v_mul_f32 v80, s44, v80
    v_mfma_f32_16x16x32_bf16 v[124:127], a[4:7], v[184:187], v[124:127]
    v_mul_f32 v81, s44, v81
    v_mul_f32 v82, s44, v82
    v_mul_f32 v83, s44, v83
    v_mul_f32 v72, s44, v72
    v_mfma_f32_16x16x32_bf16 v[128:131], a[4:7], v[188:191], v[128:131]
    ds_read_b64_tr_b16 a[26:27], v5 offset:14080
    v_mul_f32 v73, s44, v73
    v_mul_f32 v74, s44, v74
    v_mul_f32 v75, s44, v75
    v_mfma_f32_16x16x32_bf16 v[116:119], a[0:3], v[188:191], v[116:119]
    ds_read_b64_tr_b16 a[28:29], v6 offset:12544
    v_mul_f32 v84, s44, v84
    v_mul_f32 v85, s44, v85
    v_mul_f32 v86, s44, v86
    v_mfma_f32_16x16x32_bf16 v[120:123], a[0:3], v[192:195], v[120:123]
    v_mul_f32 v87, s44, v87
    v_cvt_pk_bf16_f32 v64, v64, v65
    v_cvt_pk_bf16_f32 v65, v66, v67
    v_cvt_pk_bf16_f32 v66, v76, v77
    v_mfma_f32_16x16x32_bf16 v[132:135], a[4:7], v[192:195], v[132:135]
    ds_read_b64_tr_b16 a[30:31], v6 offset:14080
    v_cvt_pk_bf16_f32 v67, v78, v79
    v_cvt_pk_bf16_f32 v68, v68, v69
    s_waitcnt lgkmcnt(8)
    v_mfma_f32_16x16x32_bf16 v[120:123], a[8:11], v[216:219], v[120:123]
    ds_read_b128 a[0:3], v10 offset:0
    v_add_u32 v1, -98304, v10
    v_cvt_pk_bf16_f32 v69, v70, v71
    v_cvt_pk_bf16_f32 v70, v80, v81
    v_mfma_f32_16x16x32_bf16 v[132:135], a[12:15], v[216:219], v[132:135]
    v_xor_b32 v2, 64, v1
    v_cvt_pk_bf16_f32 v71, v82, v83
    v_cvt_pk_bf16_f32 v72, v72, v73
    v_cvt_pk_bf16_f32 v73, v74, v75
    v_cvt_pk_bf16_f32 v74, v84, v85
    v_mfma_f32_16x16x32_bf16 v[128:131], a[12:15], v[212:215], v[128:131]
    v_and_b32 v12, 63, v0
    v_lshrrev_b32 v13, 2, v12
    v_cvt_pk_bf16_f32 v75, v86, v87
    v_permlane16_swap_b32 v64, v66
    v_permlane16_swap_b32 v65, v67
    v_mfma_f32_16x16x32_bf16 v[116:119], a[8:11], v[212:215], v[116:119]
    ds_read_b128 a[4:7], v10 offset:6144
    s_add_u32 m0, s36, 0
    v_permlane16_swap_b32 v68, v70
    v_permlane16_swap_b32 v69, v71
    v_permlane16_swap_b32 v72, v74
    v_permlane16_swap_b32 v73, v75
    v_mfma_f32_16x16x32_bf16 v[112:115], a[8:11], v[208:211], v[112:115]
    buffer_load_dwordx4 v244, s[12:15], s38 offen offset:0 nt lds
    v_mul_f32 v88, s44, v88
    v_mul_f32 v89, s44, v89
    v_mfma_f32_16x16x32_bf16 v[124:127], a[12:15], v[208:211], v[124:127]
    v_mul_u32_u24 v15, 384, v13
    v_mul_f32 v90, s44, v90
    v_mul_f32 v91, s44, v91
    s_waitcnt lgkmcnt(6)
    v_mfma_f32_16x16x32_bf16 v[136:139], a[16:19], v[184:187], v[136:139]
    ds_read_b128 a[8:11], v11 offset:0
    v_and_b32 v14, 2, v13
    v_mul_f32 v100, s44, v100
    v_mul_f32 v101, s44, v101
    v_mfma_f32_16x16x32_bf16 v[148:151], a[20:23], v[184:187], v[148:151]
    v_lshlrev_b32 v14, 1, v14
    v_mul_f32 v102, s44, v102
    v_mul_f32 v103, s44, v103
    v_mul_f32 v92, s44, v92
    v_mfma_f32_16x16x32_bf16 v[152:155], a[20:23], v[188:191], v[152:155]
    v_bfe_u32 v13, v13, 2, 1
    v_lshl_or_b32 v14, v13, 1, v14
    v_mul_f32 v93, s44, v93
    v_mul_f32 v94, s44, v94
    v_mfma_f32_16x16x32_bf16 v[140:143], a[16:19], v[188:191], v[140:143]
    ds_read_b128 a[12:15], v11 offset:6144
    v_mul_f32 v95, s44, v95
    v_mul_f32 v104, s44, v104
    v_mul_f32 v105, s44, v105
    v_mfma_f32_16x16x32_bf16 v[144:147], a[16:19], v[192:195], v[144:147]
    v_bfe_u32 v13, v12, 1, 1
    v_xor_b32 v14, v14, v13
    v_mul_f32 v106, s44, v106
    v_mul_f32 v107, s44, v107
    v_mul_f32 v96, s44, v96
    v_mfma_f32_16x16x32_bf16 v[156:159], a[20:23], v[192:195], v[156:159]
    v_lshl_add_u32 v15, v14, 4, v15
    v_mul_f32 v97, s44, v97
    v_mul_f32 v98, s44, v98
    v_mul_f32 v99, s44, v99
    s_waitcnt lgkmcnt(4)
    v_mfma_f32_16x16x32_bf16 v[144:147], a[24:27], v[216:219], v[144:147]
    ds_read_b128 a[16:19], v10 offset:128
    buffer_load_dwordx4 v245, s[12:15], s38 offen offset:1024 nt lds
    v_mul_f32 v108, s44, v108
    v_mul_f32 v109, s44, v109
    v_mfma_f32_16x16x32_bf16 v[156:159], a[28:31], v[216:219], v[156:159]
    v_and_b32 v13, 1, v12
    v_mul_f32 v110, s44, v110
    v_mul_f32 v111, s44, v111
    v_cvt_pk_bf16_f32 v88, v88, v89
    v_cvt_pk_bf16_f32 v89, v90, v91
    v_mfma_f32_16x16x32_bf16 v[152:155], a[28:31], v[212:215], v[152:155]
    v_lshl_add_u32 v15, v13, 3, v15
    v_cvt_pk_bf16_f32 v90, v100, v101
    v_cvt_pk_bf16_f32 v91, v102, v103
    v_cvt_pk_bf16_f32 v92, v92, v93
    v_mfma_f32_16x16x32_bf16 v[140:143], a[24:27], v[212:215], v[140:143]
    ds_read_b128 a[20:23], v10 offset:6272
    v_add_u32 v3, 61440, v15
    v_cvt_pk_bf16_f32 v93, v94, v95
    v_cvt_pk_bf16_f32 v94, v104, v105
    v_cvt_pk_bf16_f32 v95, v106, v107
    v_cvt_pk_bf16_f32 v96, v96, v97
    v_mfma_f32_16x16x32_bf16 v[136:139], a[24:27], v[208:211], v[136:139]
    v_xor_b32 v4, 32, v3
    v_xor_b32 v5, 64, v3
    v_cvt_pk_bf16_f32 v97, v98, v99
    v_cvt_pk_bf16_f32 v98, v108, v109
    v_cvt_pk_bf16_f32 v99, v110, v111
    v_permlane16_swap_b32 v88, v90
    v_mfma_f32_16x16x32_bf16 v[148:151], a[28:31], v[208:211], v[148:151]
    v_permlane16_swap_b32 v89, v91
    v_permlane16_swap_b32 v92, v94
    v_permlane16_swap_b32 v93, v95
    v_permlane16_swap_b32 v96, v98
    v_permlane16_swap_b32 v97, v99
    s_waitcnt lgkmcnt(4)
    v_mfma_f32_16x16x32_bf16 v[160:163], a[0:3], v[16:19], 0
    ds_read_b128 a[24:27], v11 offset:128
    v_xor_b32 v6, 96, v3
    v_mul_f32 v112, s44, v112
    v_mfma_f32_16x16x32_bf16 v[164:167], a[4:7], v[16:19], 0
    v_mul_f32 v113, s44, v113
    v_mul_f32 v114, s44, v114
    v_mul_f32 v115, s44, v115
    v_mfma_f32_16x16x32_bf16 v[172:175], a[4:7], v[20:23], 0
    buffer_load_dwordx4 v246, s[12:15], s38 offen offset:2048 nt lds
    v_mul_f32 v124, s44, v124
    v_mul_f32 v125, s44, v125
    v_mfma_f32_16x16x32_bf16 v[168:171], a[0:3], v[20:23], 0
    ds_read_b128 a[28:31], v11 offset:6272
    v_mul_f32 v126, s44, v126
    v_mul_f32 v127, s44, v127
    v_mul_f32 v116, s44, v116
    v_mfma_f32_16x16x32_bf16 v[176:179], a[0:3], v[24:27], 0
    v_mul_f32 v117, s44, v117
    v_mul_f32 v118, s44, v118
    v_mul_f32 v119, s44, v119
    v_mul_f32 v128, s44, v128
    v_mfma_f32_16x16x32_bf16 v[180:183], a[4:7], v[24:27], 0
    v_mul_f32 v129, s44, v129
    v_mul_f32 v130, s44, v130
    s_waitcnt lgkmcnt(4)
    v_mfma_f32_16x16x32_bf16 v[160:163], a[8:11], v[40:43], v[160:163]
    ds_read_b128 a[0:3], v10 offset:256
    v_mul_f32 v131, s44, v131
    v_mul_f32 v120, s44, v120
    v_mul_f32 v121, s44, v121
    v_mfma_f32_16x16x32_bf16 v[164:167], a[12:15], v[40:43], v[164:167]
    v_mul_f32 v122, s44, v122
    v_mul_f32 v123, s44, v123
    v_mul_f32 v132, s44, v132
    v_mul_f32 v133, s44, v133
    v_mfma_f32_16x16x32_bf16 v[172:175], a[12:15], v[44:47], v[172:175]
    v_mul_f32 v134, s44, v134
    v_mul_f32 v135, s44, v135
    v_cvt_pk_bf16_f32 v112, v112, v113
    v_mfma_f32_16x16x32_bf16 v[168:171], a[8:11], v[44:47], v[168:171]
    ds_read_b128 a[4:7], v10 offset:6400
    v_cvt_pk_bf16_f32 v113, v114, v115
    v_cvt_pk_bf16_f32 v114, v124, v125
    v_cvt_pk_bf16_f32 v115, v126, v127
    v_mfma_f32_16x16x32_bf16 v[176:179], a[8:11], v[48:51], v[176:179]
    buffer_load_dwordx4 v247, s[12:15], s38 offen offset:3072 nt lds
    v_cvt_pk_bf16_f32 v116, v116, v117
    v_cvt_pk_bf16_f32 v117, v118, v119
    v_cvt_pk_bf16_f32 v118, v128, v129
    v_mfma_f32_16x16x32_bf16 v[180:183], a[12:15], v[48:51], v[180:183]
    v_cvt_pk_bf16_f32 v119, v130, v131
    v_cvt_pk_bf16_f32 v120, v120, v121
    v_cvt_pk_bf16_f32 v121, v122, v123
    s_waitcnt lgkmcnt(4)
    v_mfma_f32_16x16x32_bf16 v[160:163], a[16:19], v[64:67], v[160:163]
    ds_read_b128 a[8:11], v11 offset:256
    v_cvt_pk_bf16_f32 v122, v132, v133
    v_cvt_pk_bf16_f32 v123, v134, v135
    v_permlane16_swap_b32 v112, v114
    v_mfma_f32_16x16x32_bf16 v[164:167], a[20:23], v[64:67], v[164:167]
    v_permlane16_swap_b32 v113, v115
    v_permlane16_swap_b32 v116, v118
    v_permlane16_swap_b32 v117, v119
    v_permlane16_swap_b32 v120, v122
    v_permlane16_swap_b32 v121, v123
    v_mfma_f32_16x16x32_bf16 v[172:175], a[20:23], v[68:71], v[172:175]
    v_mul_f32 v136, s44, v136
    v_mul_f32 v137, s44, v137
    v_mul_f32 v138, s44, v138
    v_mfma_f32_16x16x32_bf16 v[168:171], a[16:19], v[68:71], v[168:171]
    ds_read_b128 a[12:15], v11 offset:6400
    v_mul_f32 v139, s44, v139
    v_mul_f32 v148, s44, v148
    v_mfma_f32_16x16x32_bf16 v[176:179], a[16:19], v[72:75], v[176:179]
    v_mul_f32 v149, s44, v149
    v_mul_f32 v150, s44, v150
    v_mul_f32 v151, s44, v151
    v_mfma_f32_16x16x32_bf16 v[180:183], a[20:23], v[72:75], v[180:183]
    s_add_u32 m0, s36, 4096
    v_mul_f32 v140, s44, v140
    s_waitcnt lgkmcnt(4)
    v_mfma_f32_16x16x32_bf16 v[160:163], a[24:27], v[88:91], v[160:163]
    buffer_load_dwordx4 v248, s[12:15], s38 offen offset:0 nt lds
    v_mul_f32 v141, s44, v141
    v_mul_f32 v142, s44, v142
    v_mfma_f32_16x16x32_bf16 v[164:167], a[28:31], v[88:91], v[164:167]
    v_mul_f32 v143, s44, v143
    v_mul_f32 v152, s44, v152
    v_mul_f32 v153, s44, v153
    v_mfma_f32_16x16x32_bf16 v[172:175], a[28:31], v[92:95], v[172:175]
    v_mul_f32 v154, s44, v154
    v_mul_f32 v155, s44, v155
    v_mul_f32 v144, s44, v144
    v_mfma_f32_16x16x32_bf16 v[168:171], a[24:27], v[92:95], v[168:171]
    v_mul_f32 v145, s44, v145
    v_mul_f32 v146, s44, v146
    v_mul_f32 v147, s44, v147
    v_mul_f32 v156, s44, v156
    v_mfma_f32_16x16x32_bf16 v[176:179], a[24:27], v[96:99], v[176:179]
    v_mul_f32 v157, s44, v157
    v_mul_f32 v158, s44, v158
    v_mul_f32 v159, s44, v159
    v_mfma_f32_16x16x32_bf16 v[180:183], a[28:31], v[96:99], v[180:183]
    v_cvt_pk_bf16_f32 v136, v136, v137
    v_cvt_pk_bf16_f32 v137, v138, v139
    s_waitcnt lgkmcnt(2)
    v_mfma_f32_16x16x32_bf16 v[160:163], a[0:3], v[112:115], v[160:163]
    v_cvt_pk_bf16_f32 v138, v148, v149
    v_cvt_pk_bf16_f32 v139, v150, v151
    v_cvt_pk_bf16_f32 v140, v140, v141
    v_cvt_pk_bf16_f32 v141, v142, v143
    v_mfma_f32_16x16x32_bf16 v[164:167], a[4:7], v[112:115], v[164:167]
    v_cvt_pk_bf16_f32 v142, v152, v153
    v_cvt_pk_bf16_f32 v143, v154, v155
    v_cvt_pk_bf16_f32 v144, v144, v145
    v_mfma_f32_16x16x32_bf16 v[172:175], a[4:7], v[116:119], v[172:175]
    buffer_load_dwordx4 v249, s[12:15], s38 offen offset:1024 nt lds
    v_cvt_pk_bf16_f32 v145, v146, v147
    v_cvt_pk_bf16_f32 v146, v156, v157
    v_cvt_pk_bf16_f32 v147, v158, v159
    v_mfma_f32_16x16x32_bf16 v[168:171], a[0:3], v[116:119], v[168:171]
    s_add_u32 s38, s38, 12288
    v_permlane16_swap_b32 v136, v138
    v_permlane16_swap_b32 v137, v139
    v_permlane16_swap_b32 v140, v142
    v_mfma_f32_16x16x32_bf16 v[176:179], a[0:3], v[120:123], v[176:179]
    s_sub_u32 s46, s42, s47
    v_permlane16_swap_b32 v141, v143
    v_permlane16_swap_b32 v144, v146
    v_permlane16_swap_b32 v145, v147
    v_mfma_f32_16x16x32_bf16 v[180:183], a[4:7], v[120:123], v[180:183]
    s_waitcnt lgkmcnt(0)
    v_mfma_f32_16x16x32_bf16 v[160:163], a[8:11], v[136:139], v[160:163]
    v_mfma_f32_16x16x32_bf16 v[164:167], a[12:15], v[136:139], v[164:167]
    s_mov_b32 s42, s36
    v_mfma_f32_16x16x32_bf16 v[172:175], a[12:15], v[140:143], v[172:175]
    s_mov_b32 s36, s47
    v_mfma_f32_16x16x32_bf16 v[168:171], a[8:11], v[140:143], v[168:171]
    v_mfma_f32_16x16x32_bf16 v[176:179], a[8:11], v[144:147], v[176:179]
    s_add_u32 s47, s47, s46
    v_mfma_f32_16x16x32_bf16 v[180:183], a[12:15], v[144:147], v[180:183]
    s_waitcnt vmcnt(6) lgkmcnt(0)
    s_barrier
    ds_read_b128 a[0:3], v1 offset:0
    ds_read_b128 a[4:7], v1 offset:6144
    ds_read_b128 a[8:11], v2 offset:0
    ds_read_b128 a[12:15], v2 offset:6144
    ds_read_b128 a[16:19], v1 offset:128
    ds_read_b128 a[20:23], v1 offset:6272
    v_max3_f32 v10, v160, v161, v162
    v_max3_f32 v10, v10, v163, v164
    v_max3_f32 v10, v10, v165, v166
    v_max_f32 v10, v10, v167
    v_max3_f32 v11, v168, v169, v170
    v_max3_f32 v11, v11, v171, v172
    v_max3_f32 v11, v11, v173, v174
    v_max_f32 v11, v11, v175
    v_max3_f32 v12, v176, v177, v178
    v_max3_f32 v12, v12, v179, v180
    v_max3_f32 v12, v12, v181, v182
    v_max_f32 v12, v12, v183
    v_mov_b32 v13, v10
    v_mov_b32 v14, v11
    v_mov_b32 v15, v12
    v_permlane32_swap_b32 v10, v13
    v_permlane32_swap_b32 v11, v14
    v_permlane32_swap_b32 v12, v15
    v_max_f32 v10, v10, v13
    v_max_f32 v11, v11, v14
    v_max_f32 v12, v12, v15
    v_mov_b32 v13, v10
    v_mov_b32 v14, v11
    v_mov_b32 v15, v12
    v_permlane16_swap_b32 v10, v13
    v_permlane16_swap_b32 v11, v14
    v_permlane16_swap_b32 v12, v15
    v_max_f32 v10, v10, v13
    v_max_f32 v11, v11, v14
    v_max_f32 v12, v12, v15
    v_sub_f32 v28, 0, v10
    v_sub_f32 v29, 0, v10
    v_sub_f32 v30, 0, v10
    v_sub_f32 v31, 0, v10
    v_sub_f32 v160, v160, v10
    v_sub_f32 v161, v161, v10
    v_sub_f32 v162, v162, v10
    v_sub_f32 v163, v163, v10
    v_sub_f32 v164, v164, v10
    v_sub_f32 v165, v165, v10
    v_sub_f32 v166, v166, v10
    v_sub_f32 v167, v167, v10
    v_sub_f32 v32, 0, v11
    v_sub_f32 v33, 0, v11
    v_sub_f32 v34, 0, v11
    v_sub_f32 v35, 0, v11
    v_sub_f32 v168, v168, v11
    v_sub_f32 v169, v169, v11
    v_sub_f32 v170, v170, v11
    v_sub_f32 v171, v171, v11
    v_sub_f32 v172, v172, v11
    v_sub_f32 v173, v173, v11
    v_sub_f32 v174, v174, v11
    v_sub_f32 v175, v175, v11
    v_sub_f32 v36, 0, v12
    v_sub_f32 v37, 0, v12
    v_sub_f32 v38, 0, v12
    v_sub_f32 v39, 0, v12
    v_sub_f32 v176, v176, v12
    v_sub_f32 v177, v177, v12
    v_sub_f32 v178, v178, v12
    v_sub_f32 v179, v179, v12
    v_sub_f32 v180, v180, v12
    v_sub_f32 v181, v181, v12
    v_sub_f32 v182, v182, v12
    v_sub_f32 v183, v183, v12
    v_exp_f32 v160, v160
    v_exp_f32 v161, v161
    v_exp_f32 v162, v162
    v_exp_f32 v163, v163
    v_exp_f32 v164, v164
    v_exp_f32 v165, v165
    v_exp_f32 v166, v166
    v_exp_f32 v167, v167
    v_exp_f32 v168, v168
    v_exp_f32 v169, v169
    v_exp_f32 v170, v170
    v_exp_f32 v171, v171
    v_exp_f32 v172, v172
    s_getpc_b64 s[72:73]
L_pc_tail:
    v_lshlrev_b32 v76, 7, v0
    v_min_u32 v76, (L_safe - L_tail_begin - 4), v76
    s_add_u32 s72, s72, (L_tail_begin - L_pc_tail)
    s_addc_u32 s73, s73, 0
    v_mov_b32 v77, s73
    v_add_co_u32 v76, vcc, s72, v76
    s_nop 1
    v_addc_co_u32 v77, vcc, 0, v77, vcc
    global_load_dword v76, v[76:77], off
    s_waitcnt lgkmcnt(4)
    v_mfma_f32_16x16x32_bf16 v[184:187], a[0:3], v[16:19], v[28:31]
    ds_read_b128 a[24:27], v2 offset:128
    v_cvt_pk_bf16_f32 v52, v160, v161
    v_mfma_f32_16x16x32_bf16 v[188:191], a[4:7], v[16:19], v[28:31]
    s_add_u32 m0, s42, 24576
    v_add_f32 v7, v7, v160
    v_mfma_f32_16x16x32_bf16 v[196:199], a[4:7], v[20:23], v[32:35]
    s_waitcnt vmcnt(4)
    buffer_load_dwordx4 v244, s[12:15], s38 offen offset:0 nt lds
    v_cvt_pk_bf16_f32 v53, v162, v163
    v_mfma_f32_16x16x32_bf16 v[192:195], a[0:3], v[20:23], v[32:35]
    ds_read_b128 a[28:31], v2 offset:6272
    v_add_f32 v7, v7, v161
    v_mfma_f32_16x16x32_bf16 v[200:203], a[0:3], v[24:27], v[36:39]
    v_exp_f32 v173, v173
    v_mfma_f32_16x16x32_bf16 v[204:207], a[4:7], v[24:27], v[36:39]
    v_cvt_pk_bf16_f32 v54, v164, v165
    s_waitcnt lgkmcnt(4)
    v_mfma_f32_16x16x32_bf16 v[184:187], a[8:11], v[40:43], v[184:187]
    ds_read_b128 a[0:3], v1 offset:256
    v_mfma_f32_16x16x32_bf16 v[188:191], a[12:15], v[40:43], v[188:191]
    v_exp_f32 v174, v174
    v_mfma_f32_16x16x32_bf16 v[196:199], a[12:15], v[44:47], v[196:199]
    v_exp_f32 v175, v175
    v_mfma_f32_16x16x32_bf16 v[192:195], a[8:11], v[44:47], v[192:195]
    ds_read_b128 a[4:7], v1 offset:6400
    v_cvt_pk_bf16_f32 v55, v166, v167
    v_mfma_f32_16x16x32_bf16 v[200:203], a[8:11], v[48:51], v[200:203]
    v_exp_f32 v176, v176
    v_mfma_f32_16x16x32_bf16 v[204:207], a[12:15], v[48:51], v[204:207]
    v_add_f32 v7, v7, v162
    s_waitcnt lgkmcnt(4)
    v_mfma_f32_16x16x32_bf16 v[184:187], a[16:19], v[64:67], v[184:187]
    ds_read_b128 a[8:11], v2 offset:256
    v_cvt_pk_bf16_f32 v56, v168, v169
    v_mfma_f32_16x16x32_bf16 v[188:191], a[20:23], v[64:67], v[188:191]
    v_exp_f32 v177, v177
    v_mfma_f32_16x16x32_bf16 v[196:199], a[20:23], v[68:71], v[196:199]
    s_waitcnt vmcnt(4)
    buffer_load_dwordx4 v245, s[12:15], s38 offen offset:1024 nt lds
    v_add_f32 v7, v7, v163
    v_mfma_f32_16x16x32_bf16 v[192:195], a[16:19], v[68:71], v[192:195]
    ds_read_b128 a[12:15], v2 offset:6400
    v_cvt_pk_bf16_f32 v57, v170, v171
    v_mfma_f32_16x16x32_bf16 v[200:203], a[16:19], v[72:75], v[200:203]
    v_exp_f32 v178, v178
    v_mfma_f32_16x16x32_bf16 v[204:207], a[20:23], v[72:75], v[204:207]
    v_cvt_pk_bf16_f32 v58, v172, v173
    s_waitcnt lgkmcnt(4)
    v_mfma_f32_16x16x32_bf16 v[184:187], a[24:27], v[88:91], v[184:187]
    ds_read_b64_tr_b16 a[16:17], v3 offset:0
    v_add_f32 v7, v7, v164
    v_mfma_f32_16x16x32_bf16 v[188:191], a[28:31], v[88:91], v[188:191]
    v_exp_f32 v179, v179
    v_mfma_f32_16x16x32_bf16 v[196:199], a[28:31], v[92:95], v[196:199]
    ds_read_b64_tr_b16 a[18:19], v3 offset:6144
    v_cvt_pk_bf16_f32 v59, v174, v175
    v_mfma_f32_16x16x32_bf16 v[192:195], a[24:27], v[92:95], v[192:195]
    ds_read_b64_tr_b16 a[20:21], v4 offset:0
    v_add_f32 v7, v7, v165
    v_mfma_f32_16x16x32_bf16 v[200:203], a[24:27], v[96:99], v[200:203]
    v_exp_f32 v180, v180
    v_mfma_f32_16x16x32_bf16 v[204:207], a[28:31], v[96:99], v[204:207]
    ds_read_b64_tr_b16 a[22:23], v4 offset:6144
    s_waitcnt lgkmcnt(6)
    v_mfma_f32_16x16x32_bf16 v[184:187], a[0:3], v[112:115], v[184:187]
    ds_read_b64_tr_b16 a[24:25], v5 offset:0
    v_cvt_pk_bf16_f32 v60, v176, v177
    v_mfma_f32_16x16x32_bf16 v[188:191], a[4:7], v[112:115], v[188:191]
    v_exp_f32 v181, v181
    v_mfma_f32_16x16x32_bf16 v[196:199], a[4:7], v[116:119], v[196:199]
    ds_read_b64_tr_b16 a[26:27], v5 offset:6144
    v_mfma_f32_16x16x32_bf16 v[192:195], a[0:3], v[116:119], v[192:195]
    ds_read_b64_tr_b16 a[28:29], v6 offset:0
    s_waitcnt vmcnt(4)
    buffer_load_dwordx4 v246, s[12:15], s38 offen offset:2048 nt lds
    v_mfma_f32_16x16x32_bf16 v[200:203], a[0:3], v[120:123], v[200:203]
    v_exp_f32 v182, v182
    v_mfma_f32_16x16x32_bf16 v[204:207], a[4:7], v[120:123], v[204:207]
    ds_read_b64_tr_b16 a[30:31], v6 offset:6144
    s_waitcnt lgkmcnt(8)
    v_mfma_f32_16x16x32_bf16 v[184:187], a[8:11], v[136:139], v[184:187]
    ds_read_b64_tr_b16 a[0:1], v3 offset:128
    v_cvt_pk_bf16_f32 v61, v178, v179
    v_mfma_f32_16x16x32_bf16 v[188:191], a[12:15], v[136:139], v[188:191]
    v_exp_f32 v183, v183
    v_mfma_f32_16x16x32_bf16 v[196:199], a[12:15], v[140:143], v[196:199]
    ds_read_b64_tr_b16 a[2:3], v3 offset:6272
    v_add_f32 v7, v7, v166
    v_mfma_f32_16x16x32_bf16 v[192:195], a[8:11], v[140:143], v[192:195]
    ds_read_b64_tr_b16 a[4:5], v4 offset:128
    v_cvt_pk_bf16_f32 v62, v180, v181
    v_mfma_f32_16x16x32_bf16 v[200:203], a[8:11], v[144:147], v[200:203]
    v_cvt_pk_bf16_f32 v63, v182, v183
    v_add_f32 v7, v7, v167
    v_mfma_f32_16x16x32_bf16 v[204:207], a[12:15], v[144:147], v[204:207]
    ds_read_b64_tr_b16 a[6:7], v4 offset:6272
    s_waitcnt lgkmcnt(8)
    v_mfma_f32_16x16x32_bf16 a[32:35], a[16:19], v[52:55], 0
    ds_read_b64_tr_b16 a[8:9], v5 offset:128
    v_add_f32 v8, v8, v168
    v_mfma_f32_16x16x32_bf16 a[44:47], a[20:23], v[52:55], 0
    v_add_f32 v8, v8, v169
    v_mfma_f32_16x16x32_bf16 a[48:51], a[20:23], v[56:59], 0
    ds_read_b64_tr_b16 a[10:11], v5 offset:6272
    v_add_f32 v8, v8, v170
    v_mfma_f32_16x16x32_bf16 a[36:39], a[16:19], v[56:59], 0
    ds_read_b64_tr_b16 a[12:13], v6 offset:128
    v_add_f32 v8, v8, v171
    v_mfma_f32_16x16x32_bf16 a[40:43], a[16:19], v[60:63], 0
    s_waitcnt vmcnt(4)
    buffer_load_dwordx4 v247, s[12:15], s38 offen offset:3072 nt lds
    v_add_f32 v8, v8, v172
    v_mfma_f32_16x16x32_bf16 a[52:55], a[20:23], v[60:63], 0
    ds_read_b64_tr_b16 a[14:15], v6 offset:6272
    s_waitcnt lgkmcnt(8)
    v_mfma_f32_16x16x32_bf16 a[64:67], a[24:27], v[60:63], 0
    ds_read_b64_tr_b16 a[16:17], v3 offset:256
    v_add_f32 v8, v8, v173
    v_mfma_f32_16x16x32_bf16 a[76:79], a[28:31], v[60:63], 0
    v_exp_f32 v184, v184
    v_mfma_f32_16x16x32_bf16 a[72:75], a[28:31], v[56:59], 0
    ds_read_b64_tr_b16 a[18:19], v3 offset:6400
    v_mfma_f32_16x16x32_bf16 a[60:63], a[24:27], v[56:59], 0
    ds_read_b64_tr_b16 a[20:21], v4 offset:256
    v_exp_f32 v185, v185
    v_mfma_f32_16x16x32_bf16 a[56:59], a[24:27], v[52:55], 0
    v_exp_f32 v186, v186
    v_mfma_f32_16x16x32_bf16 a[68:71], a[28:31], v[52:55], 0
    ds_read_b64_tr_b16 a[22:23], v4 offset:6400
    s_waitcnt lgkmcnt(8)
    v_mfma_f32_16x16x32_bf16 a[80:83], a[0:3], v[52:55], 0
    ds_read_b64_tr_b16 a[24:25], v5 offset:256
    v_add_f32 v8, v8, v174
    v_mfma_f32_16x16x32_bf16 a[92:95], a[4:7], v[52:55], 0
    v_exp_f32 v187, v187
    v_mfma_f32_16x16x32_bf16 a[96:99], a[4:7], v[56:59], 0
    ds_read_b64_tr_b16 a[26:27], v5 offset:6400
    v_add_f32 v8, v8, v175
    v_mfma_f32_16x16x32_bf16 a[84:87], a[0:3], v[56:59], 0
    ds_read_b64_tr_b16 a[28:29], v6 offset:256
    v_add_f32 v9, v9, v176
    v_mfma_f32_16x16x32_bf16 a[88:91], a[0:3], v[60:63], 0
    s_add_u32 m0, s42, 28672
    v_add_f32 v9, v9, v177
    v_mfma_f32_16x16x32_bf16 a[100:103], a[4:7], v[60:63], 0
    ds_read_b64_tr_b16 a[30:31], v6 offset:6400
    s_waitcnt vmcnt(4)
    buffer_load_dwordx4 v248, s[12:15], s38 offen offset:0 nt lds
    s_waitcnt lgkmcnt(8)
    v_mfma_f32_16x16x32_bf16 a[112:115], a[8:11], v[60:63], 0
    ds_read_b128 a[0:3], v1 offset:24576
    v_mfma_f32_16x16x32_bf16 a[124:127], a[12:15], v[60:63], 0
    v_exp_f32 v188, v188
    v_mfma_f32_16x16x32_bf16 a[120:123], a[12:15], v[56:59], 0
    v_exp_f32 v189, v189
    v_mfma_f32_16x16x32_bf16 a[108:111], a[8:11], v[56:59], 0
    ds_read_b128 a[4:7], v1 offset:30720
    v_add_f32 v9, v9, v178
    v_mfma_f32_16x16x32_bf16 a[104:107], a[8:11], v[52:55], 0
    v_exp_f32 v190, v190
    v_mfma_f32_16x16x32_bf16 a[116:119], a[12:15], v[52:55], 0
    v_add_f32 v9, v9, v179
    s_waitcnt lgkmcnt(6)
    v_mfma_f32_16x16x32_bf16 a[128:131], a[16:19], v[52:55], 0
    ds_read_b128 a[8:11], v2 offset:24576
    v_add_f32 v9, v9, v180
    v_mfma_f32_16x16x32_bf16 a[140:143], a[20:23], v[52:55], 0
    v_exp_f32 v191, v191
    v_mfma_f32_16x16x32_bf16 a[144:147], a[20:23], v[56:59], 0
    v_exp_f32 v192, v192
    v_mfma_f32_16x16x32_bf16 a[132:135], a[16:19], v[56:59], 0
    ds_read_b128 a[12:15], v2 offset:30720
    v_exp_f32 v193, v193
    v_mfma_f32_16x16x32_bf16 a[136:139], a[16:19], v[60:63], 0
    v_exp_f32 v194, v194
    v_mfma_f32_16x16x32_bf16 a[148:151], a[20:23], v[60:63], 0
    v_add_f32 v9, v9, v181
    s_waitcnt lgkmcnt(4)
    v_mfma_f32_16x16x32_bf16 a[160:163], a[24:27], v[60:63], 0
    ds_read_b128 a[16:19], v1 offset:24704
    s_waitcnt vmcnt(4)
    buffer_load_dwordx4 v249, s[12:15], s38 offen offset:1024 nt lds
    v_mfma_f32_16x16x32_bf16 a[172:175], a[28:31], v[60:63], 0
    s_add_u32 s38, s38, 12288
    v_mfma_f32_16x16x32_bf16 a[168:171], a[28:31], v[56:59], 0
    v_exp_f32 v195, v195
    v_mfma_f32_16x16x32_bf16 a[156:159], a[24:27], v[56:59], 0
    ds_read_b128 a[20:23], v1 offset:30848
    v_add_f32 v9, v9, v182
    v_mfma_f32_16x16x32_bf16 a[152:155], a[24:27], v[52:55], 0
    v_exp_f32 v196, v196
    v_mfma_f32_16x16x32_bf16 a[164:167], a[28:31], v[52:55], 0
    v_add_f32 v9, v9, v183
    s_waitcnt lgkmcnt(4)
    v_mfma_f32_16x16x32_bf16 v[160:163], a[0:3], v[16:19], v[28:31]
    ds_read_b128 a[24:27], v2 offset:24704
    v_cvt_pk_bf16_f32 v52, v184, v185
    v_mfma_f32_16x16x32_bf16 v[164:167], a[4:7], v[16:19], v[28:31]
    s_add_u32 m0, s36, 0
    v_add_f32 v7, v7, v184
    v_mfma_f32_16x16x32_bf16 v[172:175], a[4:7], v[20:23], v[32:35]
    s_waitcnt vmcnt(4)
    buffer_load_dwordx4 v244, s[12:15], s38 offen offset:0 nt lds
    v_cvt_pk_bf16_f32 v53, v186, v187
    v_mfma_f32_16x16x32_bf16 v[168:171], a[0:3], v[20:23], v[32:35]
    ds_read_b128 a[28:31], v2 offset:30848
    v_add_f32 v7, v7, v185
    v_mfma_f32_16x16x32_bf16 v[176:179], a[0:3], v[24:27], v[36:39]
    v_exp_f32 v197, v197
    v_mfma_f32_16x16x32_bf16 v[180:183], a[4:7], v[24:27], v[36:39]
    v_cvt_pk_bf16_f32 v54, v188, v189
    s_waitcnt lgkmcnt(4)
    v_mfma_f32_16x16x32_bf16 v[160:163], a[8:11], v[40:43], v[160:163]
    ds_read_b128 a[0:3], v1 offset:24832
    v_add_f32 v7, v7, v186
    v_mfma_f32_16x16x32_bf16 v[164:167], a[12:15], v[40:43], v[164:167]
    v_exp_f32 v198, v198
    v_mfma_f32_16x16x32_bf16 v[172:175], a[12:15], v[44:47], v[172:175]
    v_exp_f32 v199, v199
    v_mfma_f32_16x16x32_bf16 v[168:171], a[8:11], v[44:47], v[168:171]
    ds_read_b128 a[4:7], v1 offset:30976
    v_exp_f32 v200, v200
    v_mfma_f32_16x16x32_bf16 v[176:179], a[8:11], v[48:51], v[176:179]
    s_waitcnt vmcnt(4)
    buffer_load_dwordx4 v245, s[12:15], s38 offen offset:1024 nt lds
    v_cvt_pk_bf16_f32 v55, v190, v191
    v_mfma_f32_16x16x32_bf16 v[180:183], a[12:15], v[48:51], v[180:183]
    v_add_f32 v7, v7, v187
    s_waitcnt lgkmcnt(4)
    v_mfma_f32_16x16x32_bf16 v[160:163], a[16:19], v[64:67], v[160:163]
    ds_read_b128 a[8:11], v2 offset:24832
    v_cvt_pk_bf16_f32 v56, v192, v193
    v_mfma_f32_16x16x32_bf16 v[164:167], a[20:23], v[64:67], v[164:167]
    v_exp_f32 v201, v201
    v_mfma_f32_16x16x32_bf16 v[172:175], a[20:23], v[68:71], v[172:175]
    v_exp_f32 v202, v202
    v_mfma_f32_16x16x32_bf16 v[168:171], a[16:19], v[68:71], v[168:171]
    ds_read_b128 a[12:15], v2 offset:30976
    v_add_f32 v7, v7, v188
    v_mfma_f32_16x16x32_bf16 v[176:179], a[16:19], v[72:75], v[176:179]
    v_exp_f32 v203, v203
    v_mfma_f32_16x16x32_bf16 v[180:183], a[20:23], v[72:75], v[180:183]
    v_cvt_pk_bf16_f32 v57, v194, v195
    s_waitcnt lgkmcnt(4)
    v_mfma_f32_16x16x32_bf16 v[160:163], a[24:27], v[88:91], v[160:163]
    ds_read_b64_tr_b16 a[16:17], v3 offset:24576
    v_add_f32 v7, v7, v189
    v_mfma_f32_16x16x32_bf16 v[164:167], a[28:31], v[88:91], v[164:167]
    s_waitcnt vmcnt(4)
    buffer_load_dwordx4 v246, s[12:15], s38 offen offset:2048 nt lds
    v_cvt_pk_bf16_f32 v58, v196, v197
    v_mfma_f32_16x16x32_bf16 v[172:175], a[28:31], v[92:95], v[172:175]
    ds_read_b64_tr_b16 a[18:19], v3 offset:30720
    v_add_f32 v7, v7, v190
    v_mfma_f32_16x16x32_bf16 v[168:171], a[24:27], v[92:95], v[168:171]
    ds_read_b64_tr_b16 a[20:21], v4 offset:24576
    v_cvt_pk_bf16_f32 v59, v198, v199
    v_mfma_f32_16x16x32_bf16 v[176:179], a[24:27], v[96:99], v[176:179]
    v_exp_f32 v204, v204
    v_mfma_f32_16x16x32_bf16 v[180:183], a[28:31], v[96:99], v[180:183]
    ds_read_b64_tr_b16 a[22:23], v4 offset:30720
    s_waitcnt lgkmcnt(6)
    v_mfma_f32_16x16x32_bf16 v[160:163], a[0:3], v[112:115], v[160:163]
    ds_read_b64_tr_b16 a[24:25], v5 offset:24576
    v_exp_f32 v205, v205
    v_mfma_f32_16x16x32_bf16 v[164:167], a[4:7], v[112:115], v[164:167]
    v_exp_f32 v206, v206
    v_mfma_f32_16x16x32_bf16 v[172:175], a[4:7], v[116:119], v[172:175]
    ds_read_b64_tr_b16 a[26:27], v5 offset:30720
    v_add_f32 v7, v7, v191
    v_mfma_f32_16x16x32_bf16 v[168:171], a[0:3], v[116:119], v[168:171]
    ds_read_b64_tr_b16 a[28:29], v6 offset:24576
    v_cvt_pk_bf16_f32 v60, v200, v201
    v_mfma_f32_16x16x32_bf16 v[176:179], a[0:3], v[120:123], v[176:179]
    s_waitcnt vmcnt(4)
    buffer_load_dwordx4 v247, s[12:15], s38 offen offset:3072 nt lds
    v_add_f32 v8, v8, v192
    v_mfma_f32_16x16x32_bf16 v[180:183], a[4:7], v[120:123], v[180:183]
    ds_read_b64_tr_b16 a[30:31], v6 offset:30720
    s_waitcnt lgkmcnt(8)
    v_mfma_f32_16x16x32_bf16 v[160:163], a[8:11], v[136:139], v[160:163]
    ds_read_b64_tr_b16 a[0:1], v3 offset:24704
    v_cvt_pk_bf16_f32 v61, v202, v203
    v_mfma_f32_16x16x32_bf16 v[164:167], a[12:15], v[136:139], v[164:167]
    v_exp_f32 v207, v207
    v_mfma_f32_16x16x32_bf16 v[172:175], a[12:15], v[140:143], v[172:175]
    ds_read_b64_tr_b16 a[2:3], v3 offset:30848
    v_add_f32 v8, v8, v193
    v_mfma_f32_16x16x32_bf16 v[168:171], a[8:11], v[140:143], v[168:171]
    ds_read_b64_tr_b16 a[4:5], v4 offset:24704
    v_cvt_pk_bf16_f32 v62, v204, v205
    v_mfma_f32_16x16x32_bf16 v[176:179], a[8:11], v[144:147], v[176:179]
    v_cvt_pk_bf16_f32 v63, v206, v207
    v_add_f32 v8, v8, v194
    v_mfma_f32_16x16x32_bf16 v[180:183], a[12:15], v[144:147], v[180:183]
    ds_read_b64_tr_b16 a[6:7], v4 offset:30848
    s_waitcnt lgkmcnt(8)
    v_mfma_f32_16x16x32_bf16 a[32:35], a[16:19], v[52:55], a[32:35]
    ds_read_b64_tr_b16 a[8:9], v5 offset:24704
    s_add_u32 m0, s36, 4096
    v_mfma_f32_16x16x32_bf16 a[44:47], a[20:23], v[52:55], a[44:47]
    s_waitcnt vmcnt(4)
    buffer_load_dwordx4 v248, s[12:15], s38 offen offset:0 nt lds
    v_add_f32 v8, v8, v195
    v_mfma_f32_16x16x32_bf16 a[48:51], a[20:23], v[56:59], a[48:51]
    ds_read_b64_tr_b16 a[10:11], v5 offset:30848
    v_add_f32 v8, v8, v196
    v_mfma_f32_16x16x32_bf16 a[36:39], a[16:19], v[56:59], a[36:39]
    ds_read_b64_tr_b16 a[12:13], v6 offset:24704
    v_add_f32 v8, v8, v197
    v_mfma_f32_16x16x32_bf16 a[40:43], a[16:19], v[60:63], a[40:43]
    v_exp_f32 v160, v160
    v_mfma_f32_16x16x32_bf16 a[52:55], a[20:23], v[60:63], a[52:55]
    ds_read_b64_tr_b16 a[14:15], v6 offset:30848
    s_waitcnt lgkmcnt(8)
    v_mfma_f32_16x16x32_bf16 a[64:67], a[24:27], v[60:63], a[64:67]
    ds_read_b64_tr_b16 a[16:17], v3 offset:24832
    v_exp_f32 v161, v161
    v_mfma_f32_16x16x32_bf16 a[76:79], a[28:31], v[60:63], a[76:79]
    v_exp_f32 v162, v162
    v_mfma_f32_16x16x32_bf16 a[72:75], a[28:31], v[56:59], a[72:75]
    ds_read_b64_tr_b16 a[18:19], v3 offset:30976
    v_add_f32 v8, v8, v198
    v_mfma_f32_16x16x32_bf16 a[60:63], a[24:27], v[56:59], a[60:63]
    ds_read_b64_tr_b16 a[20:21], v4 offset:24832
    v_add_f32 v8, v8, v199
    v_mfma_f32_16x16x32_bf16 a[56:59], a[24:27], v[52:55], a[56:59]
    s_waitcnt vmcnt(4)
    buffer_load_dwordx4 v249, s[12:15], s38 offen offset:1024 nt lds
    v_add_f32 v9, v9, v200
    v_mfma_f32_16x16x32_bf16 a[68:71], a[28:31], v[52:55], a[68:71]
    ds_read_b64_tr_b16 a[22:23], v4 offset:30976
    s_add_u32 s38, s38, 12288
    s_waitcnt lgkmcnt(8)
    v_mfma_f32_16x16x32_bf16 a[80:83], a[0:3], v[52:55], a[80:83]
    ds_read_b64_tr_b16 a[24:25], v5 offset:24832
    s_sub_u32 s46, s42, s47
    v_mfma_f32_16x16x32_bf16 a[92:95], a[4:7], v[52:55], a[92:95]
    s_mov_b32 s42, s36
    v_add_f32 v9, v9, v201
    v_mfma_f32_16x16x32_bf16 a[96:99], a[4:7], v[56:59], a[96:99]
    ds_read_b64_tr_b16 a[26:27], v5 offset:30976
    v_add_f32 v9, v9, v202
    v_mfma_f32_16x16x32_bf16 a[84:87], a[0:3], v[56:59], a[84:87]
    ds_read_b64_tr_b16 a[28:29], v6 offset:24832
    s_mov_b32 s36, s47
    v_mfma_f32_16x16x32_bf16 a[88:91], a[0:3], v[60:63], a[88:91]
    s_add_u32 s47, s47, s46
    v_add_f32 v9, v9, v203
    v_mfma_f32_16x16x32_bf16 a[100:103], a[4:7], v[60:63], a[100:103]
    ds_read_b64_tr_b16 a[30:31], v6 offset:30976
    s_waitcnt lgkmcnt(8)
    v_mfma_f32_16x16x32_bf16 a[112:115], a[8:11], v[60:63], a[112:115]
    v_add_u32 v1, s46, v1
    v_add_u32 v2, s46, v2
    v_mfma_f32_16x16x32_bf16 a[124:127], a[12:15], v[60:63], a[124:127]
    v_exp_f32 v163, v163
    v_exp_f32 v164, v164
    v_mfma_f32_16x16x32_bf16 a[120:123], a[12:15], v[56:59], a[120:123]
    v_add_u32 v3, s46, v3
    v_add_u32 v4, s46, v4
    v_mfma_f32_16x16x32_bf16 a[108:111], a[8:11], v[56:59], a[108:111]
    v_add_u32 v5, s46, v5
    v_add_u32 v6, s46, v6
    v_mfma_f32_16x16x32_bf16 a[104:107], a[8:11], v[52:55], a[104:107]
    v_exp_f32 v165, v165
    v_mfma_f32_16x16x32_bf16 a[116:119], a[12:15], v[52:55], a[116:119]
    s_waitcnt vmcnt(6) lgkmcnt(0)
    s_barrier
    v_mfma_f32_16x16x32_bf16 a[128:131], a[16:19], v[52:55], a[128:131]
    ds_read_b128 a[0:3], v1 offset:0
    ds_read_b128 a[4:7], v1 offset:6144
    v_mfma_f32_16x16x32_bf16 a[140:143], a[20:23], v[52:55], a[140:143]
    v_exp_f32 v166, v166
    v_mfma_f32_16x16x32_bf16 a[144:147], a[20:23], v[56:59], a[144:147]
    ds_read_b128 a[8:11], v2 offset:0
    v_add_f32 v9, v9, v204
    v_mfma_f32_16x16x32_bf16 a[132:135], a[16:19], v[56:59], a[132:135]
    ds_read_b128 a[12:15], v2 offset:6144
    v_add_f32 v9, v9, v205
    v_mfma_f32_16x16x32_bf16 a[136:139], a[16:19], v[60:63], a[136:139]
    v_exp_f32 v167, v167
    v_mfma_f32_16x16x32_bf16 a[148:151], a[20:23], v[60:63], a[148:151]
    v_exp_f32 v168, v168
    v_mfma_f32_16x16x32_bf16 a[160:163], a[24:27], v[60:63], a[160:163]
    ds_read_b128 a[16:19], v1 offset:128
    v_exp_f32 v169, v169
    v_mfma_f32_16x16x32_bf16 a[172:175], a[28:31], v[60:63], a[172:175]
    v_exp_f32 v170, v170
    v_mfma_f32_16x16x32_bf16 a[168:171], a[28:31], v[56:59], a[168:171]
    v_exp_f32 v171, v171
    v_mfma_f32_16x16x32_bf16 a[156:159], a[24:27], v[56:59], a[156:159]
    ds_read_b128 a[20:23], v1 offset:6272
    v_add_f32 v9, v9, v206
    v_mfma_f32_16x16x32_bf16 a[152:155], a[24:27], v[52:55], a[152:155]
    v_exp_f32 v172, v172
    v_mfma_f32_16x16x32_bf16 a[164:167], a[28:31], v[52:55], a[164:167]
    v_add_f32 v9, v9, v207
    s_mov_b32 s41, 13
L_att_loop:
    s_waitcnt lgkmcnt(4)
    v_mfma_f32_16x16x32_bf16 v[184:187], a[0:3], v[16:19], v[28:31]
    ds_read_b128 a[24:27], v2 offset:128
    v_cvt_pk_bf16_f32 v52, v160, v161
    v_mfma_f32_16x16x32_bf16 v[188:191], a[4:7], v[16:19], v[28:31]
    s_add_u32 m0, s42, 24576
    v_add_f32 v7, v7, v160
    v_mfma_f32_16x16x32_bf16 v[196:199], a[4:7], v[20:23], v[32:35]
    s_waitcnt vmcnt(4)
    buffer_load_dwordx4 v244, s[12:15], s38 offen offset:0 nt lds
    v_cvt_pk_bf16_f32 v53, v162, v163
    v_mfma_f32_16x16x32_bf16 v[192:195], a[0:3], v[20:23], v[32:35]
    ds_read_b128 a[28:31], v2 offset:6272
    v_add_f32 v7, v7, v161
    v_mfma_f32_16x16x32_bf16 v[200:203], a[0:3], v[24:27], v[36:39]
    v_exp_f32 v173, v173
    v_mfma_f32_16x16x32_bf16 v[204:207], a[4:7], v[24:27], v[36:39]
    v_cvt_pk_bf16_f32 v54, v164, v165
    s_waitcnt lgkmcnt(4)
    v_mfma_f32_16x16x32_bf16 v[184:187], a[8:11], v[40:43], v[184:187]
    ds_read_b128 a[0:3], v1 offset:256
    v_mfma_f32_16x16x32_bf16 v[188:191], a[12:15], v[40:43], v[188:191]
    v_exp_f32 v174, v174
    v_mfma_f32_16x16x32_bf16 v[196:199], a[12:15], v[44:47], v[196:199]
    v_exp_f32 v175, v175
    v_mfma_f32_16x16x32_bf16 v[192:195], a[8:11], v[44:47], v[192:195]
    ds_read_b128 a[4:7], v1 offset:6400
    v_cvt_pk_bf16_f32 v55, v166, v167
    v_mfma_f32_16x16x32_bf16 v[200:203], a[8:11], v[48:51], v[200:203]
    v_exp_f32 v176, v176
    v_mfma_f32_16x16x32_bf16 v[204:207], a[12:15], v[48:51], v[204:207]
    v_add_f32 v7, v7, v162
    s_waitcnt lgkmcnt(4)
    v_mfma_f32_16x16x32_bf16 v[184:187], a[16:19], v[64:67], v[184:187]
    ds_read_b128 a[8:11], v2 offset:256
    v_cvt_pk_bf16_f32 v56, v168, v169
    v_mfma_f32_16x16x32_bf16 v[188:191], a[20:23], v[64:67], v[188:191]
    v_exp_f32 v177, v177
    v_mfma_f32_16x16x32_bf16 v[196:199], a[20:23], v[68:71], v[196:199]
    s_waitcnt vmcnt(4)
    buffer_load_dwordx4 v245, s[12:15], s38 offen offset:1024 nt lds
    v_add_f32 v7, v7, v163
    v_mfma_f32_16x16x32_bf16 v[192:195], a[16:19], v[68:71], v[192:195]
    ds_read_b128 a[12:15], v2 offset:6400
    v_cvt_pk_bf16_f32 v57, v170, v171
    v_mfma_f32_16x16x32_bf16 v[200:203], a[16:19], v[72:75], v[200:203]
    v_exp_f32 v178, v178
    v_mfma_f32_16x16x32_bf16 v[204:207], a[20:23], v[72:75], v[204:207]
    v_cvt_pk_bf16_f32 v58, v172, v173
    s_waitcnt lgkmcnt(4)
    v_mfma_f32_16x16x32_bf16 v[184:187], a[24:27], v[88:91], v[184:187]
    ds_read_b64_tr_b16 a[16:17], v3 offset:0
    v_add_f32 v7, v7, v164
    v_mfma_f32_16x16x32_bf16 v[188:191], a[28:31], v[88:91], v[188:191]
    v_exp_f32 v179, v179
    v_mfma_f32_16x16x32_bf16 v[196:199], a[28:31], v[92:95], v[196:199]
    ds_read_b64_tr_b16 a[18:19], v3 offset:6144
    v_cvt_pk_bf16_f32 v59, v174, v175
    v_mfma_f32_16x16x32_bf16 v[192:195], a[24:27], v[92:95], v[192:195]
    ds_read_b64_tr_b16 a[20:21], v4 offset:0
    v_add_f32 v7, v7, v165
    v_mfma_f32_16x16x32_bf16 v[200:203], a[24:27], v[96:99], v[200:203]
    v_exp_f32 v180, v180
    v_mfma_f32_16x16x32_bf16 v[204:207], a[28:31], v[96:99], v[204:207]
    ds_read_b64_tr_b16 a[22:23], v4 offset:6144
    s_waitcnt lgkmcnt(6)
    v_mfma_f32_16x16x32_bf16 v[184:187], a[0:3], v[112:115], v[184:187]
    ds_read_b64_tr_b16 a[24:25], v5 offset:0
    v_cvt_pk_bf16_f32 v60, v176, v177
    v_mfma_f32_16x16x32_bf16 v[188:191], a[4:7], v[112:115], v[188:191]
    v_exp_f32 v181, v181
    v_mfma_f32_16x16x32_bf16 v[196:199], a[4:7], v[116:119], v[196:199]
    ds_read_b64_tr_b16 a[26:27], v5 offset:6144
    v_mfma_f32_16x16x32_bf16 v[192:195], a[0:3], v[116:119], v[192:195]
    ds_read_b64_tr_b16 a[28:29], v6 offset:0
    s_waitcnt vmcnt(4)
    buffer_load_dwordx4 v246, s[12:15], s38 offen offset:2048 nt lds
    v_mfma_f32_16x16x32_bf16 v[200:203], a[0:3], v[120:123], v[200:203]
    v_exp_f32 v182, v182
    v_mfma_f32_16x16x32_bf16 v[204:207], a[4:7], v[120:123], v[204:207]
    ds_read_b64_tr_b16 a[30:31], v6 offset:6144
    s_waitcnt lgkmcnt(8)
    v_mfma_f32_16x16x32_bf16 v[184:187], a[8:11], v[136:139], v[184:187]
    ds_read_b64_tr_b16 a[0:1], v3 offset:128
    v_cvt_pk_bf16_f32 v61, v178, v179
    v_mfma_f32_16x16x32_bf16 v[188:191], a[12:15], v[136:139], v[188:191]
    v_exp_f32 v183, v183
    v_mfma_f32_16x16x32_bf16 v[196:199], a[12:15], v[140:143], v[196:199]
    ds_read_b64_tr_b16 a[2:3], v3 offset:6272
    v_add_f32 v7, v7, v166
    v_mfma_f32_16x16x32_bf16 v[192:195], a[8:11], v[140:143], v[192:195]
    ds_read_b64_tr_b16 a[4:5], v4 offset:128
    v_cvt_pk_bf16_f32 v62, v180, v181
    v_mfma_f32_16x16x32_bf16 v[200:203], a[8:11], v[144:147], v[200:203]
    v_cvt_pk_bf16_f32 v63, v182, v183
    v_add_f32 v7, v7, v167
    v_mfma_f32_16x16x32_bf16 v[204:207], a[12:15], v[144:147], v[204:207]
    ds_read_b64_tr_b16 a[6:7], v4 offset:6272
    s_waitcnt lgkmcnt(8)
    v_mfma_f32_16x16x32_bf16 a[32:35], a[16:19], v[52:55], a[32:35]
    ds_read_b64_tr_b16 a[8:9], v5 offset:128
    v_add_f32 v8, v8, v168
    v_mfma_f32_16x16x32_bf16 a[44:47], a[20:23], v[52:55], a[44:47]
    v_add_f32 v8, v8, v169
    v_mfma_f32_16x16x32_bf16 a[48:51], a[20:23], v[56:59], a[48:51]
    ds_read_b64_tr_b16 a[10:11], v5 offset:6272
    v_add_f32 v8, v8, v170
    v_mfma_f32_16x16x32_bf16 a[36:39], a[16:19], v[56:59], a[36:39]
    ds_read_b64_tr_b16 a[12:13], v6 offset:128
    v_add_f32 v8, v8, v171
    v_mfma_f32_16x16x32_bf16 a[40:43], a[16:19], v[60:63], a[40:43]
    s_waitcnt vmcnt(4)
    buffer_load_dwordx4 v247, s[12:15], s38 offen offset:3072 nt lds
    v_add_f32 v8, v8, v172
    v_mfma_f32_16x16x32_bf16 a[52:55], a[20:23], v[60:63], a[52:55]
    ds_read_b64_tr_b16 a[14:15], v6 offset:6272
    s_waitcnt lgkmcnt(8)
    v_mfma_f32_16x16x32_bf16 a[64:67], a[24:27], v[60:63], a[64:67]
    ds_read_b64_tr_b16 a[16:17], v3 offset:256
    v_add_f32 v8, v8, v173
    v_mfma_f32_16x16x32_bf16 a[76:79], a[28:31], v[60:63], a[76:79]
    v_exp_f32 v184, v184
    v_mfma_f32_16x16x32_bf16 a[72:75], a[28:31], v[56:59], a[72:75]
    ds_read_b64_tr_b16 a[18:19], v3 offset:6400
    v_mfma_f32_16x16x32_bf16 a[60:63], a[24:27], v[56:59], a[60:63]
    ds_read_b64_tr_b16 a[20:21], v4 offset:256
    v_exp_f32 v185, v185
    v_mfma_f32_16x16x32_bf16 a[56:59], a[24:27], v[52:55], a[56:59]
    v_exp_f32 v186, v186
    v_mfma_f32_16x16x32_bf16 a[68:71], a[28:31], v[52:55], a[68:71]
    ds_read_b64_tr_b16 a[22:23], v4 offset:6400
    s_waitcnt lgkmcnt(8)
    v_mfma_f32_16x16x32_bf16 a[80:83], a[0:3], v[52:55], a[80:83]
    ds_read_b64_tr_b16 a[24:25], v5 offset:256
    v_add_f32 v8, v8, v174
    v_mfma_f32_16x16x32_bf16 a[92:95], a[4:7], v[52:55], a[92:95]
    v_exp_f32 v187, v187
    v_mfma_f32_16x16x32_bf16 a[96:99], a[4:7], v[56:59], a[96:99]
    ds_read_b64_tr_b16 a[26:27], v5 offset:6400
    v_add_f32 v8, v8, v175
    v_mfma_f32_16x16x32_bf16 a[84:87], a[0:3], v[56:59], a[84:87]
    ds_read_b64_tr_b16 a[28:29], v6 offset:256
    v_add_f32 v9, v9, v176
    v_mfma_f32_16x16x32_bf16 a[88:91], a[0:3], v[60:63], a[88:91]
    s_add_u32 m0, s42, 28672
    v_add_f32 v9, v9, v177
    v_mfma_f32_16x16x32_bf16 a[100:103], a[4:7], v[60:63], a[100:103]
    ds_read_b64_tr_b16 a[30:31], v6 offset:6400
    s_waitcnt vmcnt(4)
    buffer_load_dwordx4 v248, s[12:15], s38 offen offset:0 nt lds
    s_waitcnt lgkmcnt(8)
    v_mfma_f32_16x16x32_bf16 a[112:115], a[8:11], v[60:63], a[112:115]
    ds_read_b128 a[0:3], v1 offset:24576
    v_mfma_f32_16x16x32_bf16 a[124:127], a[12:15], v[60:63], a[124:127]
    v_exp_f32 v188, v188
    v_mfma_f32_16x16x32_bf16 a[120:123], a[12:15], v[56:59], a[120:123]
    v_exp_f32 v189, v189
    v_mfma_f32_16x16x32_bf16 a[108:111], a[8:11], v[56:59], a[108:111]
    ds_read_b128 a[4:7], v1 offset:30720
    v_add_f32 v9, v9, v178
    v_mfma_f32_16x16x32_bf16 a[104:107], a[8:11], v[52:55], a[104:107]
    v_exp_f32 v190, v190
    v_mfma_f32_16x16x32_bf16 a[116:119], a[12:15], v[52:55], a[116:119]
    v_add_f32 v9, v9, v179
    s_waitcnt lgkmcnt(6)
    v_mfma_f32_16x16x32_bf16 a[128:131], a[16:19], v[52:55], a[128:131]
    ds_read_b128 a[8:11], v2 offset:24576
    v_add_f32 v9, v9, v180
    v_mfma_f32_16x16x32_bf16 a[140:143], a[20:23], v[52:55], a[140:143]
    v_exp_f32 v191, v191
    v_mfma_f32_16x16x32_bf16 a[144:147], a[20:23], v[56:59], a[144:147]
    v_exp_f32 v192, v192
    v_mfma_f32_16x16x32_bf16 a[132:135], a[16:19], v[56:59], a[132:135]
    ds_read_b128 a[12:15], v2 offset:30720
    v_exp_f32 v193, v193
    v_mfma_f32_16x16x32_bf16 a[136:139], a[16:19], v[60:63], a[136:139]
    v_exp_f32 v194, v194
    v_mfma_f32_16x16x32_bf16 a[148:151], a[20:23], v[60:63], a[148:151]
    v_add_f32 v9, v9, v181
    s_waitcnt lgkmcnt(4)
    v_mfma_f32_16x16x32_bf16 a[160:163], a[24:27], v[60:63], a[160:163]
    ds_read_b128 a[16:19], v1 offset:24704
    s_waitcnt vmcnt(4)
    buffer_load_dwordx4 v249, s[12:15], s38 offen offset:1024 nt lds
    v_mfma_f32_16x16x32_bf16 a[172:175], a[28:31], v[60:63], a[172:175]
    s_add_u32 s38, s38, 12288
    v_mfma_f32_16x16x32_bf16 a[168:171], a[28:31], v[56:59], a[168:171]
    v_exp_f32 v195, v195
    v_mfma_f32_16x16x32_bf16 a[156:159], a[24:27], v[56:59], a[156:159]
    ds_read_b128 a[20:23], v1 offset:30848
    v_add_f32 v9, v9, v182
    v_mfma_f32_16x16x32_bf16 a[152:155], a[24:27], v[52:55], a[152:155]
    v_exp_f32 v196, v196
    v_mfma_f32_16x16x32_bf16 a[164:167], a[28:31], v[52:55], a[164:167]
    v_add_f32 v9, v9, v183
    s_waitcnt lgkmcnt(4)
    v_mfma_f32_16x16x32_bf16 v[160:163], a[0:3], v[16:19], v[28:31]
    ds_read_b128 a[24:27], v2 offset:24704
    v_cvt_pk_bf16_f32 v52, v184, v185
    v_mfma_f32_16x16x32_bf16 v[164:167], a[4:7], v[16:19], v[28:31]
    s_add_u32 m0, s36, 0
    v_add_f32 v7, v7, v184
    v_mfma_f32_16x16x32_bf16 v[172:175], a[4:7], v[20:23], v[32:35]
    s_waitcnt vmcnt(4)
    buffer_load_dwordx4 v244, s[12:15], s38 offen offset:0 nt lds
    v_cvt_pk_bf16_f32 v53, v186, v187
    v_mfma_f32_16x16x32_bf16 v[168:171], a[0:3], v[20:23], v[32:35]
    ds_read_b128 a[28:31], v2 offset:30848
    v_add_f32 v7, v7, v185
    v_mfma_f32_16x16x32_bf16 v[176:179], a[0:3], v[24:27], v[36:39]
    v_exp_f32 v197, v197
    v_mfma_f32_16x16x32_bf16 v[180:183], a[4:7], v[24:27], v[36:39]
    v_cvt_pk_bf16_f32 v54, v188, v189
    s_waitcnt lgkmcnt(4)
    v_mfma_f32_16x16x32_bf16 v[160:163], a[8:11], v[40:43], v[160:163]
    ds_read_b128 a[0:3], v1 offset:24832
    v_add_f32 v7, v7, v186
    v_mfma_f32_16x16x32_bf16 v[164:167], a[12:15], v[40:43], v[164:167]
    v_exp_f32 v198, v198
    v_mfma_f32_16x16x32_bf16 v[172:175], a[12:15], v[44:47], v[172:175]
    v_exp_f32 v199, v199
    v_mfma_f32_16x16x32_bf16 v[168:171], a[8:11], v[44:47], v[168:171]
    ds_read_b128 a[4:7], v1 offset:30976
    v_exp_f32 v200, v200
    v_mfma_f32_16x16x32_bf16 v[176:179], a[8:11], v[48:51], v[176:179]
    s_waitcnt vmcnt(4)
    buffer_load_dwordx4 v245, s[12:15], s38 offen offset:1024 nt lds
    v_cvt_pk_bf16_f32 v55, v190, v191
    v_mfma_f32_16x16x32_bf16 v[180:183], a[12:15], v[48:51], v[180:183]
    v_add_f32 v7, v7, v187
    s_waitcnt lgkmcnt(4)
    v_mfma_f32_16x16x32_bf16 v[160:163], a[16:19], v[64:67], v[160:163]
    ds_read_b128 a[8:11], v2 offset:24832
    v_cvt_pk_bf16_f32 v56, v192, v193
    v_mfma_f32_16x16x32_bf16 v[164:167], a[20:23], v[64:67], v[164:167]
    v_exp_f32 v201, v201
    v_mfma_f32_16x16x32_bf16 v[172:175], a[20:23], v[68:71], v[172:175]
    v_exp_f32 v202, v202
    v_mfma_f32_16x16x32_bf16 v[168:171], a[16:19], v[68:71], v[168:171]
    ds_read_b128 a[12:15], v2 offset:30976
    v_add_f32 v7, v7, v188
    v_mfma_f32_16x16x32_bf16 v[176:179], a[16:19], v[72:75], v[176:179]
    v_exp_f32 v203, v203
    v_mfma_f32_16x16x32_bf16 v[180:183], a[20:23], v[72:75], v[180:183]
    v_cvt_pk_bf16_f32 v57, v194, v195
    s_waitcnt lgkmcnt(4)
    v_mfma_f32_16x16x32_bf16 v[160:163], a[24:27], v[88:91], v[160:163]
    ds_read_b64_tr_b16 a[16:17], v3 offset:24576
    v_add_f32 v7, v7, v189
    v_mfma_f32_16x16x32_bf16 v[164:167], a[28:31], v[88:91], v[164:167]
    s_waitcnt vmcnt(4)
    buffer_load_dwordx4 v246, s[12:15], s38 offen offset:2048 nt lds
    v_cvt_pk_bf16_f32 v58, v196, v197
    v_mfma_f32_16x16x32_bf16 v[172:175], a[28:31], v[92:95], v[172:175]
    ds_read_b64_tr_b16 a[18:19], v3 offset:30720
    v_add_f32 v7, v7, v190
    v_mfma_f32_16x16x32_bf16 v[168:171], a[24:27], v[92:95], v[168:171]
    ds_read_b64_tr_b16 a[20:21], v4 offset:24576
    v_cvt_pk_bf16_f32 v59, v198, v199
    v_mfma_f32_16x16x32_bf16 v[176:179], a[24:27], v[96:99], v[176:179]
    v_exp_f32 v204, v204
    v_mfma_f32_16x16x32_bf16 v[180:183], a[28:31], v[96:99], v[180:183]
    ds_read_b64_tr_b16 a[22:23], v4 offset:30720
    s_waitcnt lgkmcnt(6)
    v_mfma_f32_16x16x32_bf16 v[160:163], a[0:3], v[112:115], v[160:163]
    ds_read_b64_tr_b16 a[24:25], v5 offset:24576
    v_exp_f32 v205, v205
    v_mfma_f32_16x16x32_bf16 v[164:167], a[4:7], v[112:115], v[164:167]
    v_exp_f32 v206, v206
    v_mfma_f32_16x16x32_bf16 v[172:175], a[4:7], v[116:119], v[172:175]
    ds_read_b64_tr_b16 a[26:27], v5 offset:30720
    v_add_f32 v7, v7, v191
    v_mfma_f32_16x16x32_bf16 v[168:171], a[0:3], v[116:119], v[168:171]
    ds_read_b64_tr_b16 a[28:29], v6 offset:24576
    v_cvt_pk_bf16_f32 v60, v200, v201
    v_mfma_f32_16x16x32_bf16 v[176:179], a[0:3], v[120:123], v[176:179]
    s_waitcnt vmcnt(4)
    buffer_load_dwordx4 v247, s[12:15], s38 offen offset:3072 nt lds
    v_add_f32 v8, v8, v192
    v_mfma_f32_16x16x32_bf16 v[180:183], a[4:7], v[120:123], v[180:183]
    ds_read_b64_tr_b16 a[30:31], v6 offset:30720
    s_waitcnt lgkmcnt(8)
    v_mfma_f32_16x16x32_bf16 v[160:163], a[8:11], v[136:139], v[160:163]
    ds_read_b64_tr_b16 a[0:1], v3 offset:24704
    v_cvt_pk_bf16_f32 v61, v202, v203
    v_mfma_f32_16x16x32_bf16 v[164:167], a[12:15], v[136:139], v[164:167]
    v_exp_f32 v207, v207
    v_mfma_f32_16x16x32_bf16 v[172:175], a[12:15], v[140:143], v[172:175]
    ds_read_b64_tr_b16 a[2:3], v3 offset:30848
    v_add_f32 v8, v8, v193
    v_mfma_f32_16x16x32_bf16 v[168:171], a[8:11], v[140:143], v[168:171]
    ds_read_b64_tr_b16 a[4:5], v4 offset:24704
    v_cvt_pk_bf16_f32 v62, v204, v205
    v_mfma_f32_16x16x32_bf16 v[176:179], a[8:11], v[144:147], v[176:179]
    v_cvt_pk_bf16_f32 v63, v206, v207
    v_add_f32 v8, v8, v194
    v_mfma_f32_16x16x32_bf16 v[180:183], a[12:15], v[144:147], v[180:183]
    ds_read_b64_tr_b16 a[6:7], v4 offset:30848
    s_waitcnt lgkmcnt(8)
    v_mfma_f32_16x16x32_bf16 a[32:35], a[16:19], v[52:55], a[32:35]
    ds_read_b64_tr_b16 a[8:9], v5 offset:24704
    s_add_u32 m0, s36, 4096
    v_mfma_f32_16x16x32_bf16 a[44:47], a[20:23], v[52:55], a[44:47]
    s_waitcnt vmcnt(4)
    buffer_load_dwordx4 v248, s[12:15], s38 offen offset:0 nt lds
    v_add_f32 v8, v8, v195
    v_mfma_f32_16x16x32_bf16 a[48:51], a[20:23], v[56:59], a[48:51]
    ds_read_b64_tr_b16 a[10:11], v5 offset:30848
    v_add_f32 v8, v8, v196
    v_mfma_f32_16x16x32_bf16 a[36:39], a[16:19], v[56:59], a[36:39]
    ds_read_b64_tr_b16 a[12:13], v6 offset:24704
    v_add_f32 v8, v8, v197
    v_mfma_f32_16x16x32_bf16 a[40:43], a[16:19], v[60:63], a[40:43]
    v_exp_f32 v160, v160
    v_mfma_f32_16x16x32_bf16 a[52:55], a[20:23], v[60:63], a[52:55]
    ds_read_b64_tr_b16 a[14:15], v6 offset:30848
    s_waitcnt lgkmcnt(8)
    v_mfma_f32_16x16x32_bf16 a[64:67], a[24:27], v[60:63], a[64:67]
    ds_read_b64_tr_b16 a[16:17], v3 offset:24832
    v_exp_f32 v161, v161
    v_mfma_f32_16x16x32_bf16 a[76:79], a[28:31], v[60:63], a[76:79]
    v_exp_f32 v162, v162
    v_mfma_f32_16x16x32_bf16 a[72:75], a[28:31], v[56:59], a[72:75]
    ds_read_b64_tr_b16 a[18:19], v3 offset:30976
    v_add_f32 v8, v8, v198
    v_mfma_f32_16x16x32_bf16 a[60:63], a[24:27], v[56:59], a[60:63]
    ds_read_b64_tr_b16 a[20:21], v4 offset:24832
    v_add_f32 v8, v8, v199
    v_mfma_f32_16x16x32_bf16 a[56:59], a[24:27], v[52:55], a[56:59]
    s_waitcnt vmcnt(4)
    buffer_load_dwordx4 v249, s[12:15], s38 offen offset:1024 nt lds
    v_add_f32 v9, v9, v200
    v_mfma_f32_16x16x32_bf16 a[68:71], a[28:31], v[52:55], a[68:71]
    ds_read_b64_tr_b16 a[22:23], v4 offset:30976
    s_add_u32 s38, s38, 12288
    s_waitcnt lgkmcnt(8)
    v_mfma_f32_16x16x32_bf16 a[80:83], a[0:3], v[52:55], a[80:83]
    ds_read_b64_tr_b16 a[24:25], v5 offset:24832
    s_sub_u32 s46, s42, s47
    v_mfma_f32_16x16x32_bf16 a[92:95], a[4:7], v[52:55], a[92:95]
    s_mov_b32 s42, s36
    v_add_f32 v9, v9, v201
    v_mfma_f32_16x16x32_bf16 a[96:99], a[4:7], v[56:59], a[96:99]
    ds_read_b64_tr_b16 a[26:27], v5 offset:30976
    v_add_f32 v9, v9, v202
    v_mfma_f32_16x16x32_bf16 a[84:87], a[0:3], v[56:59], a[84:87]
    ds_read_b64_tr_b16 a[28:29], v6 offset:24832
    s_mov_b32 s36, s47
    v_mfma_f32_16x16x32_bf16 a[88:91], a[0:3], v[60:63], a[88:91]
    s_add_u32 s47, s47, s46
    v_add_f32 v9, v9, v203
    v_mfma_f32_16x16x32_bf16 a[100:103], a[4:7], v[60:63], a[100:103]
    ds_read_b64_tr_b16 a[30:31], v6 offset:30976
    s_waitcnt lgkmcnt(8)
    v_mfma_f32_16x16x32_bf16 a[112:115], a[8:11], v[60:63], a[112:115]
    v_add_u32 v1, s46, v1
    v_add_u32 v2, s46, v2
    v_mfma_f32_16x16x32_bf16 a[124:127], a[12:15], v[60:63], a[124:127]
    v_exp_f32 v163, v163
    v_exp_f32 v164, v164
    v_mfma_f32_16x16x32_bf16 a[120:123], a[12:15], v[56:59], a[120:123]
    v_add_u32 v3, s46, v3
    v_add_u32 v4, s46, v4
    v_mfma_f32_16x16x32_bf16 a[108:111], a[8:11], v[56:59], a[108:111]
    v_add_u32 v5, s46, v5
    v_add_u32 v6, s46, v6
    v_mfma_f32_16x16x32_bf16 a[104:107], a[8:11], v[52:55], a[104:107]
    v_exp_f32 v165, v165
    v_mfma_f32_16x16x32_bf16 a[116:119], a[12:15], v[52:55], a[116:119]
    s_waitcnt vmcnt(6) lgkmcnt(0)
    s_barrier
    v_mfma_f32_16x16x32_bf16 a[128:131], a[16:19], v[52:55], a[128:131]
    ds_read_b128 a[0:3], v1 offset:0
    ds_read_b128 a[4:7], v1 offset:6144
    v_mfma_f32_16x16x32_bf16 a[140:143], a[20:23], v[52:55], a[140:143]
    v_exp_f32 v166, v166
    v_mfma_f32_16x16x32_bf16 a[144:147], a[20:23], v[56:59], a[144:147]
    ds_read_b128 a[8:11], v2 offset:0
    v_add_f32 v9, v9, v204
    v_mfma_f32_16x16x32_bf16 a[132:135], a[16:19], v[56:59], a[132:135]
    ds_read_b128 a[12:15], v2 offset:6144
    v_add_f32 v9, v9, v205
    v_mfma_f32_16x16x32_bf16 a[136:139], a[16:19], v[60:63], a[136:139]
    v_exp_f32 v167, v167
    v_mfma_f32_16x16x32_bf16 a[148:151], a[20:23], v[60:63], a[148:151]
    v_exp_f32 v168, v168
    v_mfma_f32_16x16x32_bf16 a[160:163], a[24:27], v[60:63], a[160:163]
    ds_read_b128 a[16:19], v1 offset:128
    v_exp_f32 v169, v169
    v_mfma_f32_16x16x32_bf16 a[172:175], a[28:31], v[60:63], a[172:175]
    v_exp_f32 v170, v170
    v_mfma_f32_16x16x32_bf16 a[168:171], a[28:31], v[56:59], a[168:171]
    v_exp_f32 v171, v171
    v_mfma_f32_16x16x32_bf16 a[156:159], a[24:27], v[56:59], a[156:159]
    ds_read_b128 a[20:23], v1 offset:6272
    v_add_f32 v9, v9, v206
    v_mfma_f32_16x16x32_bf16 a[152:155], a[24:27], v[52:55], a[152:155]
    v_exp_f32 v172, v172
    v_mfma_f32_16x16x32_bf16 a[164:167], a[28:31], v[52:55], a[164:167]
    v_add_f32 v9, v9, v207
    s_sub_u32 s41, s41, 1
    s_cmp_lg_u32 s41, 0
    s_cbranch_scc1 L_att_loop
L_tail_begin:
    s_waitcnt lgkmcnt(4)
    v_mfma_f32_16x16x32_bf16 v[184:187], a[0:3], v[16:19], v[28:31]
    ds_read_b128 a[24:27], v2 offset:128
    v_cvt_pk_bf16_f32 v52, v160, v161
    v_mfma_f32_16x16x32_bf16 v[188:191], a[4:7], v[16:19], v[28:31]
    s_add_u32 m0, s42, 24576
    v_add_f32 v7, v7, v160
    v_mfma_f32_16x16x32_bf16 v[196:199], a[4:7], v[20:23], v[32:35]
    buffer_load_dwordx4 v244, s[12:15], s38 offen offset:0 nt lds
    v_cvt_pk_bf16_f32 v53, v162, v163
    v_mfma_f32_16x16x32_bf16 v[192:195], a[0:3], v[20:23], v[32:35]
    ds_read_b128 a[28:31], v2 offset:6272
    v_cvt_pk_bf16_f32 v54, v164, v165
    v_mfma_f32_16x16x32_bf16 v[200:203], a[0:3], v[24:27], v[36:39]
    v_exp_f32 v173, v173
    v_mfma_f32_16x16x32_bf16 v[204:207], a[4:7], v[24:27], v[36:39]
    v_add_f32 v7, v7, v161
    s_waitcnt lgkmcnt(4)
    v_mfma_f32_16x16x32_bf16 v[184:187], a[8:11], v[40:43], v[184:187]
    ds_read_b128 a[0:3], v1 offset:256
    v_cvt_pk_bf16_f32 v55, v166, v167
    v_mfma_f32_16x16x32_bf16 v[188:191], a[12:15], v[40:43], v[188:191]
    v_exp_f32 v174, v174
    v_mfma_f32_16x16x32_bf16 v[196:199], a[12:15], v[44:47], v[196:199]
    v_exp_f32 v175, v175
    v_mfma_f32_16x16x32_bf16 v[192:195], a[8:11], v[44:47], v[192:195]
    ds_read_b128 a[4:7], v1 offset:6400
    v_add_f32 v7, v7, v162
    v_mfma_f32_16x16x32_bf16 v[200:203], a[8:11], v[48:51], v[200:203]
    buffer_load_dwordx4 v245, s[12:15], s38 offen offset:1024 nt lds
    v_cvt_pk_bf16_f32 v56, v168, v169
    v_mfma_f32_16x16x32_bf16 v[204:207], a[12:15], v[48:51], v[204:207]
    v_cvt_pk_bf16_f32 v57, v170, v171
    s_waitcnt lgkmcnt(4)
    v_mfma_f32_16x16x32_bf16 v[184:187], a[16:19], v[64:67], v[184:187]
    ds_read_b128 a[8:11], v2 offset:256
    v_add_f32 v7, v7, v163
    v_mov_b32 v100, 98304
    v_mfma_f32_16x16x32_bf16 v[188:191], a[20:23], v[64:67], v[188:191]
    v_exp_f32 v176, v176
    v_mfma_f32_16x16x32_bf16 v[196:199], a[20:23], v[68:71], v[196:199]
    v_exp_f32 v177, v177
    v_mfma_f32_16x16x32_bf16 v[192:195], a[16:19], v[68:71], v[192:195]
    ds_read_b128 a[12:15], v2 offset:6400
    v_cvt_pk_bf16_f32 v58, v172, v173
    v_mfma_f32_16x16x32_bf16 v[200:203], a[16:19], v[72:75], v[200:203]
    v_exp_f32 v178, v178
    v_mfma_f32_16x16x32_bf16 v[204:207], a[20:23], v[72:75], v[204:207]
    v_cvt_pk_bf16_f32 v59, v174, v175
    s_waitcnt lgkmcnt(4)
    v_mfma_f32_16x16x32_bf16 v[184:187], a[24:27], v[88:91], v[184:187]
    ds_read_b64_tr_b16 a[16:17], v3 offset:0
    buffer_load_dwordx4 v246, s[12:15], s38 offen offset:2048 nt lds
    v_add_f32 v7, v7, v164
    v_mfma_f32_16x16x32_bf16 v[188:191], a[28:31], v[88:91], v[188:191]
    v_exp_f32 v179, v179
    v_mfma_f32_16x16x32_bf16 v[196:199], a[28:31], v[92:95], v[196:199]
    ds_read_b64_tr_b16 a[18:19], v3 offset:6144
    v_add_f32 v7, v7, v165
    v_mfma_f32_16x16x32_bf16 v[192:195], a[24:27], v[92:95], v[192:195]
    ds_read_b64_tr_b16 a[20:21], v4 offset:0
    v_cvt_pk_bf16_f32 v60, v176, v177
    v_mfma_f32_16x16x32_bf16 v[200:203], a[24:27], v[96:99], v[200:203]
    v_exp_f32 v180, v180
    v_mfma_f32_16x16x32_bf16 v[204:207], a[28:31], v[96:99], v[204:207]
    ds_read_b64_tr_b16 a[22:23], v4 offset:6144
    s_waitcnt lgkmcnt(6)
    v_mfma_f32_16x16x32_bf16 v[184:187], a[0:3], v[112:115], v[184:187]
    ds_read_b64_tr_b16 a[24:25], v5 offset:0
    v_add_f32 v7, v7, v166
    v_mfma_f32_16x16x32_bf16 v[188:191], a[4:7], v[112:115], v[188:191]
    v_exp_f32 v181, v181
    v_mfma_f32_16x16x32_bf16 v[196:199], a[4:7], v[116:119], v[196:199]
    ds_read_b64_tr_b16 a[26:27], v5 offset:6144
    buffer_load_dwordx4 v247, s[12:15], s38 offen offset:3072 nt lds
    v_mfma_f32_16x16x32_bf16 v[192:195], a[0:3], v[116:119], v[192:195]
    ds_read_b64_tr_b16 a[28:29], v6 offset:0
    v_cvt_pk_bf16_f32 v61, v178, v179
    v_mfma_f32_16x16x32_bf16 v[200:203], a[0:3], v[120:123], v[200:203]
    v_exp_f32 v182, v182
    v_mfma_f32_16x16x32_bf16 v[204:207], a[4:7], v[120:123], v[204:207]
    ds_read_b64_tr_b16 a[30:31], v6 offset:6144
    s_waitcnt lgkmcnt(8)
    v_mfma_f32_16x16x32_bf16 v[184:187], a[8:11], v[136:139], v[184:187]
    ds_read_b64_tr_b16 a[0:1], v3 offset:128
    v_cvt_pk_bf16_f32 v62, v180, v181
    v_mfma_f32_16x16x32_bf16 v[188:191], a[12:15], v[136:139], v[188:191]
    v_exp_f32 v183, v183
    v_mfma_f32_16x16x32_bf16 v[196:199], a[12:15], v[140:143], v[196:199]
    ds_read_b64_tr_b16 a[2:3], v3 offset:6272
    v_add_f32 v7, v7, v167
    v_mfma_f32_16x16x32_bf16 v[192:195], a[8:11], v[140:143], v[192:195]
    ds_read_b64_tr_b16 a[4:5], v4 offset:128
    s_add_u32 m0, s42, 28672
    v_mfma_f32_16x16x32_bf16 v[200:203], a[8:11], v[144:147], v[200:203]
    buffer_load_dwordx4 v248, s[12:15], s38 offen offset:0 nt lds
    v_cvt_pk_bf16_f32 v63, v182, v183
    v_mfma_f32_16x16x32_bf16 v[204:207], a[12:15], v[144:147], v[204:207]
    ds_read_b64_tr_b16 a[6:7], v4 offset:6272
    s_waitcnt lgkmcnt(8)
    v_mfma_f32_16x16x32_bf16 a[32:35], a[16:19], v[52:55], a[32:35]
    ds_read_b64_tr_b16 a[8:9], v5 offset:128
    v_add_f32 v8, v8, v168
    v_mov_b32 v101, 0
    v_mfma_f32_16x16x32_bf16 a[44:47], a[20:23], v[52:55], a[44:47]
    v_add_f32 v8, v8, v169
    v_add_f32 v8, v8, v170
    v_mfma_f32_16x16x32_bf16 a[48:51], a[20:23], v[56:59], a[48:51]
    ds_read_b64_tr_b16 a[10:11], v5 offset:6272
    v_add_f32 v8, v8, v171
    v_mfma_f32_16x16x32_bf16 a[36:39], a[16:19], v[56:59], a[36:39]
    ds_read_b64_tr_b16 a[12:13], v6 offset:128
    v_add_f32 v8, v8, v172
    v_mfma_f32_16x16x32_bf16 a[40:43], a[16:19], v[60:63], a[40:43]
    v_exp_f32 v184, v184
    v_mfma_f32_16x16x32_bf16 a[52:55], a[20:23], v[60:63], a[52:55]
    ds_read_b64_tr_b16 a[14:15], v6 offset:6272
    s_waitcnt lgkmcnt(8)
    v_mfma_f32_16x16x32_bf16 a[64:67], a[24:27], v[60:63], a[64:67]
    ds_read_b64_tr_b16 a[16:17], v3 offset:256
    buffer_load_dwordx4 v249, s[12:15], s38 offen offset:1024 nt lds
    v_mfma_f32_16x16x32_bf16 a[76:79], a[28:31], v[60:63], a[76:79]
    s_add_u32 s38, s38, 12288
    v_exp_f32 v185, v185
    v_mfma_f32_16x16x32_bf16 a[72:75], a[28:31], v[56:59], a[72:75]
    ds_read_b64_tr_b16 a[18:19], v3 offset:6400
    s_bfe_u32 s48, s50, 0x50000
    v_mfma_f32_16x16x32_bf16 a[60:63], a[24:27], v[56:59], a[60:63]
    ds_read_b64_tr_b16 a[20:21], v4 offset:256
    s_add_u32 s48, s48, s51
    v_mfma_f32_16x16x32_bf16 a[56:59], a[24:27], v[52:55], a[56:59]
    s_cmp_ge_u32 s48, 24
    s_cselect_b32 s52, 24, 0
    v_add_f32 v8, v8, v173
    v_mfma_f32_16x16x32_bf16 a[68:71], a[28:31], v[52:55], a[68:71]
    ds_read_b64_tr_b16 a[22:23], v4 offset:6400
    s_sub_u32 s48, s48, s52
    s_waitcnt lgkmcnt(8)
    v_mfma_f32_16x16x32_bf16 a[80:83], a[0:3], v[52:55], a[80:83]
    ds_read_b64_tr_b16 a[24:25], v5 offset:256
    s_mul_i32 s48, s48, 40960
    v_mfma_f32_16x16x32_bf16 a[92:95], a[4:7], v[52:55], a[92:95]
    s_add_u32 m0, s49, 122880
    v_add_f32 v8, v8, v174
    v_mfma_f32_16x16x32_bf16 a[96:99], a[4:7], v[56:59], a[96:99]
    ds_read_b64_tr_b16 a[26:27], v5 offset:6400
    buffer_load_dwordx4 v232, s[16:19], s48 offen offset:0 lds
    v_mfma_f32_16x16x32_bf16 a[84:87], a[0:3], v[56:59], a[84:87]
    ds_read_b64_tr_b16 a[28:29], v6 offset:256
    v_add_f32 v8, v8, v175
    v_mfma_f32_16x16x32_bf16 a[88:91], a[0:3], v[60:63], a[88:91]
    v_exp_f32 v186, v186
    v_mfma_f32_16x16x32_bf16 a[100:103], a[4:7], v[60:63], a[100:103]
    ds_read_b64_tr_b16 a[30:31], v6 offset:6400
    v_add_f32 v9, v9, v176
    s_waitcnt lgkmcnt(8)
    v_mfma_f32_16x16x32_bf16 a[112:115], a[8:11], v[60:63], a[112:115]
    ds_read_b128 a[0:3], v1 offset:24576
    v_exp_f32 v187, v187
    v_mfma_f32_16x16x32_bf16 a[124:127], a[12:15], v[60:63], a[124:127]
    v_exp_f32 v188, v188
    v_mfma_f32_16x16x32_bf16 a[120:123], a[12:15], v[56:59], a[120:123]
    v_exp_f32 v189, v189
    v_mfma_f32_16x16x32_bf16 a[108:111], a[8:11], v[56:59], a[108:111]
    ds_read_b128 a[4:7], v1 offset:30720
    v_add_f32 v9, v9, v177
    v_mfma_f32_16x16x32_bf16 a[104:107], a[8:11], v[52:55], a[104:107]
    buffer_load_dwordx4 v233, s[16:19], s48 offen offset:1024 lds
    v_add_f32 v9, v9, v178
    v_mfma_f32_16x16x32_bf16 a[116:119], a[12:15], v[52:55], a[116:119]
    v_add_f32 v9, v9, v179
    s_waitcnt lgkmcnt(6)
    v_mfma_f32_16x16x32_bf16 a[128:131], a[16:19], v[52:55], a[128:131]
    ds_read_b128 a[8:11], v2 offset:24576
    v_add_f32 v9, v9, v180
    ds_write_b32 v100, v101
    v_mfma_f32_16x16x32_bf16 a[140:143], a[20:23], v[52:55], a[140:143]
    v_exp_f32 v190, v190
    v_mfma_f32_16x16x32_bf16 a[144:147], a[20:23], v[56:59], a[144:147]
    v_exp_f32 v191, v191
    v_mfma_f32_16x16x32_bf16 a[132:135], a[16:19], v[56:59], a[132:135]
    ds_read_b128 a[12:15], v2 offset:30720
    v_add_f32 v9, v9, v181
    v_mfma_f32_16x16x32_bf16 a[136:139], a[16:19], v[60:63], a[136:139]
    v_exp_f32 v192, v192
    v_mfma_f32_16x16x32_bf16 a[148:151], a[20:23], v[60:63], a[148:151]
    v_exp_f32 v193, v193
    s_waitcnt lgkmcnt(5)
    v_mfma_f32_16x16x32_bf16 a[160:163], a[24:27], v[60:63], a[160:163]
    ds_read_b128 a[16:19], v1 offset:24704
    buffer_load_dwordx4 v234, s[16:19], s48 offen offset:2048 lds
    v_mfma_f32_16x16x32_bf16 a[172:175], a[28:31], v[60:63], a[172:175]
    v_exp_f32 v194, v194
    v_mfma_f32_16x16x32_bf16 a[168:171], a[28:31], v[56:59], a[168:171]
    v_exp_f32 v195, v195
    v_mfma_f32_16x16x32_bf16 a[156:159], a[24:27], v[56:59], a[156:159]
    ds_read_b128 a[20:23], v1 offset:30848
    v_add_f32 v9, v9, v182
    v_mfma_f32_16x16x32_bf16 a[152:155], a[24:27], v[52:55], a[152:155]
    v_exp_f32 v196, v196
    v_mfma_f32_16x16x32_bf16 a[164:167], a[28:31], v[52:55], a[164:167]
    v_add_f32 v9, v9, v183
    s_waitcnt lgkmcnt(5)
    v_mfma_f32_16x16x32_bf16 v[160:163], a[0:3], v[16:19], v[28:31]
    ds_read_b128 a[24:27], v2 offset:24704
    v_cvt_pk_bf16_f32 v52, v184, v185
    v_mfma_f32_16x16x32_bf16 v[164:167], a[4:7], v[16:19], v[28:31]
    v_exp_f32 v197, v197
    v_mfma_f32_16x16x32_bf16 v[172:175], a[4:7], v[20:23], v[32:35]
    buffer_load_dwordx4 v235, s[16:19], s48 offen offset:3072 lds
    v_add_f32 v7, v7, v184
    v_mfma_f32_16x16x32_bf16 v[168:171], a[0:3], v[20:23], v[32:35]
    ds_read_b128 a[28:31], v2 offset:30848
    v_cvt_pk_bf16_f32 v53, v186, v187
    v_mfma_f32_16x16x32_bf16 v[176:179], a[0:3], v[24:27], v[36:39]
    v_exp_f32 v198, v198
    v_mfma_f32_16x16x32_bf16 v[180:183], a[4:7], v[24:27], v[36:39]
    v_add_f32 v7, v7, v185
    s_waitcnt lgkmcnt(4)
    v_mfma_f32_16x16x32_bf16 v[160:163], a[8:11], v[40:43], v[160:163]
    ds_read_b128 a[0:3], v1 offset:24832
    v_cvt_pk_bf16_f32 v54, v188, v189
    v_mfma_f32_16x16x32_bf16 v[164:167], a[12:15], v[40:43], v[164:167]
    v_exp_f32 v199, v199
    v_mfma_f32_16x16x32_bf16 v[172:175], a[12:15], v[44:47], v[172:175]
    s_add_u32 m0, s49, 126976
    v_add_f32 v7, v7, v186
    v_mfma_f32_16x16x32_bf16 v[168:171], a[8:11], v[44:47], v[168:171]
    ds_read_b128 a[4:7], v1 offset:30976
    buffer_load_dwordx4 v236, s[16:19], s48 offen offset:0 lds
    v_mfma_f32_16x16x32_bf16 v[176:179], a[8:11], v[48:51], v[176:179]
    v_exp_f32 v200, v200
    v_mfma_f32_16x16x32_bf16 v[180:183], a[12:15], v[48:51], v[180:183]
    v_cvt_pk_bf16_f32 v55, v190, v191
    s_waitcnt lgkmcnt(4)
    v_mfma_f32_16x16x32_bf16 v[160:163], a[16:19], v[64:67], v[160:163]
    ds_read_b128 a[8:11], v2 offset:24832
    v_cvt_pk_bf16_f32 v56, v192, v193
    v_mfma_f32_16x16x32_bf16 v[164:167], a[20:23], v[64:67], v[164:167]
    v_exp_f32 v201, v201
    v_mfma_f32_16x16x32_bf16 v[172:175], a[20:23], v[68:71], v[172:175]
    v_exp_f32 v202, v202
    v_mfma_f32_16x16x32_bf16 v[168:171], a[16:19], v[68:71], v[168:171]
    ds_read_b128 a[12:15], v2 offset:30976
    v_add_f32 v7, v7, v187
    v_mfma_f32_16x16x32_bf16 v[176:179], a[16:19], v[72:75], v[176:179]
    buffer_load_dwordx4 v237, s[16:19], s48 offen offset:1024 lds
    v_exp_f32 v203, v203
    v_mfma_f32_16x16x32_bf16 v[180:183], a[20:23], v[72:75], v[180:183]
    v_cvt_pk_bf16_f32 v57, v194, v195
    s_waitcnt lgkmcnt(4)
    v_mfma_f32_16x16x32_bf16 v[160:163], a[24:27], v[88:91], v[160:163]
    ds_read_b64_tr_b16 a[16:17], v3 offset:24576
    v_add_f32 v7, v7, v188
    v_add_f32 v7, v7, v189
    v_mfma_f32_16x16x32_bf16 v[164:167], a[28:31], v[88:91], v[164:167]
    v_exp_f32 v204, v204
    v_mfma_f32_16x16x32_bf16 v[172:175], a[28:31], v[92:95], v[172:175]
    ds_read_b64_tr_b16 a[18:19], v3 offset:30720
    v_cvt_pk_bf16_f32 v58, v196, v197
    v_mfma_f32_16x16x32_bf16 v[168:171], a[24:27], v[92:95], v[168:171]
    ds_read_b64_tr_b16 a[20:21], v4 offset:24576
    v_add_f32 v7, v7, v190
    v_mfma_f32_16x16x32_bf16 v[176:179], a[24:27], v[96:99], v[176:179]
    v_exp_f32 v205, v205
    v_mfma_f32_16x16x32_bf16 v[180:183], a[28:31], v[96:99], v[180:183]
    ds_read_b64_tr_b16 a[22:23], v4 offset:30720
    s_waitcnt lgkmcnt(6)
    v_mfma_f32_16x16x32_bf16 v[160:163], a[0:3], v[112:115], v[160:163]
    ds_read_b64_tr_b16 a[24:25], v5 offset:24576
    buffer_load_dwordx4 v238, s[16:19], s48 offen offset:2048 lds
    v_mfma_f32_16x16x32_bf16 v[164:167], a[4:7], v[112:115], v[164:167]
    v_exp_f32 v206, v206
    v_mfma_f32_16x16x32_bf16 v[172:175], a[4:7], v[116:119], v[172:175]
    ds_read_b64_tr_b16 a[26:27], v5 offset:30720
    v_cvt_pk_bf16_f32 v59, v198, v199
    v_mfma_f32_16x16x32_bf16 v[168:171], a[0:3], v[116:119], v[168:171]
    ds_read_b64_tr_b16 a[28:29], v6 offset:24576
    v_cvt_pk_bf16_f32 v60, v200, v201
    v_mfma_f32_16x16x32_bf16 v[176:179], a[0:3], v[120:123], v[176:179]
    v_exp_f32 v207, v207
    v_mfma_f32_16x16x32_bf16 v[180:183], a[4:7], v[120:123], v[180:183]
    ds_read_b64_tr_b16 a[30:31], v6 offset:30720
    s_waitcnt lgkmcnt(8)
    v_mfma_f32_16x16x32_bf16 v[160:163], a[8:11], v[136:139], v[160:163]
    ds_read_b64_tr_b16 a[0:1], v3 offset:24704
    v_add_f32 v7, v7, v191
    v_mfma_f32_16x16x32_bf16 v[164:167], a[12:15], v[136:139], v[164:167]
    buffer_load_dwordx4 v239, s[16:19], s48 offen offset:3072 lds
    v_cvt_pk_bf16_f32 v61, v202, v203
    v_mfma_f32_16x16x32_bf16 v[172:175], a[12:15], v[140:143], v[172:175]
    ds_read_b64_tr_b16 a[2:3], v3 offset:30848
    v_add_f32 v8, v8, v192
    v_mfma_f32_16x16x32_bf16 v[168:171], a[8:11], v[140:143], v[168:171]
    ds_read_b64_tr_b16 a[4:5], v4 offset:24704
    v_cvt_pk_bf16_f32 v62, v204, v205
    v_mfma_f32_16x16x32_bf16 v[176:179], a[8:11], v[144:147], v[176:179]
    v_cvt_pk_bf16_f32 v63, v206, v207
    v_add_f32 v8, v8, v193
    v_mfma_f32_16x16x32_bf16 v[180:183], a[12:15], v[144:147], v[180:183]
    ds_read_b64_tr_b16 a[6:7], v4 offset:30848
    s_waitcnt lgkmcnt(8)
    v_mfma_f32_16x16x32_bf16 a[32:35], a[16:19], v[52:55], a[32:35]
    ds_read_b64_tr_b16 a[8:9], v5 offset:24704
    v_add_f32 v8, v8, v194
    v_mfma_f32_16x16x32_bf16 a[44:47], a[20:23], v[52:55], a[44:47]
    s_add_u32 m0, s49, 131072
    v_add_f32 v8, v8, v195
    v_mfma_f32_16x16x32_bf16 a[48:51], a[20:23], v[56:59], a[48:51]
    ds_read_b64_tr_b16 a[10:11], v5 offset:30848
    buffer_load_dwordx4 v240, s[16:19], s48 offen offset:0 lds
    v_mfma_f32_16x16x32_bf16 a[36:39], a[16:19], v[56:59], a[36:39]
    ds_read_b64_tr_b16 a[12:13], v6 offset:24704
    v_add_f32 v8, v8, v196
    v_mfma_f32_16x16x32_bf16 a[40:43], a[16:19], v[60:63], a[40:43]
    v_exp_f32 v160, v160
    v_mfma_f32_16x16x32_bf16 a[52:55], a[20:23], v[60:63], a[52:55]
    ds_read_b64_tr_b16 a[14:15], v6 offset:30848
    s_waitcnt lgkmcnt(8)
    v_mfma_f32_16x16x32_bf16 a[64:67], a[24:27], v[60:63], a[64:67]
    ds_read_b64_tr_b16 a[16:17], v3 offset:24832
    v_exp_f32 v161, v161
    v_mfma_f32_16x16x32_bf16 a[76:79], a[28:31], v[60:63], a[76:79]
    v_exp_f32 v162, v162
    v_mfma_f32_16x16x32_bf16 a[72:75], a[28:31], v[56:59], a[72:75]
    ds_read_b64_tr_b16 a[18:19], v3 offset:30976
    v_add_f32 v8, v8, v197
    v_mfma_f32_16x16x32_bf16 a[60:63], a[24:27], v[56:59], a[60:63]
    ds_read_b64_tr_b16 a[20:21], v4 offset:24832
    v_add_f32 v8, v8, v198
    v_mfma_f32_16x16x32_bf16 a[56:59], a[24:27], v[52:55], a[56:59]
    buffer_load_dwordx4 v241, s[16:19], s48 offen offset:1024 lds
    v_add_f32 v8, v8, v199
    v_mfma_f32_16x16x32_bf16 a[68:71], a[28:31], v[52:55], a[68:71]
    ds_read_b64_tr_b16 a[22:23], v4 offset:30976
    s_waitcnt lgkmcnt(8)
    v_mfma_f32_16x16x32_bf16 a[80:83], a[0:3], v[52:55], a[80:83]
    ds_read_b64_tr_b16 a[24:25], v5 offset:24832
    s_sub_u32 s46, s42, s47
    v_mfma_f32_16x16x32_bf16 a[92:95], a[4:7], v[52:55], a[92:95]
    s_mov_b32 s42, s36
    v_add_f32 v9, v9, v200
    v_mfma_f32_16x16x32_bf16 a[96:99], a[4:7], v[56:59], a[96:99]
    ds_read_b64_tr_b16 a[26:27], v5 offset:30976
    v_add_f32 v9, v9, v201
    v_mfma_f32_16x16x32_bf16 a[84:87], a[0:3], v[56:59], a[84:87]
    ds_read_b64_tr_b16 a[28:29], v6 offset:24832
    s_mov_b32 s36, s47
    v_mfma_f32_16x16x32_bf16 a[88:91], a[0:3], v[60:63], a[88:91]
    s_add_u32 s47, s47, s46
    v_add_f32 v9, v9, v202
    v_mfma_f32_16x16x32_bf16 a[100:103], a[4:7], v[60:63], a[100:103]
    ds_read_b64_tr_b16 a[30:31], v6 offset:30976
    s_waitcnt lgkmcnt(8)
    v_mfma_f32_16x16x32_bf16 a[112:115], a[8:11], v[60:63], a[112:115]
    v_add_u32 v1, s46, v1
    v_add_u32 v2, s46, v2
    v_add_f32 v9, v9, v203
    v_mfma_f32_16x16x32_bf16 a[124:127], a[12:15], v[60:63], a[124:127]
    v_exp_f32 v163, v163
    v_exp_f32 v164, v164
    v_mfma_f32_16x16x32_bf16 a[120:123], a[12:15], v[56:59], a[120:123]
    v_add_u32 v3, s46, v3
    v_add_u32 v4, s46, v4
    v_mfma_f32_16x16x32_bf16 a[108:111], a[8:11], v[56:59], a[108:111]
    v_add_u32 v5, s46, v5
    v_add_u32 v6, s46, v6
    v_mfma_f32_16x16x32_bf16 a[104:107], a[8:11], v[52:55], a[104:107]
    v_exp_f32 v165, v165
    v_mfma_f32_16x16x32_bf16 a[116:119], a[12:15], v[52:55], a[116:119]
    s_waitcnt lgkmcnt(0)
    s_waitcnt vmcnt(10)
    s_barrier
    v_mfma_f32_16x16x32_bf16 a[128:131], a[16:19], v[52:55], a[128:131]
    ds_read_b128 a[0:3], v1 offset:0
    ds_read_b128 a[4:7], v1 offset:6144
    v_mfma_f32_16x16x32_bf16 a[140:143], a[20:23], v[52:55], a[140:143]
    v_exp_f32 v166, v166
    v_mfma_f32_16x16x32_bf16 a[144:147], a[20:23], v[56:59], a[144:147]
    ds_read_b128 a[8:11], v2 offset:0
    v_add_f32 v9, v9, v204
    v_mfma_f32_16x16x32_bf16 a[132:135], a[16:19], v[56:59], a[132:135]
    ds_read_b128 a[12:15], v2 offset:6144
    v_add_f32 v9, v9, v205
    v_mfma_f32_16x16x32_bf16 a[136:139], a[16:19], v[60:63], a[136:139]
    v_exp_f32 v167, v167
    v_mfma_f32_16x16x32_bf16 a[148:151], a[20:23], v[60:63], a[148:151]
    v_exp_f32 v168, v168
    v_mfma_f32_16x16x32_bf16 a[160:163], a[24:27], v[60:63], a[160:163]
    ds_read_b128 a[16:19], v1 offset:128
    v_exp_f32 v169, v169
    v_mfma_f32_16x16x32_bf16 a[172:175], a[28:31], v[60:63], a[172:175]
    v_exp_f32 v170, v170
    v_mfma_f32_16x16x32_bf16 a[168:171], a[28:31], v[56:59], a[168:171]
    v_exp_f32 v171, v171
    v_mfma_f32_16x16x32_bf16 a[156:159], a[24:27], v[56:59], a[156:159]
    ds_read_b128 a[20:23], v1 offset:6272
    v_add_f32 v9, v9, v206
    v_mfma_f32_16x16x32_bf16 a[152:155], a[24:27], v[52:55], a[152:155]
    v_exp_f32 v172, v172
    v_mfma_f32_16x16x32_bf16 a[164:167], a[28:31], v[52:55], a[164:167]
    v_add_f32 v9, v9, v207
    s_waitcnt lgkmcnt(4)
    v_mfma_f32_16x16x32_bf16 v[184:187], a[0:3], v[16:19], v[28:31]
    ds_read_b128 a[24:27], v2 offset:128
    v_cvt_pk_bf16_f32 v52, v160, v161
    v_mfma_f32_16x16x32_bf16 v[188:191], a[4:7], v[16:19], v[28:31]
    v_exp_f32 v173, v173
    v_mfma_f32_16x16x32_bf16 v[196:199], a[4:7], v[20:23], v[32:35]
    buffer_load_dword v243, off, s[76:79], 0 sc1
    s_bfe_u32 s48, s50, 0x50005
    s_add_u32 s48, s48, s51
    s_cmp_ge_u32 s48, 24
    s_cselect_b32 s52, 24, 0
    v_mfma_f32_16x16x32_bf16 v[192:195], a[0:3], v[20:23], v[32:35]
    ds_read_b128 a[28:31], v2 offset:6272
    s_sub_u32 s48, s48, s52
    v_mfma_f32_16x16x32_bf16 v[200:203], a[0:3], v[24:27], v[36:39]
    s_mul_i32 s48, s48, 40960
    v_exp_f32 v174, v174
    v_mfma_f32_16x16x32_bf16 v[204:207], a[4:7], v[24:27], v[36:39]
    s_add_u32 m0, s49, 0
    s_waitcnt lgkmcnt(4)
    v_mfma_f32_16x16x32_bf16 v[184:187], a[8:11], v[40:43], v[184:187]
    ds_read_b128 a[0:3], v1 offset:256
    buffer_load_dwordx4 v232, s[16:19], s48 offen offset:0 lds
    v_mfma_f32_16x16x32_bf16 v[188:191], a[12:15], v[40:43], v[188:191]
    v_exp_f32 v175, v175
    v_add_f32 v7, v7, v160
    v_mfma_f32_16x16x32_bf16 v[196:199], a[12:15], v[44:47], v[196:199]
    v_exp_f32 v176, v176
    v_mfma_f32_16x16x32_bf16 v[192:195], a[8:11], v[44:47], v[192:195]
    ds_read_b128 a[4:7], v1 offset:6400
    v_add_f32 v7, v7, v161
    v_mfma_f32_16x16x32_bf16 v[200:203], a[8:11], v[48:51], v[200:203]
    buffer_load_dwordx4 v233, s[16:19], s48 offen offset:1024 lds
    v_cvt_pk_bf16_f32 v53, v162, v163
    v_mfma_f32_16x16x32_bf16 v[204:207], a[12:15], v[48:51], v[204:207]
    v_cvt_pk_bf16_f32 v54, v164, v165
    s_waitcnt lgkmcnt(4)
    v_mfma_f32_16x16x32_bf16 v[184:187], a[16:19], v[64:67], v[184:187]
    ds_read_b128 a[8:11], v2 offset:256
    v_cvt_pk_bf16_f32 v55, v166, v167
    v_mfma_f32_16x16x32_bf16 v[188:191], a[20:23], v[64:67], v[188:191]
    v_exp_f32 v177, v177
    v_mfma_f32_16x16x32_bf16 v[196:199], a[20:23], v[68:71], v[196:199]
    buffer_load_dwordx4 v234, s[16:19], s48 offen offset:2048 lds
    v_add_f32 v7, v7, v162
    v_mfma_f32_16x16x32_bf16 v[192:195], a[16:19], v[68:71], v[192:195]
    ds_read_b128 a[12:15], v2 offset:6400
    v_exp_f32 v178, v178
    v_mfma_f32_16x16x32_bf16 v[200:203], a[16:19], v[72:75], v[200:203]
    v_exp_f32 v179, v179
    v_mfma_f32_16x16x32_bf16 v[204:207], a[20:23], v[72:75], v[204:207]
    v_cvt_pk_bf16_f32 v56, v168, v169
    s_waitcnt lgkmcnt(4)
    v_mfma_f32_16x16x32_bf16 v[184:187], a[24:27], v[88:91], v[184:187]
    ds_read_b64_tr_b16 a[16:17], v3 offset:0
    buffer_load_dwordx4 v235, s[16:19], s48 offen offset:3072 lds
    v_mfma_f32_16x16x32_bf16 v[188:191], a[28:31], v[88:91], v[188:191]
    v_exp_f32 v180, v180
    v_mfma_f32_16x16x32_bf16 v[196:199], a[28:31], v[92:95], v[196:199]
    ds_read_b64_tr_b16 a[18:19], v3 offset:6144
    v_cvt_pk_bf16_f32 v57, v170, v171
    v_mfma_f32_16x16x32_bf16 v[192:195], a[24:27], v[92:95], v[192:195]
    ds_read_b64_tr_b16 a[20:21], v4 offset:0
    s_add_u32 m0, s49, 4096
    v_add_f32 v7, v7, v163
    v_mfma_f32_16x16x32_bf16 v[200:203], a[24:27], v[96:99], v[200:203]
    buffer_load_dwordx4 v236, s[16:19], s48 offen offset:0 lds
    v_cvt_pk_bf16_f32 v58, v172, v173
    v_mfma_f32_16x16x32_bf16 v[204:207], a[28:31], v[96:99], v[204:207]
    ds_read_b64_tr_b16 a[22:23], v4 offset:6144
    s_waitcnt lgkmcnt(6)
    v_mfma_f32_16x16x32_bf16 v[184:187], a[0:3], v[112:115], v[184:187]
    ds_read_b64_tr_b16 a[24:25], v5 offset:0
    v_add_f32 v7, v7, v164
    v_mfma_f32_16x16x32_bf16 v[188:191], a[4:7], v[112:115], v[188:191]
    v_exp_f32 v181, v181
    v_mfma_f32_16x16x32_bf16 v[196:199], a[4:7], v[116:119], v[196:199]
    ds_read_b64_tr_b16 a[26:27], v5 offset:6144
    v_exp_f32 v182, v182
    v_mfma_f32_16x16x32_bf16 v[192:195], a[0:3], v[116:119], v[192:195]
    ds_read_b64_tr_b16 a[28:29], v6 offset:0
    buffer_load_dwordx4 v237, s[16:19], s48 offen offset:1024 lds
    v_mfma_f32_16x16x32_bf16 v[200:203], a[0:3], v[120:123], v[200:203]
    v_exp_f32 v183, v183
    v_mfma_f32_16x16x32_bf16 v[204:207], a[4:7], v[120:123], v[204:207]
    ds_read_b64_tr_b16 a[30:31], v6 offset:6144
    s_waitcnt lgkmcnt(8)
    v_mfma_f32_16x16x32_bf16 v[184:187], a[8:11], v[136:139], v[184:187]
    ds_read_b64_tr_b16 a[0:1], v3 offset:128
    v_cvt_pk_bf16_f32 v59, v174, v175
    v_mfma_f32_16x16x32_bf16 v[188:191], a[12:15], v[136:139], v[188:191]
    buffer_load_dwordx4 v238, s[16:19], s48 offen offset:2048 lds
    v_cvt_pk_bf16_f32 v60, v176, v177
    v_mfma_f32_16x16x32_bf16 v[196:199], a[12:15], v[140:143], v[196:199]
    ds_read_b64_tr_b16 a[2:3], v3 offset:6272
    v_cvt_pk_bf16_f32 v61, v178, v179
    v_mfma_f32_16x16x32_bf16 v[192:195], a[8:11], v[140:143], v[192:195]
    ds_read_b64_tr_b16 a[4:5], v4 offset:128
    v_add_f32 v7, v7, v165
    v_mfma_f32_16x16x32_bf16 v[200:203], a[8:11], v[144:147], v[200:203]
    v_cvt_pk_bf16_f32 v62, v180, v181
    v_cvt_pk_bf16_f32 v63, v182, v183
    v_mfma_f32_16x16x32_bf16 v[204:207], a[12:15], v[144:147], v[204:207]
    ds_read_b64_tr_b16 a[6:7], v4 offset:6272
    buffer_load_dwordx4 v239, s[16:19], s48 offen offset:3072 lds
    s_waitcnt lgkmcnt(8)
    v_mfma_f32_16x16x32_bf16 a[32:35], a[16:19], v[52:55], a[32:35]
    ds_read_b64_tr_b16 a[8:9], v5 offset:128
    v_add_f32 v7, v7, v166
    v_add_f32 v7, v7, v167
    v_mfma_f32_16x16x32_bf16 a[44:47], a[20:23], v[52:55], a[44:47]
    v_add_f32 v8, v8, v168
    v_add_f32 v8, v8, v169
    v_mfma_f32_16x16x32_bf16 a[48:51], a[20:23], v[56:59], a[48:51]
    ds_read_b64_tr_b16 a[10:11], v5 offset:6272
    s_add_u32 m0, s49, 8192
    v_mfma_f32_16x16x32_bf16 a[36:39], a[16:19], v[56:59], a[36:39]
    ds_read_b64_tr_b16 a[12:13], v6 offset:128
    buffer_load_dwordx4 v240, s[16:19], s48 offen offset:0 lds
    v_mfma_f32_16x16x32_bf16 a[40:43], a[16:19], v[60:63], a[40:43]
    v_exp_f32 v184, v184
    v_mfma_f32_16x16x32_bf16 a[52:55], a[20:23], v[60:63], a[52:55]
    ds_read_b64_tr_b16 a[14:15], v6 offset:6272
    s_waitcnt lgkmcnt(8)
    v_mfma_f32_16x16x32_bf16 a[64:67], a[24:27], v[60:63], a[64:67]
    ds_read_b64_tr_b16 a[16:17], v3 offset:256
    v_add_f32 v8, v8, v170
    v_mfma_f32_16x16x32_bf16 a[76:79], a[28:31], v[60:63], a[76:79]
    buffer_load_dwordx4 v241, s[16:19], s48 offen offset:1024 lds
    v_exp_f32 v185, v185
    v_mfma_f32_16x16x32_bf16 a[72:75], a[28:31], v[56:59], a[72:75]
    ds_read_b64_tr_b16 a[18:19], v3 offset:6400
    v_add_f32 v8, v8, v171
    v_mfma_f32_16x16x32_bf16 a[60:63], a[24:27], v[56:59], a[60:63]
    ds_read_b64_tr_b16 a[20:21], v4 offset:256
    v_add_f32 v8, v8, v172
    v_mfma_f32_16x16x32_bf16 a[56:59], a[24:27], v[52:55], a[56:59]
    v_exp_f32 v186, v186
    v_mfma_f32_16x16x32_bf16 a[68:71], a[28:31], v[52:55], a[68:71]
    ds_read_b64_tr_b16 a[22:23], v4 offset:6400
    s_waitcnt lgkmcnt(8)
    v_mfma_f32_16x16x32_bf16 a[80:83], a[0:3], v[52:55], a[80:83]
    ds_read_b64_tr_b16 a[24:25], v5 offset:256
    buffer_load_dword v254, v253, s[96:99], s101 offen
    v_mfma_f32_16x16x32_bf16 a[92:95], a[4:7], v[52:55], a[92:95]
    v_exp_f32 v187, v187
    v_mfma_f32_16x16x32_bf16 a[96:99], a[4:7], v[56:59], a[96:99]
    ds_read_b64_tr_b16 a[26:27], v5 offset:6400
    v_add_f32 v8, v8, v173
    v_add_f32 v8, v8, v174
    v_mfma_f32_16x16x32_bf16 a[84:87], a[0:3], v[56:59], a[84:87]
    ds_read_b64_tr_b16 a[28:29], v6 offset:256
    v_add_f32 v8, v8, v175
    v_mfma_f32_16x16x32_bf16 a[88:91], a[0:3], v[60:63], a[88:91]
    v_exp_f32 v188, v188
    v_mfma_f32_16x16x32_bf16 a[100:103], a[4:7], v[60:63], a[100:103]
    ds_read_b64_tr_b16 a[30:31], v6 offset:6400
    s_waitcnt lgkmcnt(8)
    v_mfma_f32_16x16x32_bf16 a[112:115], a[8:11], v[60:63], a[112:115]
    ds_read_b64_tr_b16 a[0:1], v3 offset:24576
    v_exp_f32 v189, v189
    v_mfma_f32_16x16x32_bf16 a[124:127], a[12:15], v[60:63], a[124:127]
    v_exp_f32 v190, v190
    v_mfma_f32_16x16x32_bf16 a[120:123], a[12:15], v[56:59], a[120:123]
    ds_read_b64_tr_b16 a[2:3], v3 offset:30720
    v_add_f32 v9, v9, v176
    v_mfma_f32_16x16x32_bf16 a[108:111], a[8:11], v[56:59], a[108:111]
    ds_read_b64_tr_b16 a[4:5], v4 offset:24576
    v_add_f32 v9, v9, v177
    v_mfma_f32_16x16x32_bf16 a[104:107], a[8:11], v[52:55], a[104:107]
    v_exp_f32 v191, v191
    v_mfma_f32_16x16x32_bf16 a[116:119], a[12:15], v[52:55], a[116:119]
    ds_read_b64_tr_b16 a[6:7], v4 offset:30720
    s_waitcnt lgkmcnt(8)
    v_mfma_f32_16x16x32_bf16 a[128:131], a[16:19], v[52:55], a[128:131]
    ds_read_b64_tr_b16 a[8:9], v5 offset:24576
    v_add_f32 v9, v9, v178
    v_mfma_f32_16x16x32_bf16 a[140:143], a[20:23], v[52:55], a[140:143]
    v_exp_f32 v192, v192
    v_mfma_f32_16x16x32_bf16 a[144:147], a[20:23], v[56:59], a[144:147]
    ds_read_b64_tr_b16 a[10:11], v5 offset:30720
    v_add_f32 v9, v9, v179
    v_mfma_f32_16x16x32_bf16 a[132:135], a[16:19], v[56:59], a[132:135]
    ds_read_b64_tr_b16 a[12:13], v6 offset:24576
    v_add_f32 v9, v9, v180
    v_mfma_f32_16x16x32_bf16 a[136:139], a[16:19], v[60:63], a[136:139]
    v_exp_f32 v193, v193
    v_add_f32 v9, v9, v181
    v_mfma_f32_16x16x32_bf16 a[148:151], a[20:23], v[60:63], a[148:151]
    ds_read_b64_tr_b16 a[14:15], v6 offset:30720
    s_waitcnt lgkmcnt(8)
    v_mfma_f32_16x16x32_bf16 a[160:163], a[24:27], v[60:63], a[160:163]
    ds_read_b64_tr_b16 a[16:17], v3 offset:24704
    v_exp_f32 v194, v194
    v_mfma_f32_16x16x32_bf16 a[172:175], a[28:31], v[60:63], a[172:175]
    v_exp_f32 v195, v195
    v_mfma_f32_16x16x32_bf16 a[168:171], a[28:31], v[56:59], a[168:171]
    ds_read_b64_tr_b16 a[18:19], v3 offset:30848
    v_add_f32 v9, v9, v182
    v_mfma_f32_16x16x32_bf16 a[156:159], a[24:27], v[56:59], a[156:159]
    ds_read_b64_tr_b16 a[20:21], v4 offset:24704
    v_add_f32 v9, v9, v183
    v_mfma_f32_16x16x32_bf16 a[152:155], a[24:27], v[52:55], a[152:155]
    v_exp_f32 v196, v196
    v_mfma_f32_16x16x32_bf16 a[164:167], a[28:31], v[52:55], a[164:167]
    ds_read_b64_tr_b16 a[22:23], v4 offset:30848
    v_exp_f32 v197, v197
    v_exp_f32 v198, v198
    v_exp_f32 v199, v199
    v_exp_f32 v200, v200
    v_exp_f32 v201, v201
    v_exp_f32 v202, v202
    v_exp_f32 v203, v203
    v_exp_f32 v204, v204
    v_exp_f32 v205, v205
    v_exp_f32 v206, v206
    v_exp_f32 v207, v207
    v_cvt_pk_bf16_f32 v52, v184, v185
    v_cvt_pk_bf16_f32 v53, v186, v187
    v_cvt_pk_bf16_f32 v54, v188, v189
    v_cvt_pk_bf16_f32 v55, v190, v191
    v_cvt_pk_bf16_f32 v56, v192, v193
    v_cvt_pk_bf16_f32 v57, v194, v195
    v_cvt_pk_bf16_f32 v58, v196, v197
    v_cvt_pk_bf16_f32 v59, v198, v199
    v_cvt_pk_bf16_f32 v60, v200, v201
    v_cvt_pk_bf16_f32 v61, v202, v203
    v_cvt_pk_bf16_f32 v62, v204, v205
    v_cvt_pk_bf16_f32 v63, v206, v207
    s_waitcnt lgkmcnt(8)
    v_mfma_f32_16x16x32_bf16 a[32:35], a[0:3], v[52:55], a[32:35]
    ds_read_b64_tr_b16 a[24:25], v5 offset:24704
    v_mfma_f32_16x16x32_bf16 a[44:47], a[4:7], v[52:55], a[44:47]
    v_add_f32 v7, v7, v184
    v_mfma_f32_16x16x32_bf16 a[48:51], a[4:7], v[56:59], a[48:51]
    ds_read_b64_tr_b16 a[26:27], v5 offset:30848
    v_add_f32 v7, v7, v185
    v_mfma_f32_16x16x32_bf16 a[36:39], a[0:3], v[56:59], a[36:39]
    ds_read_b64_tr_b16 a[28:29], v6 offset:24704
    v_mfma_f32_16x16x32_bf16 a[40:43], a[0:3], v[60:63], a[40:43]
    v_add_f32 v7, v7, v186
    v_mfma_f32_16x16x32_bf16 a[52:55], a[4:7], v[60:63], a[52:55]
    ds_read_b64_tr_b16 a[30:31], v6 offset:30848
    s_waitcnt lgkmcnt(8)
    v_mfma_f32_16x16x32_bf16 a[64:67], a[8:11], v[60:63], a[64:67]
    ds_read_b64_tr_b16 a[0:1], v3 offset:24832
    v_add_f32 v7, v7, v187
    v_mfma_f32_16x16x32_bf16 a[76:79], a[12:15], v[60:63], a[76:79]
    v_mfma_f32_16x16x32_bf16 a[72:75], a[12:15], v[56:59], a[72:75]
    ds_read_b64_tr_b16 a[2:3], v3 offset:30976
    v_add_f32 v7, v7, v188
    v_mfma_f32_16x16x32_bf16 a[60:63], a[8:11], v[56:59], a[60:63]
    ds_read_b64_tr_b16 a[4:5], v4 offset:24832
    v_mfma_f32_16x16x32_bf16 a[56:59], a[8:11], v[52:55], a[56:59]
    v_add_f32 v7, v7, v189
    v_mfma_f32_16x16x32_bf16 a[68:71], a[12:15], v[52:55], a[68:71]
    ds_read_b64_tr_b16 a[6:7], v4 offset:30976
    s_waitcnt lgkmcnt(8)
    v_mfma_f32_16x16x32_bf16 a[80:83], a[16:19], v[52:55], a[80:83]
    ds_read_b64_tr_b16 a[8:9], v5 offset:24832
    v_add_f32 v7, v7, v190
    v_mfma_f32_16x16x32_bf16 a[92:95], a[20:23], v[52:55], a[92:95]
    v_add_f32 v7, v7, v191
    v_mfma_f32_16x16x32_bf16 a[96:99], a[20:23], v[56:59], a[96:99]
    ds_read_b64_tr_b16 a[10:11], v5 offset:30976
    v_mfma_f32_16x16x32_bf16 a[84:87], a[16:19], v[56:59], a[84:87]
    ds_read_b64_tr_b16 a[12:13], v6 offset:24832
    v_mfma_f32_16x16x32_bf16 a[88:91], a[16:19], v[60:63], a[88:91]
    v_add_f32 v8, v8, v192
    v_mfma_f32_16x16x32_bf16 a[100:103], a[20:23], v[60:63], a[100:103]
    ds_read_b64_tr_b16 a[14:15], v6 offset:30976
    s_waitcnt lgkmcnt(8)
    v_mfma_f32_16x16x32_bf16 a[112:115], a[24:27], v[60:63], a[112:115]
    v_add_f32 v8, v8, v193
    v_mfma_f32_16x16x32_bf16 a[124:127], a[28:31], v[60:63], a[124:127]
    v_add_f32 v8, v8, v194
    v_mfma_f32_16x16x32_bf16 a[120:123], a[28:31], v[56:59], a[120:123]
    v_add_f32 v8, v8, v195
    v_mfma_f32_16x16x32_bf16 a[108:111], a[24:27], v[56:59], a[108:111]
    v_add_f32 v8, v8, v196
    v_mfma_f32_16x16x32_bf16 a[104:107], a[24:27], v[52:55], a[104:107]
    v_add_f32 v8, v8, v197
    v_mfma_f32_16x16x32_bf16 a[116:119], a[28:31], v[52:55], a[116:119]
    s_waitcnt lgkmcnt(4)
    v_mfma_f32_16x16x32_bf16 a[128:131], a[0:3], v[52:55], a[128:131]
    v_add_f32 v8, v8, v198
    v_mfma_f32_16x16x32_bf16 a[140:143], a[4:7], v[52:55], a[140:143]
    v_add_f32 v8, v8, v199
    v_mfma_f32_16x16x32_bf16 a[144:147], a[4:7], v[56:59], a[144:147]
    v_add_f32 v9, v9, v200
    v_mfma_f32_16x16x32_bf16 a[132:135], a[0:3], v[56:59], a[132:135]
    v_add_f32 v9, v9, v201
    v_mfma_f32_16x16x32_bf16 a[136:139], a[0:3], v[60:63], a[136:139]
    v_add_f32 v9, v9, v202
    v_mfma_f32_16x16x32_bf16 a[148:151], a[4:7], v[60:63], a[148:151]
    s_waitcnt lgkmcnt(0)
    v_mfma_f32_16x16x32_bf16 a[160:163], a[8:11], v[60:63], a[160:163]
    v_add_f32 v9, v9, v203
    v_mfma_f32_16x16x32_bf16 a[172:175], a[12:15], v[60:63], a[172:175]
    v_add_f32 v9, v9, v204
    v_mfma_f32_16x16x32_bf16 a[168:171], a[12:15], v[56:59], a[168:171]
    v_add_f32 v9, v9, v205
    v_mfma_f32_16x16x32_bf16 a[156:159], a[8:11], v[56:59], a[156:159]
    v_add_f32 v9, v9, v206
    v_mfma_f32_16x16x32_bf16 a[152:155], a[8:11], v[52:55], a[152:155]
    v_add_f32 v9, v9, v207
    v_mfma_f32_16x16x32_bf16 a[164:167], a[12:15], v[52:55], a[164:167]
    s_nop 7
    v_mov_b32 v10, v7
    v_mov_b32 v11, v8
    v_mov_b32 v12, v9
    v_permlane32_swap_b32 v7, v10
    v_permlane32_swap_b32 v8, v11
    v_permlane32_swap_b32 v9, v12
    v_add_f32 v7, v7, v10
    v_add_f32 v8, v8, v11
    v_add_f32 v9, v9, v12
    v_mov_b32 v10, v7
    v_mov_b32 v11, v8
    v_mov_b32 v12, v9
    v_permlane16_swap_b32 v7, v10
    v_permlane16_swap_b32 v8, v11
    v_permlane16_swap_b32 v9, v12
    v_add_f32 v7, v7, v10
    v_add_f32 v8, v8, v11
    v_add_f32 v9, v9, v12
    s_mov_b32 s43, 0x53800000
    v_cmp_ngt_f32 vcc, s43, v7
    v_cmp_ngt_f32 s[72:73], s43, v8
    v_cmp_ngt_f32 s[74:75], s43, v9
    v_rcp_f32 v10, v7
    v_rcp_f32 v12, v8
    v_rcp_f32 v14, v9
    s_or_b64 s[72:73], s[72:73], vcc
    s_or_b64 s[72:73], s[72:73], s[74:75]
    s_cbranch_scc0 L_vote_okf
    v_mov_b32 v7, 98304
    v_mov_b32 v8, 1
    ds_write_b32 v7, v8
    s_waitcnt lgkmcnt(0)
L_vote_okf:
    v_mov_b32 v11, v10
    v_mov_b32 v13, v12
    v_mov_b32 v15, v14
    v_and_b32 v7, 63, v0
    v_lshlrev_b32 v7, 4, v7
    v_add_u32 v8, 6144, v7
    v_add_u32 v9, 12288, v7
    s_mul_i32 s39, s81, 73728
    s_add_u32 s39, s39, s83
    s_add_u32 s40, s39, 3072
    s_lshl_b32 s54, s81, 7
    s_add_u32 s54, s54, s100
    v_accvgpr_read_b32 v76, a32
    v_accvgpr_read_b32 v77, a33
    v_accvgpr_read_b32 v78, a34
    v_accvgpr_read_b32 v79, a35
    v_accvgpr_read_b32 v80, a44
    v_accvgpr_read_b32 v81, a45
    v_accvgpr_read_b32 v82, a46
    v_accvgpr_read_b32 v83, a47
    v_pk_mul_f32 v[76:77], v[76:77], v[10:11]
    v_pk_mul_f32 v[78:79], v[78:79], v[10:11]
    v_pk_mul_f32 v[80:81], v[80:81], v[10:11]
    v_pk_mul_f32 v[82:83], v[82:83], v[10:11]
    v_cvt_pk_bf16_f32 v160, v76, v77
    v_cvt_pk_bf16_f32 v161, v78, v79
    v_cvt_pk_bf16_f32 v162, v80, v81
    v_cvt_pk_bf16_f32 v163, v82, v83
    buffer_store_dwordx4 v[160:163], v7, s[24:27], s39 offen offset:0 sc1
    v_accvgpr_read_b32 v100, a36
    v_accvgpr_read_b32 v101, a37
    v_accvgpr_read_b32 v102, a38
    v_accvgpr_read_b32 v103, a39
    v_accvgpr_read_b32 v104, a48
    v_accvgpr_read_b32 v105, a49
    v_accvgpr_read_b32 v106, a50
    v_accvgpr_read_b32 v107, a51
    v_pk_mul_f32 v[100:101], v[100:101], v[12:13]
    v_pk_mul_f32 v[102:103], v[102:103], v[12:13]
    v_pk_mul_f32 v[104:105], v[104:105], v[12:13]
    v_pk_mul_f32 v[106:107], v[106:107], v[12:13]
    v_cvt_pk_bf16_f32 v164, v100, v101
    v_cvt_pk_bf16_f32 v165, v102, v103
    v_cvt_pk_bf16_f32 v166, v104, v105
    v_cvt_pk_bf16_f32 v167, v106, v107
    buffer_store_dwordx4 v[164:167], v7, s[24:27], s39 offen offset:1024 sc1
    v_accvgpr_read_b32 v76, a40
    v_accvgpr_read_b32 v77, a41
    v_accvgpr_read_b32 v78, a42
    v_accvgpr_read_b32 v79, a43
    v_accvgpr_read_b32 v80, a52
    v_accvgpr_read_b32 v81, a53
    v_accvgpr_read_b32 v82, a54
    v_accvgpr_read_b32 v83, a55
    v_pk_mul_f32 v[76:77], v[76:77], v[14:15]
    v_pk_mul_f32 v[78:79], v[78:79], v[14:15]
    v_pk_mul_f32 v[80:81], v[80:81], v[14:15]
    v_pk_mul_f32 v[82:83], v[82:83], v[14:15]
    v_cvt_pk_bf16_f32 v168, v76, v77
    v_cvt_pk_bf16_f32 v169, v78, v79
    v_cvt_pk_bf16_f32 v170, v80, v81
    v_cvt_pk_bf16_f32 v171, v82, v83
    buffer_store_dwordx4 v[168:171], v7, s[24:27], s39 offen offset:2048 sc1
    v_accvgpr_read_b32 v76, a56
    v_accvgpr_read_b32 v77, a57
    v_accvgpr_read_b32 v78, a58
    v_accvgpr_read_b32 v79, a59
    v_accvgpr_read_b32 v80, a68
    v_accvgpr_read_b32 v81, a69
    v_accvgpr_read_b32 v82, a70
    v_accvgpr_read_b32 v83, a71
    v_pk_mul_f32 v[76:77], v[76:77], v[10:11]
    v_pk_mul_f32 v[78:79], v[78:79], v[10:11]
    v_pk_mul_f32 v[80:81], v[80:81], v[10:11]
    v_pk_mul_f32 v[82:83], v[82:83], v[10:11]
    v_cvt_pk_bf16_f32 v172, v76, v77
    v_cvt_pk_bf16_f32 v173, v78, v79
    v_cvt_pk_bf16_f32 v174, v80, v81
    v_cvt_pk_bf16_f32 v175, v82, v83
    buffer_store_dwordx4 v[172:175], v7, s[24:27], s40 offen offset:0 sc1
    v_accvgpr_read_b32 v100, a60
    v_accvgpr_read_b32 v101, a61
    v_accvgpr_read_b32 v102, a62
    v_accvgpr_read_b32 v103, a63
    v_accvgpr_read_b32 v104, a72
    v_accvgpr_read_b32 v105, a73
    v_accvgpr_read_b32 v106, a74
    v_accvgpr_read_b32 v107, a75
    v_pk_mul_f32 v[100:101], v[100:101], v[12:13]
    v_pk_mul_f32 v[102:103], v[102:103], v[12:13]
    v_pk_mul_f32 v[104:105], v[104:105], v[12:13]
    v_pk_mul_f32 v[106:107], v[106:107], v[12:13]
    v_cvt_pk_bf16_f32 v176, v100, v101
    v_cvt_pk_bf16_f32 v177, v102, v103
    v_cvt_pk_bf16_f32 v178, v104, v105
    v_cvt_pk_bf16_f32 v179, v106, v107
    buffer_store_dwordx4 v[176:179], v7, s[24:27], s40 offen offset:1024 sc1
    v_accvgpr_read_b32 v76, a64
    v_accvgpr_read_b32 v77, a65
    v_accvgpr_read_b32 v78, a66
    v_accvgpr_read_b32 v79, a67
    v_accvgpr_read_b32 v80, a76
    v_accvgpr_read_b32 v81, a77
    v_accvgpr_read_b32 v82, a78
    v_accvgpr_read_b32 v83, a79
    v_pk_mul_f32 v[76:77], v[76:77], v[14:15]
    v_pk_mul_f32 v[78:79], v[78:79], v[14:15]
    v_pk_mul_f32 v[80:81], v[80:81], v[14:15]
    v_pk_mul_f32 v[82:83], v[82:83], v[14:15]
    v_cvt_pk_bf16_f32 v180, v76, v77
    v_cvt_pk_bf16_f32 v181, v78, v79
    v_cvt_pk_bf16_f32 v182, v80, v81
    v_cvt_pk_bf16_f32 v183, v82, v83
    buffer_store_dwordx4 v[180:183], v7, s[24:27], s40 offen offset:2048 sc1
L_join:
    v_and_b32 v3, 63, v0
    v_lshrrev_b32 v4, 2, v3
    v_mul_u32_u24 v6, 320, v4
    v_bfe_u32 v4, v3, 4, 1
    v_and_b32 v5, 2, v3
    v_xor_b32 v5, v5, v4
    v_lshl_add_u32 v6, v5, 4, v6
    v_and_b32 v4, 1, v3
    v_lshl_add_u32 v6, v4, 3, v6
    v_add_u32 v1, 122880, v6
    v_xor_b32 v2, 16, v1
    s_waitcnt lgkmcnt(0)
    s_waitcnt vmcnt(17)
    s_barrier
    v_mov_b32 v3, 98304
    ds_read_b32 v4, v3
    ds_read_b64_tr_b16 a[0:1], v1 offset:0
    ds_read_b64_tr_b16 a[2:3], v1 offset:5120
    ds_read_b64_tr_b16 a[4:5], v2 offset:0
    ds_read_b64_tr_b16 a[6:7], v2 offset:5120
    ds_read_b64_tr_b16 a[8:9], v1 offset:64
    ds_read_b64_tr_b16 a[10:11], v1 offset:5184
    ds_read_b64_tr_b16 a[12:13], v2 offset:64
    ds_read_b64_tr_b16 a[14:15], v2 offset:5184
    ds_read_b64_tr_b16 a[16:17], v1 offset:128
    ds_read_b64_tr_b16 a[18:19], v1 offset:5248
    v_readfirstlane_b32 s82, v243
    s_waitcnt lgkmcnt(10)
    v_readfirstlane_b32 s43, v4
    s_nop 0
    s_cmp_gt_u32 s43, s85
    s_cbranch_scc1 L_safe
    s_cmp_lg_u32 s82, 0
    s_cbranch_scc0 L_nonce_slow
L_nonce_ok:
    v_mov_b32 v253, s82
    ds_read_b64_tr_b16 a[20:21], v2 offset:128
    ds_read_b64_tr_b16 a[22:23], v2 offset:5248
    s_waitcnt lgkmcnt(8)
    v_mfma_f32_16x16x32_bf16 v[16:19], a[0:3], v[160:163], 0
    ds_read_b64_tr_b16 a[24:25], v1 offset:192
    v_mfma_f32_16x16x32_bf16 v[28:31], a[4:7], v[160:163], 0
    v_mfma_f32_16x16x32_bf16 v[32:35], a[4:7], v[164:167], 0
    ds_read_b64_tr_b16 a[26:27], v1 offset:5312
    v_mfma_f32_16x16x32_bf16 v[20:23], a[0:3], v[164:167], 0
    ds_read_b64_tr_b16 a[28:29], v2 offset:192
    v_mfma_f32_16x16x32_bf16 v[24:27], a[0:3], v[168:171], 0
    v_mfma_f32_16x16x32_bf16 v[36:39], a[4:7], v[168:171], 0
    ds_read_b64_tr_b16 a[30:31], v2 offset:5312
    s_waitcnt lgkmcnt(8)
    v_mfma_f32_16x16x32_bf16 v[48:51], a[8:11], v[168:171], 0
    ds_read_b64_tr_b16 a[0:1], v1 offset:256
    v_mfma_f32_16x16x32_bf16 v[60:63], a[12:15], v[168:171], 0
    v_mfma_f32_16x16x32_bf16 v[56:59], a[12:15], v[164:167], 0
    ds_read_b64_tr_b16 a[2:3], v1 offset:5376
    v_mfma_f32_16x16x32_bf16 v[44:47], a[8:11], v[164:167], 0
    ds_read_b64_tr_b16 a[4:5], v2 offset:256
    v_mfma_f32_16x16x32_bf16 v[40:43], a[8:11], v[160:163], 0
    v_mfma_f32_16x16x32_bf16 v[52:55], a[12:15], v[160:163], 0
    ds_read_b64_tr_b16 a[6:7], v2 offset:5376
    s_waitcnt lgkmcnt(8)
    v_mfma_f32_16x16x32_bf16 v[64:67], a[16:19], v[160:163], 0
    ds_read_b64_tr_b16 a[8:9], v1 offset:10240
    v_mfma_f32_16x16x32_bf16 v[76:79], a[20:23], v[160:163], 0
    v_mfma_f32_16x16x32_bf16 v[80:83], a[20:23], v[164:167], 0
    ds_read_b64_tr_b16 a[10:11], v1 offset:15360
    v_mfma_f32_16x16x32_bf16 v[68:71], a[16:19], v[164:167], 0
    ds_read_b64_tr_b16 a[12:13], v2 offset:10240
    v_mfma_f32_16x16x32_bf16 v[72:75], a[16:19], v[168:171], 0
    v_mfma_f32_16x16x32_bf16 v[84:87], a[20:23], v[168:171], 0
    ds_read_b64_tr_b16 a[14:15], v2 offset:15360
    s_waitcnt lgkmcnt(8)
    v_mfma_f32_16x16x32_bf16 v[96:99], a[24:27], v[168:171], 0
    ds_read_b64_tr_b16 a[16:17], v1 offset:10304
    v_mfma_f32_16x16x32_bf16 v[108:111], a[28:31], v[168:171], 0
    v_mfma_f32_16x16x32_bf16 v[104:107], a[28:31], v[164:167], 0
    ds_read_b64_tr_b16 a[18:19], v1 offset:15424
    s_waitcnt vmcnt(0)
    s_barrier
    s_cmp_lg_u32 s3, 0
    s_cbranch_scc1 L_nf_A
    buffer_store_dword v253, off, s[24:27], s54 offset:0 sc1
L_nf_A:
    v_mfma_f32_16x16x32_bf16 v[92:95], a[24:27], v[164:167], 0
    ds_read_b64_tr_b16 a[20:21], v2 offset:10304
    s_bfe_u32 s48, s50, 0x5000a
    s_add_u32 s48, s48, s51
    s_cmp_ge_u32 s48, 24
    s_cselect_b32 s52, 24, 0
    s_sub_u32 s48, s48, s52
    s_mul_i32 s48, s48, 40960
    s_add_u32 m0, s49, 40960
    v_mfma_f32_16x16x32_bf16 v[88:91], a[24:27], v[160:163], 0
    buffer_load_dwordx4 v232, s[16:19], s48 offen offset:0 lds
    v_accvgpr_read_b32 v136, a80
    v_accvgpr_read_b32 v137, a81
    v_accvgpr_read_b32 v138, a82
    v_mfma_f32_16x16x32_bf16 v[100:103], a[28:31], v[160:163], 0
    ds_read_b64_tr_b16 a[22:23], v2 offset:15424
    v_accvgpr_read_b32 v139, a83
    v_accvgpr_read_b32 v140, a92
    s_waitcnt lgkmcnt(8)
    v_mfma_f32_16x16x32_bf16 v[112:115], a[0:3], v[160:163], 0
    ds_read_b64_tr_b16 a[24:25], v1 offset:10368
    buffer_load_dwordx4 v233, s[16:19], s48 offen offset:1024 lds
    v_accvgpr_read_b32 v141, a93
    v_accvgpr_read_b32 v142, a94
    v_mfma_f32_16x16x32_bf16 v[124:127], a[4:7], v[160:163], 0
    v_accvgpr_read_b32 v143, a95
    v_pk_mul_f32 v[136:137], v[136:137], v[10:11]
    v_pk_mul_f32 v[138:139], v[138:139], v[10:11]
    v_pk_mul_f32 v[140:141], v[140:141], v[10:11]
    v_mfma_f32_16x16x32_bf16 v[128:131], a[4:7], v[164:167], 0
    ds_read_b64_tr_b16 a[26:27], v1 offset:15488
    v_pk_mul_f32 v[142:143], v[142:143], v[10:11]
    v_cvt_pk_bf16_f32 v184, v136, v137
    v_cvt_pk_bf16_f32 v185, v138, v139
    v_mfma_f32_16x16x32_bf16 v[116:119], a[0:3], v[164:167], 0
    ds_read_b64_tr_b16 a[28:29], v2 offset:10368
    buffer_load_dwordx4 v234, s[16:19], s48 offen offset:2048 lds
    v_cvt_pk_bf16_f32 v186, v140, v141
    v_cvt_pk_bf16_f32 v187, v142, v143
    v_accvgpr_read_b32 v144, a84
    v_mfma_f32_16x16x32_bf16 v[120:123], a[0:3], v[168:171], 0
    v_accvgpr_read_b32 v145, a85
    v_accvgpr_read_b32 v146, a86
    v_accvgpr_read_b32 v147, a87
    v_accvgpr_read_b32 v148, a96
    v_mfma_f32_16x16x32_bf16 v[132:135], a[4:7], v[168:171], 0
    ds_read_b64_tr_b16 a[30:31], v2 offset:15488
    buffer_load_dwordx4 v235, s[16:19], s48 offen offset:3072 lds
    v_accvgpr_read_b32 v149, a97
    v_accvgpr_read_b32 v150, a98
    s_waitcnt lgkmcnt(8)
    v_mfma_f32_16x16x32_bf16 v[24:27], a[8:11], v[180:183], v[24:27]
    ds_read_b64_tr_b16 a[0:1], v1 offset:10432
    v_accvgpr_read_b32 v151, a99
    v_pk_mul_f32 v[144:145], v[144:145], v[12:13]
    v_pk_mul_f32 v[146:147], v[146:147], v[12:13]
    v_mfma_f32_16x16x32_bf16 v[36:39], a[12:15], v[180:183], v[36:39]
    s_add_u32 m0, s49, 45056
    v_pk_mul_f32 v[148:149], v[148:149], v[12:13]
    v_pk_mul_f32 v[150:151], v[150:151], v[12:13]
    v_cvt_pk_bf16_f32 v188, v144, v145
    v_mfma_f32_16x16x32_bf16 v[32:35], a[12:15], v[176:179], v[32:35]
    ds_read_b64_tr_b16 a[2:3], v1 offset:15552
    buffer_load_dwordx4 v236, s[16:19], s48 offen offset:0 lds
    v_cvt_pk_bf16_f32 v189, v146, v147
    v_cvt_pk_bf16_f32 v190, v148, v149
    v_cvt_pk_bf16_f32 v191, v150, v151
    v_mfma_f32_16x16x32_bf16 v[20:23], a[8:11], v[176:179], v[20:23]
    ds_read_b64_tr_b16 a[4:5], v2 offset:10432
    v_accvgpr_read_b32 v136, a88
    v_accvgpr_read_b32 v137, a89
    v_accvgpr_read_b32 v138, a90
    v_mfma_f32_16x16x32_bf16 v[16:19], a[8:11], v[172:175], v[16:19]
    buffer_load_dwordx4 v237, s[16:19], s48 offen offset:1024 lds
    v_accvgpr_read_b32 v139, a91
    v_accvgpr_read_b32 v140, a100
    v_accvgpr_read_b32 v141, a101
    v_accvgpr_read_b32 v142, a102
    v_mfma_f32_16x16x32_bf16 v[28:31], a[12:15], v[172:175], v[28:31]
    ds_read_b64_tr_b16 a[6:7], v2 offset:15552
    v_accvgpr_read_b32 v143, a103
    v_pk_mul_f32 v[136:137], v[136:137], v[14:15]
    v_pk_mul_f32 v[138:139], v[138:139], v[14:15]
    v_pk_mul_f32 v[140:141], v[140:141], v[14:15]
    s_waitcnt lgkmcnt(8)
    v_mfma_f32_16x16x32_bf16 v[40:43], a[16:19], v[172:175], v[40:43]
    ds_read_b64_tr_b16 a[8:9], v1 offset:10496
    v_pk_mul_f32 v[142:143], v[142:143], v[14:15]
    v_cvt_pk_bf16_f32 v192, v136, v137
    v_cvt_pk_bf16_f32 v193, v138, v139
    v_cvt_pk_bf16_f32 v194, v140, v141
    v_cvt_pk_bf16_f32 v195, v142, v143
    v_mfma_f32_16x16x32_bf16 v[52:55], a[20:23], v[172:175], v[52:55]
    buffer_load_dwordx4 v238, s[16:19], s48 offen offset:2048 lds
    v_accvgpr_read_b32 v136, a104
    v_accvgpr_read_b32 v137, a105
    v_mfma_f32_16x16x32_bf16 v[56:59], a[20:23], v[176:179], v[56:59]
    ds_read_b64_tr_b16 a[10:11], v1 offset:15616
    v_accvgpr_read_b32 v138, a106
    v_accvgpr_read_b32 v139, a107
    v_accvgpr_read_b32 v140, a116
    v_mfma_f32_16x16x32_bf16 v[44:47], a[16:19], v[176:179], v[44:47]
    ds_read_b64_tr_b16 a[12:13], v2 offset:10496
    buffer_load_dwordx4 v239, s[16:19], s48 offen offset:3072 lds
    v_accvgpr_read_b32 v141, a117
    v_accvgpr_read_b32 v142, a118
    v_mfma_f32_16x16x32_bf16 v[48:51], a[16:19], v[180:183], v[48:51]
    v_accvgpr_read_b32 v143, a119
    v_pk_mul_f32 v[136:137], v[136:137], v[10:11]
    v_pk_mul_f32 v[138:139], v[138:139], v[10:11]
    v_pk_mul_f32 v[140:141], v[140:141], v[10:11]
    v_mfma_f32_16x16x32_bf16 v[60:63], a[20:23], v[180:183], v[60:63]
    ds_read_b64_tr_b16 a[14:15], v2 offset:15616
    s_add_u32 m0, s49, 49152
    v_pk_mul_f32 v[142:143], v[142:143], v[10:11]
    s_waitcnt lgkmcnt(8)
    v_mfma_f32_16x16x32_bf16 v[72:75], a[24:27], v[180:183], v[72:75]
    ds_read_b64_tr_b16 a[16:17], v1 offset:20480
    buffer_load_dwordx4 v240, s[16:19], s48 offen offset:0 lds
    v_cvt_pk_bf16_f32 v196, v136, v137
    v_cvt_pk_bf16_f32 v197, v138, v139
    v_cvt_pk_bf16_f32 v198, v140, v141
    v_mfma_f32_16x16x32_bf16 v[84:87], a[28:31], v[180:183], v[84:87]
    v_cvt_pk_bf16_f32 v199, v142, v143
    v_accvgpr_read_b32 v144, a108
    v_accvgpr_read_b32 v145, a109
    v_accvgpr_read_b32 v146, a110
    v_accvgpr_read_b32 v147, a111
    v_mfma_f32_16x16x32_bf16 v[80:83], a[28:31], v[176:179], v[80:83]
    ds_read_b64_tr_b16 a[18:19], v1 offset:25600
    buffer_load_dwordx4 v241, s[16:19], s48 offen offset:1024 lds
    s_bfe_u32 s48, s50, 0x5000f
    s_add_u32 s48, s48, s51
    s_cmp_ge_u32 s48, 24
    s_cselect_b32 s52, 24, 0
    s_sub_u32 s48, s48, s52
    v_mfma_f32_16x16x32_bf16 v[68:71], a[24:27], v[176:179], v[68:71]
    ds_read_b64_tr_b16 a[20:21], v2 offset:20480
    s_mul_i32 s48, s48, 40960
    v_accvgpr_read_b32 v148, a120
    v_accvgpr_read_b32 v149, a121
    v_accvgpr_read_b32 v150, a122
    v_mfma_f32_16x16x32_bf16 v[64:67], a[24:27], v[172:175], v[64:67]
    s_add_u32 m0, s49, 81920
    v_accvgpr_read_b32 v151, a123
    v_pk_mul_f32 v[144:145], v[144:145], v[12:13]
    v_pk_mul_f32 v[146:147], v[146:147], v[12:13]
    v_mfma_f32_16x16x32_bf16 v[76:79], a[28:31], v[172:175], v[76:79]
    ds_read_b64_tr_b16 a[22:23], v2 offset:25600
    buffer_load_dwordx4 v232, s[16:19], s48 offen offset:0 lds
    v_pk_mul_f32 v[148:149], v[148:149], v[12:13]
    v_pk_mul_f32 v[150:151], v[150:151], v[12:13]
    s_waitcnt lgkmcnt(8)
    v_mfma_f32_16x16x32_bf16 v[88:91], a[0:3], v[172:175], v[88:91]
    ds_read_b64_tr_b16 a[24:25], v1 offset:20544
    v_cvt_pk_bf16_f32 v200, v144, v145
    v_cvt_pk_bf16_f32 v201, v146, v147
    v_cvt_pk_bf16_f32 v202, v148, v149
    v_mfma_f32_16x16x32_bf16 v[100:103], a[4:7], v[172:175], v[100:103]
    buffer_load_dwordx4 v233, s[16:19], s48 offen offset:1024 lds
    v_cvt_pk_bf16_f32 v203, v150, v151
    v_accvgpr_read_b32 v136, a112
    v_accvgpr_read_b32 v137, a113
    v_mfma_f32_16x16x32_bf16 v[104:107], a[4:7], v[176:179], v[104:107]
    ds_read_b64_tr_b16 a[26:27], v1 offset:25664
    v_accvgpr_read_b32 v138, a114
    v_accvgpr_read_b32 v139, a115
    v_accvgpr_read_b32 v140, a124
    v_accvgpr_read_b32 v141, a125
    v_mfma_f32_16x16x32_bf16 v[92:95], a[0:3], v[176:179], v[92:95]
    ds_read_b64_tr_b16 a[28:29], v2 offset:20544
    v_accvgpr_read_b32 v142, a126
    v_accvgpr_read_b32 v143, a127
    v_pk_mul_f32 v[136:137], v[136:137], v[14:15]
    v_pk_mul_f32 v[138:139], v[138:139], v[14:15]
    v_pk_mul_f32 v[140:141], v[140:141], v[14:15]
    v_mfma_f32_16x16x32_bf16 v[96:99], a[0:3], v[180:183], v[96:99]
    buffer_load_dwordx4 v234, s[16:19], s48 offen offset:2048 lds
    v_pk_mul_f32 v[142:143], v[142:143], v[14:15]
    v_cvt_pk_bf16_f32 v204, v136, v137
    v_cvt_pk_bf16_f32 v205, v138, v139
    v_cvt_pk_bf16_f32 v206, v140, v141
    v_cvt_pk_bf16_f32 v207, v142, v143
    v_mfma_f32_16x16x32_bf16 v[108:111], a[4:7], v[180:183], v[108:111]
    ds_read_b64_tr_b16 a[30:31], v2 offset:25664
    v_accvgpr_read_b32 v136, a128
    s_waitcnt lgkmcnt(8)
    v_mfma_f32_16x16x32_bf16 v[120:123], a[8:11], v[180:183], v[120:123]
    ds_read_b64_tr_b16 a[0:1], v1 offset:20608
    buffer_load_dwordx4 v235, s[16:19], s48 offen offset:3072 lds
    v_accvgpr_read_b32 v137, a129
    v_accvgpr_read_b32 v138, a130
    v_mfma_f32_16x16x32_bf16 v[132:135], a[12:15], v[180:183], v[132:135]
    v_accvgpr_read_b32 v139, a131
    v_accvgpr_read_b32 v140, a140
    v_accvgpr_read_b32 v141, a141
    v_accvgpr_read_b32 v142, a142
    v_mfma_f32_16x16x32_bf16 v[128:131], a[12:15], v[176:179], v[128:131]
    ds_read_b64_tr_b16 a[2:3], v1 offset:25728
    s_add_u32 m0, s49, 86016
    v_accvgpr_read_b32 v143, a143
    v_pk_mul_f32 v[136:137], v[136:137], v[10:11]
    v_mfma_f32_16x16x32_bf16 v[116:119], a[8:11], v[176:179], v[116:119]
    ds_read_b64_tr_b16 a[4:5], v2 offset:20608
    buffer_load_dwordx4 v236, s[16:19], s48 offen offset:0 lds
    v_pk_mul_f32 v[138:139], v[138:139], v[10:11]
    v_pk_mul_f32 v[140:141], v[140:141], v[10:11]
    v_mfma_f32_16x16x32_bf16 v[112:115], a[8:11], v[172:175], v[112:115]
    v_pk_mul_f32 v[142:143], v[142:143], v[10:11]
    v_cvt_pk_bf16_f32 v208, v136, v137
    v_cvt_pk_bf16_f32 v209, v138, v139
    v_cvt_pk_bf16_f32 v210, v140, v141
    v_mfma_f32_16x16x32_bf16 v[124:127], a[12:15], v[172:175], v[124:127]
    ds_read_b64_tr_b16 a[6:7], v2 offset:25728
    buffer_load_dwordx4 v237, s[16:19], s48 offen offset:1024 lds
    v_cvt_pk_bf16_f32 v211, v142, v143
    s_waitcnt lgkmcnt(8)
    v_mfma_f32_16x16x32_bf16 v[16:19], a[16:19], v[184:187], v[16:19]
    ds_read_b64_tr_b16 a[8:9], v1 offset:20672
    v_accvgpr_read_b32 v144, a132
    v_accvgpr_read_b32 v145, a133
    v_accvgpr_read_b32 v146, a134
    v_mfma_f32_16x16x32_bf16 v[28:31], a[20:23], v[184:187], v[28:31]
    v_accvgpr_read_b32 v147, a135
    v_accvgpr_read_b32 v148, a144
    v_accvgpr_read_b32 v149, a145
    v_accvgpr_read_b32 v150, a146
    v_accvgpr_read_b32 v151, a147
    v_mfma_f32_16x16x32_bf16 v[32:35], a[20:23], v[188:191], v[32:35]
    ds_read_b64_tr_b16 a[10:11], v1 offset:25792
    buffer_load_dwordx4 v238, s[16:19], s48 offen offset:2048 lds
    v_pk_mul_f32 v[144:145], v[144:145], v[12:13]
    v_pk_mul_f32 v[146:147], v[146:147], v[12:13]
    v_mfma_f32_16x16x32_bf16 v[20:23], a[16:19], v[188:191], v[20:23]
    ds_read_b64_tr_b16 a[12:13], v2 offset:20672
    v_pk_mul_f32 v[148:149], v[148:149], v[12:13]
    v_pk_mul_f32 v[150:151], v[150:151], v[12:13]
    v_cvt_pk_bf16_f32 v212, v144, v145
    v_mfma_f32_16x16x32_bf16 v[24:27], a[16:19], v[192:195], v[24:27]
    buffer_load_dwordx4 v239, s[16:19], s48 offen offset:3072 lds
    v_cvt_pk_bf16_f32 v213, v146, v147
    v_cvt_pk_bf16_f32 v214, v148, v149
    v_cvt_pk_bf16_f32 v215, v150, v151
    v_accvgpr_read_b32 v136, a136
    v_mfma_f32_16x16x32_bf16 v[36:39], a[20:23], v[192:195], v[36:39]
    ds_read_b64_tr_b16 a[14:15], v2 offset:25792
    v_accvgpr_read_b32 v137, a137
    v_accvgpr_read_b32 v138, a138
    s_waitcnt lgkmcnt(8)
    v_mfma_f32_16x16x32_bf16 v[48:51], a[24:27], v[192:195], v[48:51]
    ds_read_b64_tr_b16 a[16:17], v1 offset:20736
    s_add_u32 m0, s49, 90112
    v_accvgpr_read_b32 v139, a139
    v_accvgpr_read_b32 v140, a148
    v_accvgpr_read_b32 v141, a149
    v_mfma_f32_16x16x32_bf16 v[60:63], a[28:31], v[192:195], v[60:63]
    buffer_load_dwordx4 v240, s[16:19], s48 offen offset:0 lds
    v_accvgpr_read_b32 v142, a150
    v_accvgpr_read_b32 v143, a151
    v_pk_mul_f32 v[136:137], v[136:137], v[14:15]
    v_pk_mul_f32 v[138:139], v[138:139], v[14:15]
    v_pk_mul_f32 v[140:141], v[140:141], v[14:15]
    v_mfma_f32_16x16x32_bf16 v[56:59], a[28:31], v[188:191], v[56:59]
    ds_read_b64_tr_b16 a[18:19], v1 offset:25856
    v_pk_mul_f32 v[142:143], v[142:143], v[14:15]
    v_cvt_pk_bf16_f32 v216, v136, v137
    v_cvt_pk_bf16_f32 v217, v138, v139
    v_cvt_pk_bf16_f32 v218, v140, v141
    v_cvt_pk_bf16_f32 v219, v142, v143
    v_mfma_f32_16x16x32_bf16 v[44:47], a[24:27], v[188:191], v[44:47]
    ds_read_b64_tr_b16 a[20:21], v2 offset:20736
    v_accvgpr_read_b32 v136, a152
    v_accvgpr_read_b32 v137, a153
    v_mfma_f32_16x16x32_bf16 v[40:43], a[24:27], v[184:187], v[40:43]
    buffer_load_dwordx4 v241, s[16:19], s48 offen offset:1024 lds
    v_accvgpr_read_b32 v138, a154
    v_accvgpr_read_b32 v139, a155
    v_mfma_f32_16x16x32_bf16 v[52:55], a[28:31], v[184:187], v[52:55]
    ds_read_b64_tr_b16 a[22:23], v2 offset:25856
    v_accvgpr_read_b32 v140, a164
    v_accvgpr_read_b32 v141, a165
    s_waitcnt lgkmcnt(8)
    v_mfma_f32_16x16x32_bf16 v[64:67], a[0:3], v[184:187], v[64:67]
    ds_read_b64_tr_b16 a[24:25], v1 offset:30720
    buffer_load_dword v243, v242, s[24:27], 0 offen offset:0 sc1
    v_accvgpr_read_b32 v142, a166
    v_accvgpr_read_b32 v143, a167
    v_mfma_f32_16x16x32_bf16 v[76:79], a[4:7], v[184:187], v[76:79]
    v_pk_mul_f32 v[136:137], v[136:137], v[10:11]
    v_pk_mul_f32 v[138:139], v[138:139], v[10:11]
    v_pk_mul_f32 v[140:141], v[140:141], v[10:11]
    v_pk_mul_f32 v[142:143], v[142:143], v[10:11]
    v_mfma_f32_16x16x32_bf16 v[80:83], a[4:7], v[188:191], v[80:83]
    ds_read_b64_tr_b16 a[26:27], v1 offset:35840
    v_cvt_pk_bf16_f32 v220, v136, v137
    v_cvt_pk_bf16_f32 v221, v138, v139
    v_cvt_pk_bf16_f32 v222, v140, v141
    v_mfma_f32_16x16x32_bf16 v[68:71], a[0:3], v[188:191], v[68:71]
    ds_read_b64_tr_b16 a[28:29], v2 offset:30720
    v_cvt_pk_bf16_f32 v223, v142, v143
    v_accvgpr_read_b32 v144, a156
    v_accvgpr_read_b32 v145, a157
    v_mfma_f32_16x16x32_bf16 v[72:75], a[0:3], v[192:195], v[72:75]
    v_accvgpr_read_b32 v146, a158
    v_accvgpr_read_b32 v147, a159
    v_accvgpr_read_b32 v148, a168
    v_accvgpr_read_b32 v149, a169
    v_mfma_f32_16x16x32_bf16 v[84:87], a[4:7], v[192:195], v[84:87]
    ds_read_b64_tr_b16 a[30:31], v2 offset:35840
    v_accvgpr_read_b32 v150, a170
    v_accvgpr_read_b32 v151, a171
    s_waitcnt lgkmcnt(8)
    v_mfma_f32_16x16x32_bf16 v[96:99], a[8:11], v[192:195], v[96:99]
    ds_read_b64_tr_b16 a[0:1], v1 offset:30784
    v_pk_mul_f32 v[144:145], v[144:145], v[12:13]
    v_pk_mul_f32 v[146:147], v[146:147], v[12:13]
    v_pk_mul_f32 v[148:149], v[148:149], v[12:13]
    v_mfma_f32_16x16x32_bf16 v[108:111], a[12:15], v[192:195], v[108:111]
    v_pk_mul_f32 v[150:151], v[150:151], v[12:13]
    v_cvt_pk_bf16_f32 v224, v144, v145
    v_cvt_pk_bf16_f32 v225, v146, v147
    v_cvt_pk_bf16_f32 v226, v148, v149
    v_mfma_f32_16x16x32_bf16 v[104:107], a[12:15], v[188:191], v[104:107]
    ds_read_b64_tr_b16 a[2:3], v1 offset:35904
    v_cvt_pk_bf16_f32 v227, v150, v151
    v_accvgpr_read_b32 v136, a160
    v_accvgpr_read_b32 v137, a161
    v_mfma_f32_16x16x32_bf16 v[92:95], a[8:11], v[188:191], v[92:95]
    ds_read_b64_tr_b16 a[4:5], v2 offset:30784
    v_accvgpr_read_b32 v138, a162
    v_accvgpr_read_b32 v139, a163
    v_accvgpr_read_b32 v140, a172
    v_mfma_f32_16x16x32_bf16 v[88:91], a[8:11], v[184:187], v[88:91]
    v_accvgpr_read_b32 v141, a173
    v_accvgpr_read_b32 v142, a174
    v_accvgpr_read_b32 v143, a175
    v_pk_mul_f32 v[136:137], v[136:137], v[14:15]
    v_mfma_f32_16x16x32_bf16 v[100:103], a[12:15], v[184:187], v[100:103]
    ds_read_b64_tr_b16 a[6:7], v2 offset:35904
    v_pk_mul_f32 v[138:139], v[138:139], v[14:15]
    v_pk_mul_f32 v[140:141], v[140:141], v[14:15]
    v_pk_mul_f32 v[142:143], v[142:143], v[14:15]
    s_waitcnt lgkmcnt(8)
    v_mfma_f32_16x16x32_bf16 v[112:115], a[16:19], v[184:187], v[112:115]
    ds_read_b64_tr_b16 a[8:9], v1 offset:30848
    v_cvt_pk_bf16_f32 v228, v136, v137
    v_cvt_pk_bf16_f32 v229, v138, v139
    v_cvt_pk_bf16_f32 v230, v140, v141
    v_cvt_pk_bf16_f32 v231, v142, v143
    v_mfma_f32_16x16x32_bf16 v[124:127], a[20:23], v[184:187], v[124:127]
    v_mfma_f32_16x16x32_bf16 v[128:131], a[20:23], v[188:191], v[128:131]
    ds_read_b64_tr_b16 a[10:11], v1 offset:35968
    v_mfma_f32_16x16x32_bf16 v[116:119], a[16:19], v[188:191], v[116:119]
    ds_read_b64_tr_b16 a[12:13], v2 offset:30848
    v_mfma_f32_16x16x32_bf16 v[120:123], a[16:19], v[192:195], v[120:123]
    v_mfma_f32_16x16x32_bf16 v[132:135], a[20:23], v[192:195], v[132:135]
    ds_read_b64_tr_b16 a[14:15], v2 offset:35968
    s_waitcnt lgkmcnt(8)
    v_mfma_f32_16x16x32_bf16 v[24:27], a[24:27], v[204:207], v[24:27]
    ds_read_b64_tr_b16 a[16:17], v1 offset:30912
    s_waitcnt vmcnt(0)
    v_cmp_eq_u32 vcc, s82, v243
    s_nop 0
    s_cmp_eq_u64 vcc, exec
    s_cbranch_scc0 L_slow_A
L_ok_A:
    v_mfma_f32_16x16x32_bf16 v[36:39], a[28:31], v[204:207], v[36:39]
    v_mfma_f32_16x16x32_bf16 v[32:35], a[28:31], v[200:203], v[32:35]
    ds_read_b64_tr_b16 a[18:19], v1 offset:36032
    v_mfma_f32_16x16x32_bf16 v[20:23], a[24:27], v[200:203], v[20:23]
    ds_read_b64_tr_b16 a[20:21], v2 offset:30912
    buffer_load_dwordx4 a[176:179], v7, s[24:27], s4 offen offset:0 sc1
    v_mfma_f32_16x16x32_bf16 v[16:19], a[24:27], v[196:199], v[16:19]
    v_mfma_f32_16x16x32_bf16 v[28:31], a[28:31], v[196:199], v[28:31]
    ds_read_b64_tr_b16 a[22:23], v2 offset:36032
    s_waitcnt lgkmcnt(8)
    v_mfma_f32_16x16x32_bf16 v[40:43], a[0:3], v[196:199], v[40:43]
    ds_read_b64_tr_b16 a[24:25], v1 offset:30976
    buffer_load_dwordx4 a[180:183], v7, s[24:27], s4 offen offset:1024 sc1
    v_mfma_f32_16x16x32_bf16 v[52:55], a[4:7], v[196:199], v[52:55]
    v_mfma_f32_16x16x32_bf16 v[56:59], a[4:7], v[200:203], v[56:59]
    ds_read_b64_tr_b16 a[26:27], v1 offset:36096
    v_mfma_f32_16x16x32_bf16 v[44:47], a[0:3], v[200:203], v[44:47]
    ds_read_b64_tr_b16 a[28:29], v2 offset:30976
    buffer_load_dwordx4 a[184:187], v7, s[24:27], s4 offen offset:2048 sc1
    v_mfma_f32_16x16x32_bf16 v[48:51], a[0:3], v[204:207], v[48:51]
    v_mfma_f32_16x16x32_bf16 v[60:63], a[4:7], v[204:207], v[60:63]
    ds_read_b64_tr_b16 a[30:31], v2 offset:36096
    s_waitcnt lgkmcnt(8)
    v_mfma_f32_16x16x32_bf16 v[72:75], a[8:11], v[204:207], v[72:75]
    buffer_load_dwordx4 a[188:191], v7, s[24:27], s6 offen offset:0 sc1
    v_mfma_f32_16x16x32_bf16 v[84:87], a[12:15], v[204:207], v[84:87]
    v_add_u32 v1, -122880, v1
    v_mfma_f32_16x16x32_bf16 v[80:83], a[12:15], v[200:203], v[80:83]
    v_mfma_f32_16x16x32_bf16 v[68:71], a[8:11], v[200:203], v[68:71]
    v_add_u32 v2, -122880, v2
    v_mfma_f32_16x16x32_bf16 v[64:67], a[8:11], v[196:199], v[64:67]
    buffer_load_dwordx4 a[192:195], v7, s[24:27], s6 offen offset:1024 sc1
    v_mfma_f32_16x16x32_bf16 v[76:79], a[12:15], v[196:199], v[76:79]
    s_waitcnt lgkmcnt(0)
    s_barrier
    v_mfma_f32_16x16x32_bf16 v[88:91], a[16:19], v[196:199], v[88:91]
    ds_read_b64_tr_b16 a[0:1], v1 offset:0
    v_mfma_f32_16x16x32_bf16 v[100:103], a[20:23], v[196:199], v[100:103]
    ds_read_b64_tr_b16 a[2:3], v1 offset:5120
    buffer_load_dwordx4 a[196:199], v7, s[24:27], s6 offen offset:2048 sc1
    v_mfma_f32_16x16x32_bf16 v[104:107], a[20:23], v[200:203], v[104:107]
    ds_read_b64_tr_b16 a[4:5], v2 offset:0
    v_mfma_f32_16x16x32_bf16 v[92:95], a[16:19], v[200:203], v[92:95]
    ds_read_b64_tr_b16 a[6:7], v2 offset:5120
    v_mfma_f32_16x16x32_bf16 v[96:99], a[16:19], v[204:207], v[96:99]
    ds_read_b64_tr_b16 a[8:9], v1 offset:64
    buffer_load_dwordx4 a[200:203], v7, s[24:27], s28 offen offset:0 sc1
    v_mfma_f32_16x16x32_bf16 v[108:111], a[20:23], v[204:207], v[108:111]
    ds_read_b64_tr_b16 a[10:11], v1 offset:5184
    v_mfma_f32_16x16x32_bf16 v[120:123], a[24:27], v[204:207], v[120:123]
    ds_read_b64_tr_b16 a[12:13], v2 offset:64
    v_mfma_f32_16x16x32_bf16 v[132:135], a[28:31], v[204:207], v[132:135]
    ds_read_b64_tr_b16 a[14:15], v2 offset:5184
    v_mfma_f32_16x16x32_bf16 v[128:131], a[28:31], v[200:203], v[128:131]
    ds_read_b64_tr_b16 a[16:17], v1 offset:128
    buffer_load_dwordx4 a[204:207], v7, s[24:27], s28 offen offset:1024 sc1
    v_mfma_f32_16x16x32_bf16 v[116:119], a[24:27], v[200:203], v[116:119]
    ds_read_b64_tr_b16 a[18:19], v1 offset:5248
    v_mfma_f32_16x16x32_bf16 v[112:115], a[24:27], v[196:199], v[112:115]
    ds_read_b64_tr_b16 a[20:21], v2 offset:128
    v_mfma_f32_16x16x32_bf16 v[124:127], a[28:31], v[196:199], v[124:127]
    ds_read_b64_tr_b16 a[22:23], v2 offset:5248
    buffer_load_dwordx4 a[208:211], v7, s[24:27], s28 offen offset:2048 sc1
    s_waitcnt lgkmcnt(8)
    v_mfma_f32_16x16x32_bf16 v[16:19], a[0:3], v[208:211], v[16:19]
    ds_read_b64_tr_b16 a[24:25], v1 offset:192
    v_mfma_f32_16x16x32_bf16 v[28:31], a[4:7], v[208:211], v[28:31]
    v_mfma_f32_16x16x32_bf16 v[32:35], a[4:7], v[212:215], v[32:35]
    ds_read_b64_tr_b16 a[26:27], v1 offset:5312
    buffer_load_dwordx4 a[212:215], v7, s[24:27], s5 offen offset:0 sc1
    v_mfma_f32_16x16x32_bf16 v[20:23], a[0:3], v[212:215], v[20:23]
    ds_read_b64_tr_b16 a[28:29], v2 offset:192
    v_mfma_f32_16x16x32_bf16 v[24:27], a[0:3], v[216:219], v[24:27]
    v_mfma_f32_16x16x32_bf16 v[36:39], a[4:7], v[216:219], v[36:39]
    ds_read_b64_tr_b16 a[30:31], v2 offset:5312
    buffer_load_dwordx4 a[216:219], v7, s[24:27], s5 offen offset:1024 sc1
    s_waitcnt lgkmcnt(8)
    v_mfma_f32_16x16x32_bf16 v[48:51], a[8:11], v[216:219], v[48:51]
    ds_read_b64_tr_b16 a[0:1], v1 offset:256
    v_mfma_f32_16x16x32_bf16 v[60:63], a[12:15], v[216:219], v[60:63]
    v_mfma_f32_16x16x32_bf16 v[56:59], a[12:15], v[212:215], v[56:59]
    ds_read_b64_tr_b16 a[2:3], v1 offset:5376
    v_mfma_f32_16x16x32_bf16 v[44:47], a[8:11], v[212:215], v[44:47]
    ds_read_b64_tr_b16 a[4:5], v2 offset:256
    buffer_load_dwordx4 a[220:223], v7, s[24:27], s5 offen offset:2048 sc1
    v_mfma_f32_16x16x32_bf16 v[40:43], a[8:11], v[208:211], v[40:43]
    v_mfma_f32_16x16x32_bf16 v[52:55], a[12:15], v[208:211], v[52:55]
    ds_read_b64_tr_b16 a[6:7], v2 offset:5376
    s_waitcnt lgkmcnt(8)
    v_mfma_f32_16x16x32_bf16 v[64:67], a[16:19], v[208:211], v[64:67]
    ds_read_b64_tr_b16 a[8:9], v1 offset:10240
    buffer_load_dwordx4 a[224:227], v7, s[24:27], s7 offen offset:0 sc1
    v_mfma_f32_16x16x32_bf16 v[76:79], a[20:23], v[208:211], v[76:79]
    v_mfma_f32_16x16x32_bf16 v[80:83], a[20:23], v[212:215], v[80:83]
    ds_read_b64_tr_b16 a[10:11], v1 offset:15360
    v_mfma_f32_16x16x32_bf16 v[68:71], a[16:19], v[212:215], v[68:71]
    ds_read_b64_tr_b16 a[12:13], v2 offset:10240
    buffer_load_dwordx4 a[228:231], v7, s[24:27], s7 offen offset:1024 sc1
    v_mfma_f32_16x16x32_bf16 v[72:75], a[16:19], v[216:219], v[72:75]
    v_mfma_f32_16x16x32_bf16 v[84:87], a[20:23], v[216:219], v[84:87]
    ds_read_b64_tr_b16 a[14:15], v2 offset:15360
    s_waitcnt lgkmcnt(8)
    v_mfma_f32_16x16x32_bf16 v[96:99], a[24:27], v[216:219], v[96:99]
    ds_read_b64_tr_b16 a[16:17], v1 offset:10304
    v_mfma_f32_16x16x32_bf16 v[108:111], a[28:31], v[216:219], v[108:111]
    buffer_load_dwordx4 a[232:235], v7, s[24:27], s7 offen offset:2048 sc1
    v_mfma_f32_16x16x32_bf16 v[104:107], a[28:31], v[212:215], v[104:107]
    ds_read_b64_tr_b16 a[18:19], v1 offset:15424
    v_mfma_f32_16x16x32_bf16 v[92:95], a[24:27], v[212:215], v[92:95]
    ds_read_b64_tr_b16 a[20:21], v2 offset:10304
    v_mfma_f32_16x16x32_bf16 v[88:91], a[24:27], v[208:211], v[88:91]
    buffer_load_dwordx4 a[236:239], v7, s[24:27], s29 offen offset:0 sc1
    v_mfma_f32_16x16x32_bf16 v[100:103], a[28:31], v[208:211], v[100:103]
    ds_read_b64_tr_b16 a[22:23], v2 offset:15424
    s_waitcnt lgkmcnt(8)
    v_mfma_f32_16x16x32_bf16 v[112:115], a[0:3], v[208:211], v[112:115]
    ds_read_b64_tr_b16 a[24:25], v1 offset:10368
    v_mfma_f32_16x16x32_bf16 v[124:127], a[4:7], v[208:211], v[124:127]
    buffer_load_dwordx4 a[240:243], v7, s[24:27], s29 offen offset:1024 sc1
    v_mfma_f32_16x16x32_bf16 v[128:131], a[4:7], v[212:215], v[128:131]
    ds_read_b64_tr_b16 a[26:27], v1 offset:15488
    v_mfma_f32_16x16x32_bf16 v[116:119], a[0:3], v[212:215], v[116:119]
    ds_read_b64_tr_b16 a[28:29], v2 offset:10368
    v_mfma_f32_16x16x32_bf16 v[120:123], a[0:3], v[216:219], v[120:123]
    v_mfma_f32_16x16x32_bf16 v[132:135], a[4:7], v[216:219], v[132:135]
    ds_read_b64_tr_b16 a[30:31], v2 offset:15488
    buffer_load_dwordx4 a[244:247], v7, s[24:27], s29 offen offset:2048 sc1
    s_waitcnt lgkmcnt(8)
    v_mfma_f32_16x16x32_bf16 v[24:27], a[8:11], v[228:231], v[24:27]
    ds_read_b64_tr_b16 a[0:1], v1 offset:10432
    v_mfma_f32_16x16x32_bf16 v[36:39], a[12:15], v[228:231], v[36:39]
    v_mfma_f32_16x16x32_bf16 v[32:35], a[12:15], v[224:227], v[32:35]
    ds_read_b64_tr_b16 a[2:3], v1 offset:15552
    buffer_store_dwordx4 v[184:187], v8, s[24:27], s39 offen offset:0 sc1
    v_mfma_f32_16x16x32_bf16 v[20:23], a[8:11], v[224:227], v[20:23]
    ds_read_b64_tr_b16 a[4:5], v2 offset:10432
    v_mfma_f32_16x16x32_bf16 v[16:19], a[8:11], v[220:223], v[16:19]
    v_mfma_f32_16x16x32_bf16 v[28:31], a[12:15], v[220:223], v[28:31]
    ds_read_b64_tr_b16 a[6:7], v2 offset:15552
    s_waitcnt lgkmcnt(8)
    v_mfma_f32_16x16x32_bf16 v[40:43], a[16:19], v[220:223], v[40:43]
    ds_read_b64_tr_b16 a[8:9], v1 offset:10496
    buffer_store_dwordx4 v[188:191], v8, s[24:27], s39 offen offset:1024 sc1
    v_mfma_f32_16x16x32_bf16 v[52:55], a[20:23], v[220:223], v[52:55]
    v_mfma_f32_16x16x32_bf16 v[56:59], a[20:23], v[224:227], v[56:59]
    ds_read_b64_tr_b16 a[10:11], v1 offset:15616
    v_mfma_f32_16x16x32_bf16 v[44:47], a[16:19], v[224:227], v[44:47]
    ds_read_b64_tr_b16 a[12:13], v2 offset:10496
    v_mfma_f32_16x16x32_bf16 v[48:51], a[16:19], v[228:231], v[48:51]
    buffer_store_dwordx4 v[192:195], v8, s[24:27], s39 offen offset:2048 sc1
    v_mfma_f32_16x16x32_bf16 v[60:63], a[20:23], v[228:231], v[60:63]
    ds_read_b64_tr_b16 a[14:15], v2 offset:15616
    s_waitcnt lgkmcnt(8)
    v_mfma_f32_16x16x32_bf16 v[72:75], a[24:27], v[228:231], v[72:75]
    ds_read_b64_tr_b16 a[16:17], v1 offset:20480
    v_mfma_f32_16x16x32_bf16 v[84:87], a[28:31], v[228:231], v[84:87]
    v_mfma_f32_16x16x32_bf16 v[80:83], a[28:31], v[224:227], v[80:83]
    ds_read_b64_tr_b16 a[18:19], v1 offset:25600
    v_mfma_f32_16x16x32_bf16 v[68:71], a[24:27], v[224:227], v[68:71]
    ds_read_b64_tr_b16 a[20:21], v2 offset:20480
    buffer_store_dwordx4 v[196:199], v8, s[24:27], s40 offen offset:0 sc1
    v_mfma_f32_16x16x32_bf16 v[64:67], a[24:27], v[220:223], v[64:67]
    v_mfma_f32_16x16x32_bf16 v[76:79], a[28:31], v[220:223], v[76:79]
    ds_read_b64_tr_b16 a[22:23], v2 offset:25600
    s_waitcnt lgkmcnt(8)
    v_mfma_f32_16x16x32_bf16 v[88:91], a[0:3], v[220:223], v[88:91]
    ds_read_b64_tr_b16 a[24:25], v1 offset:20544
    v_mfma_f32_16x16x32_bf16 v[100:103], a[4:7], v[220:223], v[100:103]
    buffer_store_dwordx4 v[200:203], v8, s[24:27], s40 offen offset:1024 sc1
    v_mfma_f32_16x16x32_bf16 v[104:107], a[4:7], v[224:227], v[104:107]
    ds_read_b64_tr_b16 a[26:27], v1 offset:25664
    v_mfma_f32_16x16x32_bf16 v[92:95], a[0:3], v[224:227], v[92:95]
    ds_read_b64_tr_b16 a[28:29], v2 offset:20544
    v_mfma_f32_16x16x32_bf16 v[96:99], a[0:3], v[228:231], v[96:99]
    v_mfma_f32_16x16x32_bf16 v[108:111], a[4:7], v[228:231], v[108:111]
    ds_read_b64_tr_b16 a[30:31], v2 offset:25664
    buffer_store_dwordx4 v[204:207], v8, s[24:27], s40 offen offset:2048 sc1
    s_waitcnt lgkmcnt(8)
    v_mfma_f32_16x16x32_bf16 v[120:123], a[8:11], v[228:231], v[120:123]
    ds_read_b64_tr_b16 a[0:1], v1 offset:20608
    v_mfma_f32_16x16x32_bf16 v[132:135], a[12:15], v[228:231], v[132:135]
    v_mfma_f32_16x16x32_bf16 v[128:131], a[12:15], v[224:227], v[128:131]
    ds_read_b64_tr_b16 a[2:3], v1 offset:25728
    v_mfma_f32_16x16x32_bf16 v[116:119], a[8:11], v[224:227], v[116:119]
    ds_read_b64_tr_b16 a[4:5], v2 offset:20608
    v_mfma_f32_16x16x32_bf16 v[112:115], a[8:11], v[220:223], v[112:115]
    buffer_store_dwordx4 v[208:211], v9, s[24:27], s39 offen offset:0 sc1
    v_mfma_f32_16x16x32_bf16 v[124:127], a[12:15], v[220:223], v[124:127]
    ds_read_b64_tr_b16 a[6:7], v2 offset:25728
    s_waitcnt vmcnt(22)
    s_waitcnt lgkmcnt(8)
    v_mfma_f32_16x16x32_bf16 v[16:19], a[16:19], a[176:179], v[16:19]
    ds_read_b64_tr_b16 a[8:9], v1 offset:20672
    v_mfma_f32_16x16x32_bf16 v[28:31], a[20:23], a[176:179], v[28:31]
    v_mfma_f32_16x16x32_bf16 v[32:35], a[20:23], a[180:183], v[32:35]
    ds_read_b64_tr_b16 a[10:11], v1 offset:25792
    buffer_store_dwordx4 v[212:215], v9, s[24:27], s39 offen offset:1024 sc1
    v_mfma_f32_16x16x32_bf16 v[20:23], a[16:19], a[180:183], v[20:23]
    ds_read_b64_tr_b16 a[12:13], v2 offset:20672
    v_mfma_f32_16x16x32_bf16 v[24:27], a[16:19], a[184:187], v[24:27]
    v_mfma_f32_16x16x32_bf16 v[36:39], a[20:23], a[184:187], v[36:39]
    ds_read_b64_tr_b16 a[14:15], v2 offset:25792
    s_waitcnt lgkmcnt(8)
    v_mfma_f32_16x16x32_bf16 v[48:51], a[24:27], a[184:187], v[48:51]
    ds_read_b64_tr_b16 a[16:17], v1 offset:20736
    buffer_store_dwordx4 v[216:219], v9, s[24:27], s39 offen offset:2048 sc1
    v_mfma_f32_16x16x32_bf16 v[60:63], a[28:31], a[184:187], v[60:63]
    v_mfma_f32_16x16x32_bf16 v[56:59], a[28:31], a[180:183], v[56:59]
    ds_read_b64_tr_b16 a[18:19], v1 offset:25856
    v_mfma_f32_16x16x32_bf16 v[44:47], a[24:27], a[180:183], v[44:47]
    ds_read_b64_tr_b16 a[20:21], v2 offset:20736
    v_mfma_f32_16x16x32_bf16 v[40:43], a[24:27], a[176:179], v[40:43]
    v_mfma_f32_16x16x32_bf16 v[52:55], a[28:31], a[176:179], v[52:55]
    ds_read_b64_tr_b16 a[22:23], v2 offset:25856
    buffer_store_dwordx4 v[220:223], v9, s[24:27], s40 offen offset:0 sc1
    s_waitcnt lgkmcnt(8)
    v_mfma_f32_16x16x32_bf16 v[64:67], a[0:3], a[176:179], v[64:67]
    ds_read_b64_tr_b16 a[24:25], v1 offset:30720
    v_mfma_f32_16x16x32_bf16 v[76:79], a[4:7], a[176:179], v[76:79]
    v_mfma_f32_16x16x32_bf16 v[80:83], a[4:7], a[180:183], v[80:83]
    ds_read_b64_tr_b16 a[26:27], v1 offset:35840
    v_mfma_f32_16x16x32_bf16 v[68:71], a[0:3], a[180:183], v[68:71]
    ds_read_b64_tr_b16 a[28:29], v2 offset:30720
    buffer_store_dwordx4 v[224:227], v9, s[24:27], s40 offen offset:1024 sc1
    v_mfma_f32_16x16x32_bf16 v[72:75], a[0:3], a[184:187], v[72:75]
    v_mfma_f32_16x16x32_bf16 v[84:87], a[4:7], a[184:187], v[84:87]
    ds_read_b64_tr_b16 a[30:31], v2 offset:35840
    s_waitcnt lgkmcnt(8)
    v_mfma_f32_16x16x32_bf16 v[96:99], a[8:11], a[184:187], v[96:99]
    ds_read_b64_tr_b16 a[0:1], v1 offset:30784
    v_mfma_f32_16x16x32_bf16 v[108:111], a[12:15], a[184:187], v[108:111]
    v_mfma_f32_16x16x32_bf16 v[104:107], a[12:15], a[180:183], v[104:107]
    ds_read_b64_tr_b16 a[2:3], v1 offset:35904
    buffer_store_dwordx4 v[228:231], v9, s[24:27], s40 offen offset:2048 sc1
    v_mfma_f32_16x16x32_bf16 v[92:95], a[8:11], a[180:183], v[92:95]
    ds_read_b64_tr_b16 a[4:5], v2 offset:30784
    v_mfma_f32_16x16x32_bf16 v[88:91], a[8:11], a[176:179], v[88:91]
    v_mfma_f32_16x16x32_bf16 v[100:103], a[12:15], a[176:179], v[100:103]
    ds_read_b64_tr_b16 a[6:7], v2 offset:35904
    s_waitcnt lgkmcnt(8)
    v_mfma_f32_16x16x32_bf16 v[112:115], a[16:19], a[176:179], v[112:115]
    ds_read_b64_tr_b16 a[8:9], v1 offset:30848
    v_mfma_f32_16x16x32_bf16 v[124:127], a[20:23], a[176:179], v[124:127]
    s_bfe_u32 s48, s50, 0x50014
    s_add_u32 s48, s48, s51
    s_cmp_ge_u32 s48, 24
    s_cselect_b32 s52, 24, 0
    s_sub_u32 s48, s48, s52
    s_mul_i32 s48, s48, 40960
    s_add_u32 m0, s49, 122880
    v_mfma_f32_16x16x32_bf16 v[128:131], a[20:23], a[180:183], v[128:131]
    ds_read_b64_tr_b16 a[10:11], v1 offset:35968
    buffer_load_dwordx4 v232, s[16:19], s48 offen offset:0 lds
    v_mfma_f32_16x16x32_bf16 v[116:119], a[16:19], a[180:183], v[116:119]
    ds_read_b64_tr_b16 a[12:13], v2 offset:30848
    v_mfma_f32_16x16x32_bf16 v[120:123], a[16:19], a[184:187], v[120:123]
    v_mfma_f32_16x16x32_bf16 v[132:135], a[20:23], a[184:187], v[132:135]
    ds_read_b64_tr_b16 a[14:15], v2 offset:35968
    s_waitcnt vmcnt(25)
    s_waitcnt lgkmcnt(8)
    v_mfma_f32_16x16x32_bf16 v[24:27], a[24:27], a[196:199], v[24:27]
    ds_read_b64_tr_b16 a[16:17], v1 offset:30912
    buffer_load_dwordx4 v233, s[16:19], s48 offen offset:1024 lds
    v_mfma_f32_16x16x32_bf16 v[36:39], a[28:31], a[196:199], v[36:39]
    v_mfma_f32_16x16x32_bf16 v[32:35], a[28:31], a[192:195], v[32:35]
    ds_read_b64_tr_b16 a[18:19], v1 offset:36032
    v_mfma_f32_16x16x32_bf16 v[20:23], a[24:27], a[192:195], v[20:23]
    ds_read_b64_tr_b16 a[20:21], v2 offset:30912
    v_mfma_f32_16x16x32_bf16 v[16:19], a[24:27], a[188:191], v[16:19]
    v_mfma_f32_16x16x32_bf16 v[28:31], a[28:31], a[188:191], v[28:31]
    ds_read_b64_tr_b16 a[22:23], v2 offset:36032
    buffer_load_dwordx4 v234, s[16:19], s48 offen offset:2048 lds
    s_waitcnt lgkmcnt(8)
    v_mfma_f32_16x16x32_bf16 v[40:43], a[0:3], a[188:191], v[40:43]
    ds_read_b64_tr_b16 a[24:25], v1 offset:30976
    v_mfma_f32_16x16x32_bf16 v[52:55], a[4:7], a[188:191], v[52:55]
    v_mfma_f32_16x16x32_bf16 v[56:59], a[4:7], a[192:195], v[56:59]
    ds_read_b64_tr_b16 a[26:27], v1 offset:36096
    v_mfma_f32_16x16x32_bf16 v[44:47], a[0:3], a[192:195], v[44:47]
    ds_read_b64_tr_b16 a[28:29], v2 offset:30976
    buffer_load_dwordx4 v235, s[16:19], s48 offen offset:3072 lds
    v_mfma_f32_16x16x32_bf16 v[48:51], a[0:3], a[196:199], v[48:51]
    v_mfma_f32_16x16x32_bf16 v[60:63], a[4:7], a[196:199], v[60:63]
    ds_read_b64_tr_b16 a[30:31], v2 offset:36096
    s_waitcnt lgkmcnt(8)
    v_mfma_f32_16x16x32_bf16 v[72:75], a[8:11], a[196:199], v[72:75]
    v_mfma_f32_16x16x32_bf16 v[84:87], a[12:15], a[196:199], v[84:87]
    v_add_u32 v1, 40960, v1
    s_add_u32 m0, s49, 126976
    v_mfma_f32_16x16x32_bf16 v[80:83], a[12:15], a[192:195], v[80:83]
    buffer_load_dwordx4 v236, s[16:19], s48 offen offset:0 lds
    v_mfma_f32_16x16x32_bf16 v[68:71], a[8:11], a[192:195], v[68:71]
    v_add_u32 v2, 40960, v2
    v_mfma_f32_16x16x32_bf16 v[64:67], a[8:11], a[188:191], v[64:67]
    v_mfma_f32_16x16x32_bf16 v[76:79], a[12:15], a[188:191], v[76:79]
    s_waitcnt lgkmcnt(0)
    s_barrier
    v_mfma_f32_16x16x32_bf16 v[88:91], a[16:19], a[188:191], v[88:91]
    ds_read_b64_tr_b16 a[0:1], v1 offset:0
    v_mfma_f32_16x16x32_bf16 v[100:103], a[20:23], a[188:191], v[100:103]
    ds_read_b64_tr_b16 a[2:3], v1 offset:5120
    buffer_load_dwordx4 v237, s[16:19], s48 offen offset:1024 lds
    v_mfma_f32_16x16x32_bf16 v[104:107], a[20:23], a[192:195], v[104:107]
    ds_read_b64_tr_b16 a[4:5], v2 offset:0
    v_mfma_f32_16x16x32_bf16 v[92:95], a[16:19], a[192:195], v[92:95]
    ds_read_b64_tr_b16 a[6:7], v2 offset:5120
    v_mfma_f32_16x16x32_bf16 v[96:99], a[16:19], a[196:199], v[96:99]
    ds_read_b64_tr_b16 a[8:9], v1 offset:64
    v_mfma_f32_16x16x32_bf16 v[108:111], a[20:23], a[196:199], v[108:111]
    ds_read_b64_tr_b16 a[10:11], v1 offset:5184
    buffer_load_dwordx4 v238, s[16:19], s48 offen offset:2048 lds
    v_mfma_f32_16x16x32_bf16 v[120:123], a[24:27], a[196:199], v[120:123]
    ds_read_b64_tr_b16 a[12:13], v2 offset:64
    v_mfma_f32_16x16x32_bf16 v[132:135], a[28:31], a[196:199], v[132:135]
    ds_read_b64_tr_b16 a[14:15], v2 offset:5184
    v_mfma_f32_16x16x32_bf16 v[128:131], a[28:31], a[192:195], v[128:131]
    ds_read_b64_tr_b16 a[16:17], v1 offset:128
    v_mfma_f32_16x16x32_bf16 v[116:119], a[24:27], a[192:195], v[116:119]
    ds_read_b64_tr_b16 a[18:19], v1 offset:5248
    v_mfma_f32_16x16x32_bf16 v[112:115], a[24:27], a[188:191], v[112:115]
    ds_read_b64_tr_b16 a[20:21], v2 offset:128
    s_waitcnt vmcnt(7)
    s_barrier
    s_cmp_lg_u32 s3, 0
    s_cbranch_scc1 L_nf_B
    buffer_store_dword v253, off, s[24:27], s54 offset:64 sc1
L_nf_B:
    buffer_load_dwordx4 v239, s[16:19], s48 offen offset:3072 lds
    v_mfma_f32_16x16x32_bf16 v[124:127], a[28:31], a[188:191], v[124:127]
    ds_read_b64_tr_b16 a[22:23], v2 offset:5248
    s_waitcnt lgkmcnt(8)
    v_mfma_f32_16x16x32_bf16 v[16:19], a[0:3], a[200:203], v[16:19]
    ds_read_b64_tr_b16 a[24:25], v1 offset:192
    v_mfma_f32_16x16x32_bf16 v[28:31], a[4:7], a[200:203], v[28:31]
    v_mfma_f32_16x16x32_bf16 v[32:35], a[4:7], a[204:207], v[32:35]
    ds_read_b64_tr_b16 a[26:27], v1 offset:5312
    s_add_u32 m0, s49, 131072
    v_mfma_f32_16x16x32_bf16 v[20:23], a[0:3], a[204:207], v[20:23]
    ds_read_b64_tr_b16 a[28:29], v2 offset:192
    buffer_load_dwordx4 v240, s[16:19], s48 offen offset:0 lds
    v_mfma_f32_16x16x32_bf16 v[24:27], a[0:3], a[208:211], v[24:27]
    v_mfma_f32_16x16x32_bf16 v[36:39], a[4:7], a[208:211], v[36:39]
    ds_read_b64_tr_b16 a[30:31], v2 offset:5312
    s_waitcnt lgkmcnt(8)
    v_mfma_f32_16x16x32_bf16 v[48:51], a[8:11], a[208:211], v[48:51]
    ds_read_b64_tr_b16 a[0:1], v1 offset:256
    v_mfma_f32_16x16x32_bf16 v[60:63], a[12:15], a[208:211], v[60:63]
    buffer_load_dwordx4 v241, s[16:19], s48 offen offset:1024 lds
    s_bfe_u32 s48, s50, 0x50019
    s_add_u32 s48, s48, s51
    v_mfma_f32_16x16x32_bf16 v[56:59], a[12:15], a[204:207], v[56:59]
    ds_read_b64_tr_b16 a[2:3], v1 offset:5376
    s_cmp_ge_u32 s48, 24
    s_cselect_b32 s52, 24, 0
    v_mfma_f32_16x16x32_bf16 v[44:47], a[8:11], a[204:207], v[44:47]
    ds_read_b64_tr_b16 a[4:5], v2 offset:256
    s_sub_u32 s48, s48, s52
    v_mfma_f32_16x16x32_bf16 v[40:43], a[8:11], a[200:203], v[40:43]
    s_mul_i32 s48, s48, 40960
    v_mfma_f32_16x16x32_bf16 v[52:55], a[12:15], a[200:203], v[52:55]
    ds_read_b64_tr_b16 a[6:7], v2 offset:5376
    s_add_u32 m0, s49, 0
    s_waitcnt lgkmcnt(8)
    v_mfma_f32_16x16x32_bf16 v[64:67], a[16:19], a[200:203], v[64:67]
    ds_read_b64_tr_b16 a[8:9], v1 offset:10240
    buffer_load_dwordx4 v232, s[16:19], s48 offen offset:0 lds
    v_mfma_f32_16x16x32_bf16 v[76:79], a[20:23], a[200:203], v[76:79]
    v_mfma_f32_16x16x32_bf16 v[80:83], a[20:23], a[204:207], v[80:83]
    ds_read_b64_tr_b16 a[10:11], v1 offset:15360
    v_mfma_f32_16x16x32_bf16 v[68:71], a[16:19], a[204:207], v[68:71]
    ds_read_b64_tr_b16 a[12:13], v2 offset:10240
    v_mfma_f32_16x16x32_bf16 v[72:75], a[16:19], a[208:211], v[72:75]
    buffer_load_dwordx4 v233, s[16:19], s48 offen offset:1024 lds
    v_mfma_f32_16x16x32_bf16 v[84:87], a[20:23], a[208:211], v[84:87]
    ds_read_b64_tr_b16 a[14:15], v2 offset:15360
    s_waitcnt lgkmcnt(8)
    v_mfma_f32_16x16x32_bf16 v[96:99], a[24:27], a[208:211], v[96:99]
    ds_read_b64_tr_b16 a[16:17], v1 offset:10304
    v_mfma_f32_16x16x32_bf16 v[108:111], a[28:31], a[208:211], v[108:111]
    v_mfma_f32_16x16x32_bf16 v[104:107], a[28:31], a[204:207], v[104:107]
    ds_read_b64_tr_b16 a[18:19], v1 offset:15424
    v_mfma_f32_16x16x32_bf16 v[92:95], a[24:27], a[204:207], v[92:95]
    ds_read_b64_tr_b16 a[20:21], v2 offset:10304
    buffer_load_dwordx4 v234, s[16:19], s48 offen offset:2048 lds
    v_mfma_f32_16x16x32_bf16 v[88:91], a[24:27], a[200:203], v[88:91]
    v_mfma_f32_16x16x32_bf16 v[100:103], a[28:31], a[200:203], v[100:103]
    ds_read_b64_tr_b16 a[22:23], v2 offset:15424
    s_waitcnt lgkmcnt(8)
    v_mfma_f32_16x16x32_bf16 v[112:115], a[0:3], a[200:203], v[112:115]
    ds_read_b64_tr_b16 a[24:25], v1 offset:10368
    v_mfma_f32_16x16x32_bf16 v[124:127], a[4:7], a[200:203], v[124:127]
    v_mfma_f32_16x16x32_bf16 v[128:131], a[4:7], a[204:207], v[128:131]
    ds_read_b64_tr_b16 a[26:27], v1 offset:15488
    buffer_load_dwordx4 v235, s[16:19], s48 offen offset:3072 lds
    v_mfma_f32_16x16x32_bf16 v[116:119], a[0:3], a[204:207], v[116:119]
    ds_read_b64_tr_b16 a[28:29], v2 offset:10368
    v_mfma_f32_16x16x32_bf16 v[120:123], a[0:3], a[208:211], v[120:123]
    v_mfma_f32_16x16x32_bf16 v[132:135], a[4:7], a[208:211], v[132:135]
    ds_read_b64_tr_b16 a[30:31], v2 offset:15488
    s_add_u32 m0, s49, 4096
    s_waitcnt lgkmcnt(8)
    v_mfma_f32_16x16x32_bf16 v[24:27], a[8:11], a[220:223], v[24:27]
    ds_read_b64_tr_b16 a[0:1], v1 offset:10432
    buffer_load_dwordx4 v236, s[16:19], s48 offen offset:0 lds
    v_mfma_f32_16x16x32_bf16 v[36:39], a[12:15], a[220:223], v[36:39]
    v_mfma_f32_16x16x32_bf16 v[32:35], a[12:15], a[216:219], v[32:35]
    ds_read_b64_tr_b16 a[2:3], v1 offset:15552
    buffer_load_dword v243, v242, s[24:27], 0 offen offset:64 sc1
    v_mfma_f32_16x16x32_bf16 v[20:23], a[8:11], a[216:219], v[20:23]
    ds_read_b64_tr_b16 a[4:5], v2 offset:10432
    v_mfma_f32_16x16x32_bf16 v[16:19], a[8:11], a[212:215], v[16:19]
    v_mfma_f32_16x16x32_bf16 v[28:31], a[12:15], a[212:215], v[28:31]
    ds_read_b64_tr_b16 a[6:7], v2 offset:15552
    buffer_load_dwordx4 v237, s[16:19], s48 offen offset:1024 lds
    s_waitcnt lgkmcnt(8)
    v_mfma_f32_16x16x32_bf16 v[40:43], a[16:19], a[212:215], v[40:43]
    ds_read_b64_tr_b16 a[8:9], v1 offset:10496
    v_mfma_f32_16x16x32_bf16 v[52:55], a[20:23], a[212:215], v[52:55]
    v_mfma_f32_16x16x32_bf16 v[56:59], a[20:23], a[216:219], v[56:59]
    ds_read_b64_tr_b16 a[10:11], v1 offset:15616
    v_mfma_f32_16x16x32_bf16 v[44:47], a[16:19], a[216:219], v[44:47]
    ds_read_b64_tr_b16 a[12:13], v2 offset:10496
    v_mfma_f32_16x16x32_bf16 v[48:51], a[16:19], a[220:223], v[48:51]
    buffer_load_dwordx4 v238, s[16:19], s48 offen offset:2048 lds
    v_mfma_f32_16x16x32_bf16 v[60:63], a[20:23], a[220:223], v[60:63]
    ds_read_b64_tr_b16 a[14:15], v2 offset:15616
    s_waitcnt lgkmcnt(8)
    v_mfma_f32_16x16x32_bf16 v[72:75], a[24:27], a[220:223], v[72:75]
    ds_read_b64_tr_b16 a[16:17], v1 offset:20480
    v_mfma_f32_16x16x32_bf16 v[84:87], a[28:31], a[220:223], v[84:87]
    v_mfma_f32_16x16x32_bf16 v[80:83], a[28:31], a[216:219], v[80:83]
    ds_read_b64_tr_b16 a[18:19], v1 offset:25600
    buffer_load_dwordx4 v239, s[16:19], s48 offen offset:3072 lds
    v_mfma_f32_16x16x32_bf16 v[68:71], a[24:27], a[216:219], v[68:71]
    ds_read_b64_tr_b16 a[20:21], v2 offset:20480
    v_mfma_f32_16x16x32_bf16 v[64:67], a[24:27], a[212:215], v[64:67]
    v_mfma_f32_16x16x32_bf16 v[76:79], a[28:31], a[212:215], v[76:79]
    ds_read_b64_tr_b16 a[22:23], v2 offset:25600
    s_waitcnt lgkmcnt(8)
    v_mfma_f32_16x16x32_bf16 v[88:91], a[0:3], a[212:215], v[88:91]
    ds_read_b64_tr_b16 a[24:25], v1 offset:20544
    s_add_u32 m0, s49, 8192
    v_mfma_f32_16x16x32_bf16 v[100:103], a[4:7], a[212:215], v[100:103]
    buffer_load_dwordx4 v240, s[16:19], s48 offen offset:0 lds
    v_mfma_f32_16x16x32_bf16 v[104:107], a[4:7], a[216:219], v[104:107]
    ds_read_b64_tr_b16 a[26:27], v1 offset:25664
    v_mfma_f32_16x16x32_bf16 v[92:95], a[0:3], a[216:219], v[92:95]
    ds_read_b64_tr_b16 a[28:29], v2 offset:20544
    v_mfma_f32_16x16x32_bf16 v[96:99], a[0:3], a[220:223], v[96:99]
    v_mfma_f32_16x16x32_bf16 v[108:111], a[4:7], a[220:223], v[108:111]
    ds_read_b64_tr_b16 a[30:31], v2 offset:25664
    s_waitcnt lgkmcnt(8)
    v_mfma_f32_16x16x32_bf16 v[120:123], a[8:11], a[220:223], v[120:123]
    ds_read_b64_tr_b16 a[0:1], v1 offset:20608
    buffer_load_dwordx4 v241, s[16:19], s48 offen offset:1024 lds
    v_mfma_f32_16x16x32_bf16 v[132:135], a[12:15], a[220:223], v[132:135]
    v_mfma_f32_16x16x32_bf16 v[128:131], a[12:15], a[216:219], v[128:131]
    ds_read_b64_tr_b16 a[2:3], v1 offset:25728
    v_mfma_f32_16x16x32_bf16 v[116:119], a[8:11], a[216:219], v[116:119]
    ds_read_b64_tr_b16 a[4:5], v2 offset:20608
    v_mfma_f32_16x16x32_bf16 v[112:115], a[8:11], a[212:215], v[112:115]
    s_waitcnt vmcnt(5)
    v_cmp_eq_u32 vcc, s82, v243
    s_nop 0
    s_cmp_eq_u64 vcc, exec
    s_cbranch_scc0 L_slow_B
L_ok_B:
    v_mfma_f32_16x16x32_bf16 v[124:127], a[12:15], a[212:215], v[124:127]
    ds_read_b64_tr_b16 a[6:7], v2 offset:25728
    s_waitcnt lgkmcnt(8)
    v_mfma_f32_16x16x32_bf16 v[16:19], a[16:19], a[224:227], v[16:19]
    ds_read_b64_tr_b16 a[8:9], v1 offset:20672
    v_mfma_f32_16x16x32_bf16 v[28:31], a[20:23], a[224:227], v[28:31]
    v_mfma_f32_16x16x32_bf16 v[32:35], a[20:23], a[228:231], v[32:35]
    ds_read_b64_tr_b16 a[10:11], v1 offset:25792
    buffer_load_dwordx4 a[32:35], v8, s[24:27], s4 offen offset:0 sc1
    v_mfma_f32_16x16x32_bf16 v[20:23], a[16:19], a[228:231], v[20:23]
    ds_read_b64_tr_b16 a[12:13], v2 offset:20672
    v_mfma_f32_16x16x32_bf16 v[24:27], a[16:19], a[232:235], v[24:27]
    v_mfma_f32_16x16x32_bf16 v[36:39], a[20:23], a[232:235], v[36:39]
    ds_read_b64_tr_b16 a[14:15], v2 offset:25792
    s_waitcnt lgkmcnt(8)
    v_mfma_f32_16x16x32_bf16 v[48:51], a[24:27], a[232:235], v[48:51]
    ds_read_b64_tr_b16 a[16:17], v1 offset:20736
    buffer_load_dwordx4 a[36:39], v8, s[24:27], s4 offen offset:1024 sc1
    v_mfma_f32_16x16x32_bf16 v[60:63], a[28:31], a[232:235], v[60:63]
    v_mfma_f32_16x16x32_bf16 v[56:59], a[28:31], a[228:231], v[56:59]
    ds_read_b64_tr_b16 a[18:19], v1 offset:25856
    v_mfma_f32_16x16x32_bf16 v[44:47], a[24:27], a[228:231], v[44:47]
    ds_read_b64_tr_b16 a[20:21], v2 offset:20736
    v_mfma_f32_16x16x32_bf16 v[40:43], a[24:27], a[224:227], v[40:43]
    buffer_load_dwordx4 a[40:43], v8, s[24:27], s4 offen offset:2048 sc1
    v_mfma_f32_16x16x32_bf16 v[52:55], a[28:31], a[224:227], v[52:55]
    ds_read_b64_tr_b16 a[22:23], v2 offset:25856
    s_waitcnt lgkmcnt(8)
    v_mfma_f32_16x16x32_bf16 v[64:67], a[0:3], a[224:227], v[64:67]
    ds_read_b64_tr_b16 a[24:25], v1 offset:30720
    v_mfma_f32_16x16x32_bf16 v[76:79], a[4:7], a[224:227], v[76:79]
    v_mfma_f32_16x16x32_bf16 v[80:83], a[4:7], a[228:231], v[80:83]
    ds_read_b64_tr_b16 a[26:27], v1 offset:35840
    v_mfma_f32_16x16x32_bf16 v[68:71], a[0:3], a[228:231], v[68:71]
    ds_read_b64_tr_b16 a[28:29], v2 offset:30720
    buffer_load_dwordx4 a[44:47], v8, s[24:27], s6 offen offset:0 sc1
    v_mfma_f32_16x16x32_bf16 v[72:75], a[0:3], a[232:235], v[72:75]
    v_mfma_f32_16x16x32_bf16 v[84:87], a[4:7], a[232:235], v[84:87]
    ds_read_b64_tr_b16 a[30:31], v2 offset:35840
    s_waitcnt lgkmcnt(8)
    v_mfma_f32_16x16x32_bf16 v[96:99], a[8:11], a[232:235], v[96:99]
    ds_read_b64_tr_b16 a[0:1], v1 offset:30784
    v_mfma_f32_16x16x32_bf16 v[108:111], a[12:15], a[232:235], v[108:111]
    buffer_load_dwordx4 a[48:51], v8, s[24:27], s6 offen offset:1024 sc1
    v_mfma_f32_16x16x32_bf16 v[104:107], a[12:15], a[228:231], v[104:107]
    ds_read_b64_tr_b16 a[2:3], v1 offset:35904
    v_mfma_f32_16x16x32_bf16 v[92:95], a[8:11], a[228:231], v[92:95]
    ds_read_b64_tr_b16 a[4:5], v2 offset:30784
    v_mfma_f32_16x16x32_bf16 v[88:91], a[8:11], a[224:227], v[88:91]
    v_mfma_f32_16x16x32_bf16 v[100:103], a[12:15], a[224:227], v[100:103]
    ds_read_b64_tr_b16 a[6:7], v2 offset:35904
    buffer_load_dwordx4 a[52:55], v8, s[24:27], s6 offen offset:2048 sc1
    s_waitcnt lgkmcnt(8)
    v_mfma_f32_16x16x32_bf16 v[112:115], a[16:19], a[224:227], v[112:115]
    ds_read_b64_tr_b16 a[8:9], v1 offset:30848
    v_mfma_f32_16x16x32_bf16 v[124:127], a[20:23], a[224:227], v[124:127]
    v_mfma_f32_16x16x32_bf16 v[128:131], a[20:23], a[228:231], v[128:131]
    ds_read_b64_tr_b16 a[10:11], v1 offset:35968
    v_mfma_f32_16x16x32_bf16 v[116:119], a[16:19], a[228:231], v[116:119]
    ds_read_b64_tr_b16 a[12:13], v2 offset:30848
    v_mfma_f32_16x16x32_bf16 v[120:123], a[16:19], a[232:235], v[120:123]
    buffer_load_dwordx4 a[56:59], v8, s[24:27], s28 offen offset:0 sc1
    v_mfma_f32_16x16x32_bf16 v[132:135], a[20:23], a[232:235], v[132:135]
    ds_read_b64_tr_b16 a[14:15], v2 offset:35968
    s_waitcnt lgkmcnt(8)
    v_mfma_f32_16x16x32_bf16 v[24:27], a[24:27], a[244:247], v[24:27]
    ds_read_b64_tr_b16 a[16:17], v1 offset:30912
    v_mfma_f32_16x16x32_bf16 v[36:39], a[28:31], a[244:247], v[36:39]
    v_mfma_f32_16x16x32_bf16 v[32:35], a[28:31], a[240:243], v[32:35]
    ds_read_b64_tr_b16 a[18:19], v1 offset:36032
    buffer_load_dwordx4 a[60:63], v8, s[24:27], s28 offen offset:1024 sc1
    v_mfma_f32_16x16x32_bf16 v[20:23], a[24:27], a[240:243], v[20:23]
    ds_read_b64_tr_b16 a[20:21], v2 offset:30912
    v_mfma_f32_16x16x32_bf16 v[16:19], a[24:27], a[236:239], v[16:19]
    v_mfma_f32_16x16x32_bf16 v[28:31], a[28:31], a[236:239], v[28:31]
    ds_read_b64_tr_b16 a[22:23], v2 offset:36032
    s_waitcnt lgkmcnt(8)
    v_mfma_f32_16x16x32_bf16 v[40:43], a[0:3], a[236:239], v[40:43]
    ds_read_b64_tr_b16 a[24:25], v1 offset:30976
    buffer_load_dwordx4 a[64:67], v8, s[24:27], s28 offen offset:2048 sc1
    v_mfma_f32_16x16x32_bf16 v[52:55], a[4:7], a[236:239], v[52:55]
    v_mfma_f32_16x16x32_bf16 v[56:59], a[4:7], a[240:243], v[56:59]
    ds_read_b64_tr_b16 a[26:27], v1 offset:36096
    v_mfma_f32_16x16x32_bf16 v[44:47], a[0:3], a[240:243], v[44:47]
    ds_read_b64_tr_b16 a[28:29], v2 offset:30976
    v_mfma_f32_16x16x32_bf16 v[48:51], a[0:3], a[244:247], v[48:51]
    v_mfma_f32_16x16x32_bf16 v[60:63], a[4:7], a[244:247], v[60:63]
    ds_read_b64_tr_b16 a[30:31], v2 offset:36096
    buffer_load_dwordx4 a[68:71], v8, s[24:27], s5 offen offset:0 sc1
    s_waitcnt lgkmcnt(8)
    v_mfma_f32_16x16x32_bf16 v[72:75], a[8:11], a[244:247], v[72:75]
    v_mfma_f32_16x16x32_bf16 v[84:87], a[12:15], a[244:247], v[84:87]
    v_add_u32 v1, 40960, v1
    v_mfma_f32_16x16x32_bf16 v[80:83], a[12:15], a[240:243], v[80:83]
    v_mfma_f32_16x16x32_bf16 v[68:71], a[8:11], a[240:243], v[68:71]
    v_add_u32 v2, 40960, v2
    buffer_load_dwordx4 a[72:75], v8, s[24:27], s5 offen offset:1024 sc1
    v_mfma_f32_16x16x32_bf16 v[64:67], a[8:11], a[236:239], v[64:67]
    v_mfma_f32_16x16x32_bf16 v[76:79], a[12:15], a[236:239], v[76:79]
    s_waitcnt lgkmcnt(0)
    s_barrier
    v_mfma_f32_16x16x32_bf16 v[88:91], a[16:19], a[236:239], v[88:91]
    ds_read_b64_tr_b16 a[0:1], v1 offset:0
    v_mfma_f32_16x16x32_bf16 v[100:103], a[20:23], a[236:239], v[100:103]
    ds_read_b64_tr_b16 a[2:3], v1 offset:5120
    v_mfma_f32_16x16x32_bf16 v[104:107], a[20:23], a[240:243], v[104:107]
    ds_read_b64_tr_b16 a[4:5], v2 offset:0
    buffer_load_dwordx4 a[76:79], v8, s[24:27], s5 offen offset:2048 sc1
    v_mfma_f32_16x16x32_bf16 v[92:95], a[16:19], a[240:243], v[92:95]
    ds_read_b64_tr_b16 a[6:7], v2 offset:5120
    v_mfma_f32_16x16x32_bf16 v[96:99], a[16:19], a[244:247], v[96:99]
    ds_read_b64_tr_b16 a[8:9], v1 offset:64
    v_mfma_f32_16x16x32_bf16 v[108:111], a[20:23], a[244:247], v[108:111]
    ds_read_b64_tr_b16 a[10:11], v1 offset:5184
    v_mfma_f32_16x16x32_bf16 v[120:123], a[24:27], a[244:247], v[120:123]
    ds_read_b64_tr_b16 a[12:13], v2 offset:64
    buffer_load_dwordx4 a[80:83], v8, s[24:27], s7 offen offset:0 sc1
    v_mfma_f32_16x16x32_bf16 v[132:135], a[28:31], a[244:247], v[132:135]
    ds_read_b64_tr_b16 a[14:15], v2 offset:5184
    v_mfma_f32_16x16x32_bf16 v[128:131], a[28:31], a[240:243], v[128:131]
    ds_read_b64_tr_b16 a[16:17], v1 offset:128
    v_mfma_f32_16x16x32_bf16 v[116:119], a[24:27], a[240:243], v[116:119]
    ds_read_b64_tr_b16 a[18:19], v1 offset:5248
    v_mfma_f32_16x16x32_bf16 v[112:115], a[24:27], a[236:239], v[112:115]
    ds_read_b64_tr_b16 a[20:21], v2 offset:128
    buffer_load_dwordx4 a[84:87], v8, s[24:27], s7 offen offset:1024 sc1
    v_mfma_f32_16x16x32_bf16 v[124:127], a[28:31], a[236:239], v[124:127]
    ds_read_b64_tr_b16 a[22:23], v2 offset:5248
    s_waitcnt vmcnt(11)
    s_waitcnt lgkmcnt(8)
    v_mfma_f32_16x16x32_bf16 v[16:19], a[0:3], a[32:35], v[16:19]
    ds_read_b64_tr_b16 a[24:25], v1 offset:192
    v_mfma_f32_16x16x32_bf16 v[28:31], a[4:7], a[32:35], v[28:31]
    v_mfma_f32_16x16x32_bf16 v[32:35], a[4:7], a[36:39], v[32:35]
    ds_read_b64_tr_b16 a[26:27], v1 offset:5312
    v_mfma_f32_16x16x32_bf16 v[20:23], a[0:3], a[36:39], v[20:23]
    ds_read_b64_tr_b16 a[28:29], v2 offset:192
    buffer_load_dwordx4 a[88:91], v8, s[24:27], s7 offen offset:2048 sc1
    v_mfma_f32_16x16x32_bf16 v[24:27], a[0:3], a[40:43], v[24:27]
    v_mfma_f32_16x16x32_bf16 v[36:39], a[4:7], a[40:43], v[36:39]
    ds_read_b64_tr_b16 a[30:31], v2 offset:5312
    s_waitcnt lgkmcnt(8)
    v_mfma_f32_16x16x32_bf16 v[48:51], a[8:11], a[40:43], v[48:51]
    ds_read_b64_tr_b16 a[0:1], v1 offset:256
    v_mfma_f32_16x16x32_bf16 v[60:63], a[12:15], a[40:43], v[60:63]
    buffer_load_dwordx4 a[92:95], v8, s[24:27], s29 offen offset:0 sc1
    v_mfma_f32_16x16x32_bf16 v[56:59], a[12:15], a[36:39], v[56:59]
    ds_read_b64_tr_b16 a[2:3], v1 offset:5376
    v_mfma_f32_16x16x32_bf16 v[44:47], a[8:11], a[36:39], v[44:47]
    ds_read_b64_tr_b16 a[4:5], v2 offset:256
    v_mfma_f32_16x16x32_bf16 v[40:43], a[8:11], a[32:35], v[40:43]
    v_mfma_f32_16x16x32_bf16 v[52:55], a[12:15], a[32:35], v[52:55]
    ds_read_b64_tr_b16 a[6:7], v2 offset:5376
    buffer_load_dwordx4 a[96:99], v8, s[24:27], s29 offen offset:1024 sc1
    s_waitcnt lgkmcnt(8)
    v_mfma_f32_16x16x32_bf16 v[64:67], a[16:19], a[32:35], v[64:67]
    ds_read_b64_tr_b16 a[8:9], v1 offset:10240
    v_mfma_f32_16x16x32_bf16 v[76:79], a[20:23], a[32:35], v[76:79]
    v_mfma_f32_16x16x32_bf16 v[80:83], a[20:23], a[36:39], v[80:83]
    ds_read_b64_tr_b16 a[10:11], v1 offset:15360
    v_mfma_f32_16x16x32_bf16 v[68:71], a[16:19], a[36:39], v[68:71]
    ds_read_b64_tr_b16 a[12:13], v2 offset:10240
    v_mfma_f32_16x16x32_bf16 v[72:75], a[16:19], a[40:43], v[72:75]
    buffer_load_dwordx4 a[100:103], v8, s[24:27], s29 offen offset:2048 sc1
    v_mfma_f32_16x16x32_bf16 v[84:87], a[20:23], a[40:43], v[84:87]
    ds_read_b64_tr_b16 a[14:15], v2 offset:15360
    s_waitcnt lgkmcnt(8)
    v_mfma_f32_16x16x32_bf16 v[96:99], a[24:27], a[40:43], v[96:99]
    ds_read_b64_tr_b16 a[16:17], v1 offset:10304
    v_mfma_f32_16x16x32_bf16 v[108:111], a[28:31], a[40:43], v[108:111]
    v_mfma_f32_16x16x32_bf16 v[104:107], a[28:31], a[36:39], v[104:107]
    ds_read_b64_tr_b16 a[18:19], v1 offset:15424
    buffer_load_dwordx4 a[104:107], v9, s[24:27], s4 offen offset:0 sc1
    v_mfma_f32_16x16x32_bf16 v[92:95], a[24:27], a[36:39], v[92:95]
    ds_read_b64_tr_b16 a[20:21], v2 offset:10304
    v_mfma_f32_16x16x32_bf16 v[88:91], a[24:27], a[32:35], v[88:91]
    v_mfma_f32_16x16x32_bf16 v[100:103], a[28:31], a[32:35], v[100:103]
    ds_read_b64_tr_b16 a[22:23], v2 offset:15424
    s_waitcnt lgkmcnt(8)
    v_mfma_f32_16x16x32_bf16 v[112:115], a[0:3], a[32:35], v[112:115]
    ds_read_b64_tr_b16 a[24:25], v1 offset:10368
    v_mfma_f32_16x16x32_bf16 v[124:127], a[4:7], a[32:35], v[124:127]
    buffer_load_dwordx4 a[108:111], v9, s[24:27], s4 offen offset:1024 sc1
    v_mfma_f32_16x16x32_bf16 v[128:131], a[4:7], a[36:39], v[128:131]
    ds_read_b64_tr_b16 a[26:27], v1 offset:15488
    v_mfma_f32_16x16x32_bf16 v[116:119], a[0:3], a[36:39], v[116:119]
    ds_read_b64_tr_b16 a[28:29], v2 offset:10368
    v_mfma_f32_16x16x32_bf16 v[120:123], a[0:3], a[40:43], v[120:123]
    v_mfma_f32_16x16x32_bf16 v[132:135], a[4:7], a[40:43], v[132:135]
    ds_read_b64_tr_b16 a[30:31], v2 offset:15488
    s_waitcnt vmcnt(14)
    buffer_load_dwordx4 a[112:115], v9, s[24:27], s4 offen offset:2048 sc1
    s_waitcnt lgkmcnt(8)
    v_mfma_f32_16x16x32_bf16 v[24:27], a[8:11], a[52:55], v[24:27]
    ds_read_b64_tr_b16 a[0:1], v1 offset:10432
    v_mfma_f32_16x16x32_bf16 v[36:39], a[12:15], a[52:55], v[36:39]
    v_mfma_f32_16x16x32_bf16 v[32:35], a[12:15], a[48:51], v[32:35]
    ds_read_b64_tr_b16 a[2:3], v1 offset:15552
    v_mfma_f32_16x16x32_bf16 v[20:23], a[8:11], a[48:51], v[20:23]
    ds_read_b64_tr_b16 a[4:5], v2 offset:10432
    buffer_load_dwordx4 a[116:119], v9, s[24:27], s6 offen offset:0 sc1
    v_mfma_f32_16x16x32_bf16 v[16:19], a[8:11], a[44:47], v[16:19]
    v_mfma_f32_16x16x32_bf16 v[28:31], a[12:15], a[44:47], v[28:31]
    ds_read_b64_tr_b16 a[6:7], v2 offset:15552
    s_waitcnt lgkmcnt(8)
    v_mfma_f32_16x16x32_bf16 v[40:43], a[16:19], a[44:47], v[40:43]
    ds_read_b64_tr_b16 a[8:9], v1 offset:10496
    v_mfma_f32_16x16x32_bf16 v[52:55], a[20:23], a[44:47], v[52:55]
    v_mfma_f32_16x16x32_bf16 v[56:59], a[20:23], a[48:51], v[56:59]
    ds_read_b64_tr_b16 a[10:11], v1 offset:15616
    buffer_load_dwordx4 a[120:123], v9, s[24:27], s6 offen offset:1024 sc1
    v_mfma_f32_16x16x32_bf16 v[44:47], a[16:19], a[48:51], v[44:47]
    ds_read_b64_tr_b16 a[12:13], v2 offset:10496
    v_mfma_f32_16x16x32_bf16 v[48:51], a[16:19], a[52:55], v[48:51]
    v_mfma_f32_16x16x32_bf16 v[60:63], a[20:23], a[52:55], v[60:63]
    ds_read_b64_tr_b16 a[14:15], v2 offset:15616
    s_waitcnt lgkmcnt(8)
    v_mfma_f32_16x16x32_bf16 v[72:75], a[24:27], a[52:55], v[72:75]
    ds_read_b64_tr_b16 a[16:17], v1 offset:20480
    buffer_load_dwordx4 a[124:127], v9, s[24:27], s6 offen offset:2048 sc1
    v_mfma_f32_16x16x32_bf16 v[84:87], a[28:31], a[52:55], v[84:87]
    v_mfma_f32_16x16x32_bf16 v[80:83], a[28:31], a[48:51], v[80:83]
    ds_read_b64_tr_b16 a[18:19], v1 offset:25600
    v_mfma_f32_16x16x32_bf16 v[68:71], a[24:27], a[48:51], v[68:71]
    ds_read_b64_tr_b16 a[20:21], v2 offset:20480
    v_mfma_f32_16x16x32_bf16 v[64:67], a[24:27], a[44:47], v[64:67]
    buffer_load_dwordx4 a[128:131], v9, s[24:27], s28 offen offset:0 sc1
    v_mfma_f32_16x16x32_bf16 v[76:79], a[28:31], a[44:47], v[76:79]
    ds_read_b64_tr_b16 a[22:23], v2 offset:25600
    s_waitcnt lgkmcnt(8)
    v_mfma_f32_16x16x32_bf16 v[88:91], a[0:3], a[44:47], v[88:91]
    ds_read_b64_tr_b16 a[24:25], v1 offset:20544
    v_mfma_f32_16x16x32_bf16 v[100:103], a[4:7], a[44:47], v[100:103]
    v_mfma_f32_16x16x32_bf16 v[104:107], a[4:7], a[48:51], v[104:107]
    ds_read_b64_tr_b16 a[26:27], v1 offset:25664
    v_mfma_f32_16x16x32_bf16 v[92:95], a[0:3], a[48:51], v[92:95]
    ds_read_b64_tr_b16 a[28:29], v2 offset:20544
    buffer_load_dwordx4 a[132:135], v9, s[24:27], s28 offen offset:1024 sc1
    v_mfma_f32_16x16x32_bf16 v[96:99], a[0:3], a[52:55], v[96:99]
    v_mfma_f32_16x16x32_bf16 v[108:111], a[4:7], a[52:55], v[108:111]
    ds_read_b64_tr_b16 a[30:31], v2 offset:25664
    s_waitcnt lgkmcnt(8)
    v_mfma_f32_16x16x32_bf16 v[120:123], a[8:11], a[52:55], v[120:123]
    ds_read_b64_tr_b16 a[0:1], v1 offset:20608
    v_mfma_f32_16x16x32_bf16 v[132:135], a[12:15], a[52:55], v[132:135]
    buffer_load_dwordx4 a[136:139], v9, s[24:27], s28 offen offset:2048 sc1
    v_mfma_f32_16x16x32_bf16 v[128:131], a[12:15], a[48:51], v[128:131]
    ds_read_b64_tr_b16 a[2:3], v1 offset:25728
    v_mfma_f32_16x16x32_bf16 v[116:119], a[8:11], a[48:51], v[116:119]
    ds_read_b64_tr_b16 a[4:5], v2 offset:20608
    v_mfma_f32_16x16x32_bf16 v[112:115], a[8:11], a[44:47], v[112:115]
    v_mfma_f32_16x16x32_bf16 v[124:127], a[12:15], a[44:47], v[124:127]
    ds_read_b64_tr_b16 a[6:7], v2 offset:25728
    s_waitcnt vmcnt(18)
    s_waitcnt lgkmcnt(8)
    v_mfma_f32_16x16x32_bf16 v[16:19], a[16:19], a[56:59], v[16:19]
    ds_read_b64_tr_b16 a[8:9], v1 offset:20672
    buffer_load_dwordx4 a[140:143], v9, s[24:27], s5 offen offset:0 sc1
    v_mfma_f32_16x16x32_bf16 v[28:31], a[20:23], a[56:59], v[28:31]
    v_mfma_f32_16x16x32_bf16 v[32:35], a[20:23], a[60:63], v[32:35]
    ds_read_b64_tr_b16 a[10:11], v1 offset:25792
    v_mfma_f32_16x16x32_bf16 v[20:23], a[16:19], a[60:63], v[20:23]
    ds_read_b64_tr_b16 a[12:13], v2 offset:20672
    v_mfma_f32_16x16x32_bf16 v[24:27], a[16:19], a[64:67], v[24:27]
    buffer_load_dwordx4 a[144:147], v9, s[24:27], s5 offen offset:1024 sc1
    v_mfma_f32_16x16x32_bf16 v[36:39], a[20:23], a[64:67], v[36:39]
    ds_read_b64_tr_b16 a[14:15], v2 offset:25792
    s_waitcnt lgkmcnt(8)
    v_mfma_f32_16x16x32_bf16 v[48:51], a[24:27], a[64:67], v[48:51]
    ds_read_b64_tr_b16 a[16:17], v1 offset:20736
    v_mfma_f32_16x16x32_bf16 v[60:63], a[28:31], a[64:67], v[60:63]
    v_mfma_f32_16x16x32_bf16 v[56:59], a[28:31], a[60:63], v[56:59]
    ds_read_b64_tr_b16 a[18:19], v1 offset:25856
    buffer_load_dwordx4 a[148:151], v9, s[24:27], s5 offen offset:2048 sc1
    v_mfma_f32_16x16x32_bf16 v[44:47], a[24:27], a[60:63], v[44:47]
    ds_read_b64_tr_b16 a[20:21], v2 offset:20736
    v_mfma_f32_16x16x32_bf16 v[40:43], a[24:27], a[56:59], v[40:43]
    v_mfma_f32_16x16x32_bf16 v[52:55], a[28:31], a[56:59], v[52:55]
    ds_read_b64_tr_b16 a[22:23], v2 offset:25856
    s_waitcnt lgkmcnt(8)
    v_mfma_f32_16x16x32_bf16 v[64:67], a[0:3], a[56:59], v[64:67]
    ds_read_b64_tr_b16 a[24:25], v1 offset:30720
    v_mfma_f32_16x16x32_bf16 v[76:79], a[4:7], a[56:59], v[76:79]
    buffer_load_dwordx4 a[152:155], v9, s[24:27], s7 offen offset:0 sc1
    v_mfma_f32_16x16x32_bf16 v[80:83], a[4:7], a[60:63], v[80:83]
    ds_read_b64_tr_b16 a[26:27], v1 offset:35840
    v_mfma_f32_16x16x32_bf16 v[68:71], a[0:3], a[60:63], v[68:71]
    ds_read_b64_tr_b16 a[28:29], v2 offset:30720
    v_mfma_f32_16x16x32_bf16 v[72:75], a[0:3], a[64:67], v[72:75]
    v_mfma_f32_16x16x32_bf16 v[84:87], a[4:7], a[64:67], v[84:87]
    ds_read_b64_tr_b16 a[30:31], v2 offset:35840
    buffer_load_dwordx4 a[156:159], v9, s[24:27], s7 offen offset:1024 sc1
    s_waitcnt lgkmcnt(8)
    v_mfma_f32_16x16x32_bf16 v[96:99], a[8:11], a[64:67], v[96:99]
    ds_read_b64_tr_b16 a[0:1], v1 offset:30784
    v_mfma_f32_16x16x32_bf16 v[108:111], a[12:15], a[64:67], v[108:111]
    v_mfma_f32_16x16x32_bf16 v[104:107], a[12:15], a[60:63], v[104:107]
    ds_read_b64_tr_b16 a[2:3], v1 offset:35904
    v_mfma_f32_16x16x32_bf16 v[92:95], a[8:11], a[60:63], v[92:95]
    ds_read_b64_tr_b16 a[4:5], v2 offset:30784
    buffer_load_dwordx4 a[160:163], v9, s[24:27], s7 offen offset:2048 sc1
    v_mfma_f32_16x16x32_bf16 v[88:91], a[8:11], a[56:59], v[88:91]
    v_mfma_f32_16x16x32_bf16 v[100:103], a[12:15], a[56:59], v[100:103]
    ds_read_b64_tr_b16 a[6:7], v2 offset:35904
    s_waitcnt lgkmcnt(8)
    v_mfma_f32_16x16x32_bf16 v[112:115], a[16:19], a[56:59], v[112:115]
    ds_read_b64_tr_b16 a[8:9], v1 offset:30848
    v_mfma_f32_16x16x32_bf16 v[124:127], a[20:23], a[56:59], v[124:127]
    v_mfma_f32_16x16x32_bf16 v[128:131], a[20:23], a[60:63], v[128:131]
    ds_read_b64_tr_b16 a[10:11], v1 offset:35968
    buffer_load_dwordx4 a[164:167], v9, s[24:27], s29 offen offset:0 sc1
    v_mfma_f32_16x16x32_bf16 v[116:119], a[16:19], a[60:63], v[116:119]
    ds_read_b64_tr_b16 a[12:13], v2 offset:30848
    v_mfma_f32_16x16x32_bf16 v[120:123], a[16:19], a[64:67], v[120:123]
    v_mfma_f32_16x16x32_bf16 v[132:135], a[20:23], a[64:67], v[132:135]
    ds_read_b64_tr_b16 a[14:15], v2 offset:35968
    s_waitcnt vmcnt(22)
    s_waitcnt lgkmcnt(8)
    v_mfma_f32_16x16x32_bf16 v[24:27], a[24:27], a[76:79], v[24:27]
    ds_read_b64_tr_b16 a[16:17], v1 offset:30912
    buffer_load_dwordx4 a[168:171], v9, s[24:27], s29 offen offset:1024 sc1
    v_mfma_f32_16x16x32_bf16 v[36:39], a[28:31], a[76:79], v[36:39]
    v_mfma_f32_16x16x32_bf16 v[32:35], a[28:31], a[72:75], v[32:35]
    ds_read_b64_tr_b16 a[18:19], v1 offset:36032
    v_mfma_f32_16x16x32_bf16 v[20:23], a[24:27], a[72:75], v[20:23]
    ds_read_b64_tr_b16 a[20:21], v2 offset:30912
    v_mfma_f32_16x16x32_bf16 v[16:19], a[24:27], a[68:71], v[16:19]
    v_mfma_f32_16x16x32_bf16 v[28:31], a[28:31], a[68:71], v[28:31]
    ds_read_b64_tr_b16 a[22:23], v2 offset:36032
    buffer_load_dwordx4 a[172:175], v9, s[24:27], s29 offen offset:2048 sc1
    s_waitcnt lgkmcnt(8)
    v_mfma_f32_16x16x32_bf16 v[40:43], a[0:3], a[68:71], v[40:43]
    ds_read_b64_tr_b16 a[24:25], v1 offset:30976
    v_mfma_f32_16x16x32_bf16 v[52:55], a[4:7], a[68:71], v[52:55]
    v_mfma_f32_16x16x32_bf16 v[56:59], a[4:7], a[72:75], v[56:59]
    ds_read_b64_tr_b16 a[26:27], v1 offset:36096
    v_mfma_f32_16x16x32_bf16 v[44:47], a[0:3], a[72:75], v[44:47]
    ds_read_b64_tr_b16 a[28:29], v2 offset:30976
    v_mfma_f32_16x16x32_bf16 v[48:51], a[0:3], a[76:79], v[48:51]
    v_mfma_f32_16x16x32_bf16 v[60:63], a[4:7], a[76:79], v[60:63]
    ds_read_b64_tr_b16 a[30:31], v2 offset:36096
    s_waitcnt lgkmcnt(8)
    v_mfma_f32_16x16x32_bf16 v[72:75], a[8:11], a[76:79], v[72:75]
    v_add_u32 v1, 40960, v1
    v_mfma_f32_16x16x32_bf16 v[84:87], a[12:15], a[76:79], v[84:87]
    v_add_u32 v2, 40960, v2
    v_mfma_f32_16x16x32_bf16 v[80:83], a[12:15], a[72:75], v[80:83]
    v_mfma_f32_16x16x32_bf16 v[68:71], a[8:11], a[72:75], v[68:71]
    v_add_u32 v3, -122880, v1
    v_mfma_f32_16x16x32_bf16 v[64:67], a[8:11], a[68:71], v[64:67]
    v_add_u32 v4, -122880, v2
    v_mfma_f32_16x16x32_bf16 v[76:79], a[12:15], a[68:71], v[76:79]
    s_waitcnt lgkmcnt(0)
    s_barrier
    v_mfma_f32_16x16x32_bf16 v[88:91], a[16:19], a[68:71], v[88:91]
    ds_read_b64_tr_b16 a[0:1], v1 offset:0
    v_mfma_f32_16x16x32_bf16 v[100:103], a[20:23], a[68:71], v[100:103]
    ds_read_b64_tr_b16 a[2:3], v1 offset:5120
    v_mfma_f32_16x16x32_bf16 v[104:107], a[20:23], a[72:75], v[104:107]
    ds_read_b64_tr_b16 a[4:5], v2 offset:0
    v_mfma_f32_16x16x32_bf16 v[92:95], a[16:19], a[72:75], v[92:95]
    ds_read_b64_tr_b16 a[6:7], v2 offset:5120
    v_mfma_f32_16x16x32_bf16 v[96:99], a[16:19], a[76:79], v[96:99]
    ds_read_b64_tr_b16 a[8:9], v1 offset:10240
    v_mfma_f32_16x16x32_bf16 v[108:111], a[20:23], a[76:79], v[108:111]
    ds_read_b64_tr_b16 a[10:11], v1 offset:15360
    v_mfma_f32_16x16x32_bf16 v[120:123], a[24:27], a[76:79], v[120:123]
    ds_read_b64_tr_b16 a[12:13], v2 offset:10240
    v_mfma_f32_16x16x32_bf16 v[132:135], a[28:31], a[76:79], v[132:135]
    ds_read_b64_tr_b16 a[14:15], v2 offset:15360
    v_mfma_f32_16x16x32_bf16 v[128:131], a[28:31], a[72:75], v[128:131]
    ds_read_b64_tr_b16 a[16:17], v1 offset:20480
    v_mfma_f32_16x16x32_bf16 v[116:119], a[24:27], a[72:75], v[116:119]
    ds_read_b64_tr_b16 a[18:19], v1 offset:25600
    v_mfma_f32_16x16x32_bf16 v[112:115], a[24:27], a[68:71], v[112:115]
    ds_read_b64_tr_b16 a[20:21], v2 offset:20480
    v_mfma_f32_16x16x32_bf16 v[124:127], a[28:31], a[68:71], v[124:127]
    ds_read_b64_tr_b16 a[22:23], v2 offset:25600
L_last:
    s_waitcnt vmcnt(21)
    s_waitcnt lgkmcnt(8)
    v_mfma_f32_16x16x32_bf16 v[16:19], a[0:3], a[80:83], v[16:19]
    ds_read_b64_tr_b16 a[24:25], v1 offset:30720
    v_mfma_f32_16x16x32_bf16 v[28:31], a[4:7], a[80:83], v[28:31]
    s_mul_i32 s39, s71, 15360
    v_mfma_f32_16x16x32_bf16 v[32:35], a[4:7], a[84:87], v[32:35]
    ds_read_b64_tr_b16 a[26:27], v1 offset:35840
    v_mfma_f32_16x16x32_bf16 v[20:23], a[0:3], a[84:87], v[20:23]
    ds_read_b64_tr_b16 a[28:29], v2 offset:30720
    s_add_u32 s39, s39, s68
    v_mfma_f32_16x16x32_bf16 v[24:27], a[0:3], a[88:91], v[24:27]
    v_and_b32 v12, 63, v0
    v_mfma_f32_16x16x32_bf16 v[36:39], a[4:7], a[88:91], v[36:39]
    ds_read_b64_tr_b16 a[30:31], v2 offset:35840
    s_waitcnt vmcnt(18)
    s_waitcnt lgkmcnt(8)
    v_mfma_f32_16x16x32_bf16 v[16:19], a[8:11], a[92:95], v[16:19]
    ds_read_b64_tr_b16 a[0:1], v3 offset:0
    v_mfma_f32_16x16x32_bf16 v[28:31], a[12:15], a[92:95], v[28:31]
    v_and_b32 v13, 7, v12
    v_mfma_f32_16x16x32_bf16 v[32:35], a[12:15], a[96:99], v[32:35]
    ds_read_b64_tr_b16 a[2:3], v3 offset:5120
    v_mfma_f32_16x16x32_bf16 v[20:23], a[8:11], a[96:99], v[20:23]
    ds_read_b64_tr_b16 a[4:5], v4 offset:0
    v_mfma_f32_16x16x32_bf16 v[24:27], a[8:11], a[100:103], v[24:27]
    v_min_u32 v13, 6, v13
    v_mfma_f32_16x16x32_bf16 v[36:39], a[12:15], a[100:103], v[36:39]
    ds_read_b64_tr_b16 a[6:7], v4 offset:5120
    s_waitcnt vmcnt(15)
    s_waitcnt lgkmcnt(8)
    v_mfma_f32_16x16x32_bf16 v[16:19], a[16:19], a[104:107], v[16:19]
    ds_read_b64_tr_b16 a[8:9], v3 offset:10240
    v_mfma_f32_16x16x32_bf16 v[28:31], a[20:23], a[104:107], v[28:31]
    v_add3_u32 v13, v13, s80, 1
    v_mfma_f32_16x16x32_bf16 v[32:35], a[20:23], a[108:111], v[32:35]
    ds_read_b64_tr_b16 a[10:11], v3 offset:15360
    v_mfma_f32_16x16x32_bf16 v[20:23], a[16:19], a[108:111], v[20:23]
    ds_read_b64_tr_b16 a[12:13], v4 offset:10240
    v_and_b32 v13, 7, v13
    v_mfma_f32_16x16x32_bf16 v[24:27], a[16:19], a[112:115], v[24:27]
    v_lshlrev_b32 v13, 7, v13
    v_mfma_f32_16x16x32_bf16 v[36:39], a[20:23], a[112:115], v[36:39]
    ds_read_b64_tr_b16 a[14:15], v4 offset:15360
    s_waitcnt vmcnt(12)
    s_waitcnt lgkmcnt(8)
    v_mfma_f32_16x16x32_bf16 v[16:19], a[24:27], a[116:119], v[16:19]
    ds_read_b64_tr_b16 a[16:17], v3 offset:20480
    v_mfma_f32_16x16x32_bf16 v[28:31], a[28:31], a[116:119], v[28:31]
    v_and_b32 v14, 8, v12
    v_mfma_f32_16x16x32_bf16 v[32:35], a[28:31], a[120:123], v[32:35]
    ds_read_b64_tr_b16 a[18:19], v3 offset:25600
    v_mfma_f32_16x16x32_bf16 v[20:23], a[24:27], a[120:123], v[20:23]
    ds_read_b64_tr_b16 a[20:21], v4 offset:20480
    v_mfma_f32_16x16x32_bf16 v[24:27], a[24:27], a[124:127], v[24:27]
    v_lshl_add_u32 v13, v14, 3, v13
    v_mfma_f32_16x16x32_bf16 v[36:39], a[28:31], a[124:127], v[36:39]
    ds_read_b64_tr_b16 a[22:23], v4 offset:25600
    s_waitcnt vmcnt(9)
    s_waitcnt lgkmcnt(8)
    v_mfma_f32_16x16x32_bf16 v[16:19], a[0:3], a[128:131], v[16:19]
    ds_read_b64_tr_b16 a[24:25], v3 offset:30720
    v_mfma_f32_16x16x32_bf16 v[28:31], a[4:7], a[128:131], v[28:31]
    s_add_u32 s72, s68, 491520
    v_mfma_f32_16x16x32_bf16 v[32:35], a[4:7], a[132:135], v[32:35]
    ds_read_b64_tr_b16 a[26:27], v3 offset:35840
    v_mfma_f32_16x16x32_bf16 v[20:23], a[0:3], a[132:135], v[20:23]
    ds_read_b64_tr_b16 a[28:29], v4 offset:30720
    v_add_u32 v242, s72, v13
    v_mfma_f32_16x16x32_bf16 v[24:27], a[0:3], a[136:139], v[24:27]
    v_and_b32 v13, 15, v12
    v_mfma_f32_16x16x32_bf16 v[36:39], a[4:7], a[136:139], v[36:39]
    ds_read_b64_tr_b16 a[30:31], v4 offset:35840
    s_waitcnt vmcnt(6)
    s_waitcnt lgkmcnt(8)
    v_mfma_f32_16x16x32_bf16 v[16:19], a[8:11], a[140:143], v[16:19]
    ds_read_b64_tr_b16 a[0:1], v1 offset:64
    v_mfma_f32_16x16x32_bf16 v[28:31], a[12:15], a[140:143], v[28:31]
    v_mul_u32_u24 v13, 1280, v13
    v_mfma_f32_16x16x32_bf16 v[32:35], a[12:15], a[144:147], v[32:35]
    ds_read_b64_tr_b16 a[2:3], v1 offset:5184
    v_mfma_f32_16x16x32_bf16 v[20:23], a[8:11], a[144:147], v[20:23]
    ds_read_b64_tr_b16 a[4:5], v2 offset:64
    v_mfma_f32_16x16x32_bf16 v[24:27], a[8:11], a[148:151], v[24:27]
    v_lshrrev_b32 v14, 4, v12
    v_mfma_f32_16x16x32_bf16 v[36:39], a[12:15], a[148:151], v[36:39]
    ds_read_b64_tr_b16 a[6:7], v2 offset:5184
    s_waitcnt vmcnt(3)
    s_waitcnt lgkmcnt(8)
    v_mfma_f32_16x16x32_bf16 v[16:19], a[16:19], a[152:155], v[16:19]
    ds_read_b64_tr_b16 a[8:9], v1 offset:10304
    v_mfma_f32_16x16x32_bf16 v[28:31], a[20:23], a[152:155], v[28:31]
    v_lshl_add_u32 v5, v14, 4, v13
    v_mfma_f32_16x16x32_bf16 v[32:35], a[20:23], a[156:159], v[32:35]
    ds_read_b64_tr_b16 a[10:11], v1 offset:15424
    v_mfma_f32_16x16x32_bf16 v[20:23], a[16:19], a[156:159], v[20:23]
    ds_read_b64_tr_b16 a[12:13], v2 offset:10304
    s_lshl_b32 s54, s80, 7
    v_mfma_f32_16x16x32_bf16 v[24:27], a[16:19], a[160:163], v[24:27]
    s_add_u32 s54, s54, s72
    v_mfma_f32_16x16x32_bf16 v[36:39], a[20:23], a[160:163], v[36:39]
    ds_read_b64_tr_b16 a[14:15], v2 offset:15424
    s_waitcnt vmcnt(0)
    s_waitcnt lgkmcnt(8)
    v_mfma_f32_16x16x32_bf16 v[16:19], a[24:27], a[164:167], v[16:19]
    ds_read_b64_tr_b16 a[16:17], v1 offset:20544
    v_mfma_f32_16x16x32_bf16 v[28:31], a[28:31], a[164:167], v[28:31]
    s_mov_b32 s73, 0xffff0000
    v_mfma_f32_16x16x32_bf16 v[32:35], a[28:31], a[168:171], v[32:35]
    ds_read_b64_tr_b16 a[18:19], v1 offset:25664
    v_mfma_f32_16x16x32_bf16 v[20:23], a[24:27], a[168:171], v[20:23]
    ds_read_b64_tr_b16 a[20:21], v2 offset:20544
    v_mfma_f32_16x16x32_bf16 v[24:27], a[24:27], a[172:175], v[24:27]
    v_mfma_f32_16x16x32_bf16 v[36:39], a[28:31], a[172:175], v[36:39]
    ds_read_b64_tr_b16 a[22:23], v2 offset:25664
    s_waitcnt lgkmcnt(8)
    v_mfma_f32_16x16x32_bf16 v[40:43], a[0:3], a[80:83], v[40:43]
    ds_read_b64_tr_b16 a[24:25], v1 offset:30784
    v_mfma_f32_16x16x32_bf16 v[52:55], a[4:7], a[80:83], v[52:55]
    v_mfma_f32_16x16x32_bf16 v[56:59], a[4:7], a[84:87], v[56:59]
    ds_read_b64_tr_b16 a[26:27], v1 offset:35904
    v_mfma_f32_16x16x32_bf16 v[44:47], a[0:3], a[84:87], v[44:47]
    ds_read_b64_tr_b16 a[28:29], v2 offset:30784
    v_mfma_f32_16x16x32_bf16 v[48:51], a[0:3], a[88:91], v[48:51]
    v_cvt_pk_bf16_f32 v160, v16, v17
    v_mfma_f32_16x16x32_bf16 v[60:63], a[4:7], a[88:91], v[60:63]
    ds_read_b64_tr_b16 a[30:31], v2 offset:35904
    s_waitcnt lgkmcnt(8)
    v_mfma_f32_16x16x32_bf16 v[40:43], a[8:11], a[92:95], v[40:43]
    ds_read_b64_tr_b16 a[0:1], v3 offset:64
    v_mfma_f32_16x16x32_bf16 v[52:55], a[12:15], a[92:95], v[52:55]
    v_cvt_pk_bf16_f32 v162, v28, v29
    v_mfma_f32_16x16x32_bf16 v[56:59], a[12:15], a[96:99], v[56:59]
    ds_read_b64_tr_b16 a[2:3], v3 offset:5184
    v_cvt_pk_bf16_f32 v161, v18, v19
    v_mfma_f32_16x16x32_bf16 v[44:47], a[8:11], a[96:99], v[44:47]
    ds_read_b64_tr_b16 a[4:5], v4 offset:64
    v_mfma_f32_16x16x32_bf16 v[48:51], a[8:11], a[100:103], v[48:51]
    v_cvt_pk_bf16_f32 v163, v30, v31
    v_mfma_f32_16x16x32_bf16 v[60:63], a[12:15], a[100:103], v[60:63]
    ds_read_b64_tr_b16 a[6:7], v4 offset:5184
    s_waitcnt lgkmcnt(8)
    v_mfma_f32_16x16x32_bf16 v[40:43], a[16:19], a[104:107], v[40:43]
    ds_read_b64_tr_b16 a[8:9], v3 offset:10304
    v_permlane16_swap_b32 v160, v162
    v_mfma_f32_16x16x32_bf16 v[52:55], a[20:23], a[104:107], v[52:55]
    v_permlane16_swap_b32 v161, v163
    v_mfma_f32_16x16x32_bf16 v[56:59], a[20:23], a[108:111], v[56:59]
    ds_read_b64_tr_b16 a[10:11], v3 offset:15424
    v_mfma_f32_16x16x32_bf16 v[44:47], a[16:19], a[108:111], v[44:47]
    ds_read_b64_tr_b16 a[12:13], v4 offset:10304
    s_cmp_eq_u32 s80, 0
    s_cselect_b32 s75, 0x40000000, s39
    buffer_store_dwordx4 v[160:163], v7, s[24:27], s75 offen offset:0 sc1
    v_mfma_f32_16x16x32_bf16 v[48:51], a[16:19], a[112:115], v[48:51]
    v_cvt_pk_bf16_f32 v164, v20, v21
    v_mfma_f32_16x16x32_bf16 v[60:63], a[20:23], a[112:115], v[60:63]
    ds_read_b64_tr_b16 a[14:15], v4 offset:15424
    s_waitcnt lgkmcnt(8)
    v_mfma_f32_16x16x32_bf16 v[40:43], a[24:27], a[116:119], v[40:43]
    ds_read_b64_tr_b16 a[16:17], v3 offset:20544
    v_mfma_f32_16x16x32_bf16 v[52:55], a[28:31], a[116:119], v[52:55]
    v_cvt_pk_bf16_f32 v166, v32, v33
    v_mfma_f32_16x16x32_bf16 v[56:59], a[28:31], a[120:123], v[56:59]
    ds_read_b64_tr_b16 a[18:19], v3 offset:25664
    v_cvt_pk_bf16_f32 v165, v22, v23
    v_mfma_f32_16x16x32_bf16 v[44:47], a[24:27], a[120:123], v[44:47]
    ds_read_b64_tr_b16 a[20:21], v4 offset:20544
    v_mfma_f32_16x16x32_bf16 v[48:51], a[24:27], a[124:127], v[48:51]
    v_cvt_pk_bf16_f32 v167, v34, v35
    v_mfma_f32_16x16x32_bf16 v[60:63], a[28:31], a[124:127], v[60:63]
    ds_read_b64_tr_b16 a[22:23], v4 offset:25664
    s_waitcnt lgkmcnt(8)
    v_mfma_f32_16x16x32_bf16 v[40:43], a[0:3], a[128:131], v[40:43]
    ds_read_b64_tr_b16 a[24:25], v3 offset:30784
    v_permlane16_swap_b32 v164, v166
    v_mfma_f32_16x16x32_bf16 v[52:55], a[4:7], a[128:131], v[52:55]
    v_permlane16_swap_b32 v165, v167
    v_mfma_f32_16x16x32_bf16 v[56:59], a[4:7], a[132:135], v[56:59]
    ds_read_b64_tr_b16 a[26:27], v3 offset:35904
    v_mfma_f32_16x16x32_bf16 v[44:47], a[0:3], a[132:135], v[44:47]
    ds_read_b64_tr_b16 a[28:29], v4 offset:30784
    s_cmp_eq_u32 s80, 1
    s_cselect_b32 s75, 0x40000000, s39
    buffer_store_dwordx4 v[164:167], v7, s[24:27], s75 offen offset:1024 sc1
    v_mfma_f32_16x16x32_bf16 v[48:51], a[0:3], a[136:139], v[48:51]
    v_cvt_pk_bf16_f32 v168, v24, v25
    v_mfma_f32_16x16x32_bf16 v[60:63], a[4:7], a[136:139], v[60:63]
    ds_read_b64_tr_b16 a[30:31], v4 offset:35904
    s_waitcnt lgkmcnt(8)
    v_mfma_f32_16x16x32_bf16 v[40:43], a[8:11], a[140:143], v[40:43]
    ds_read_b64_tr_b16 a[0:1], v1 offset:128
    v_mfma_f32_16x16x32_bf16 v[52:55], a[12:15], a[140:143], v[52:55]
    v_cvt_pk_bf16_f32 v170, v36, v37
    v_mfma_f32_16x16x32_bf16 v[56:59], a[12:15], a[144:147], v[56:59]
    ds_read_b64_tr_b16 a[2:3], v1 offset:5248
    v_cvt_pk_bf16_f32 v169, v26, v27
    v_mfma_f32_16x16x32_bf16 v[44:47], a[8:11], a[144:147], v[44:47]
    ds_read_b64_tr_b16 a[4:5], v2 offset:128
    v_mfma_f32_16x16x32_bf16 v[48:51], a[8:11], a[148:151], v[48:51]
    v_cvt_pk_bf16_f32 v171, v38, v39
    v_mfma_f32_16x16x32_bf16 v[60:63], a[12:15], a[148:151], v[60:63]
    ds_read_b64_tr_b16 a[6:7], v2 offset:5248
    s_waitcnt lgkmcnt(8)
    v_mfma_f32_16x16x32_bf16 v[40:43], a[16:19], a[152:155], v[40:43]
    ds_read_b64_tr_b16 a[8:9], v1 offset:10368
    v_permlane16_swap_b32 v168, v170
    v_mfma_f32_16x16x32_bf16 v[52:55], a[20:23], a[152:155], v[52:55]
    v_permlane16_swap_b32 v169, v171
    v_mfma_f32_16x16x32_bf16 v[56:59], a[20:23], a[156:159], v[56:59]
    ds_read_b64_tr_b16 a[10:11], v1 offset:15488
    v_mfma_f32_16x16x32_bf16 v[44:47], a[16:19], a[156:159], v[44:47]
    ds_read_b64_tr_b16 a[12:13], v2 offset:10368
    s_cmp_eq_u32 s80, 2
    s_cselect_b32 s75, 0x40000000, s39
    buffer_store_dwordx4 v[168:171], v7, s[24:27], s75 offen offset:2048 sc1
    v_mfma_f32_16x16x32_bf16 v[48:51], a[16:19], a[160:163], v[48:51]
    s_add_u32 s39, s39, 3072
    v_mfma_f32_16x16x32_bf16 v[60:63], a[20:23], a[160:163], v[60:63]
    ds_read_b64_tr_b16 a[14:15], v2 offset:15488
    s_waitcnt lgkmcnt(8)
    v_mfma_f32_16x16x32_bf16 v[40:43], a[24:27], a[164:167], v[40:43]
    ds_read_b64_tr_b16 a[16:17], v1 offset:20608
    v_mfma_f32_16x16x32_bf16 v[52:55], a[28:31], a[164:167], v[52:55]
    v_mfma_f32_16x16x32_bf16 v[56:59], a[28:31], a[168:171], v[56:59]
    ds_read_b64_tr_b16 a[18:19], v1 offset:25728
    v_mfma_f32_16x16x32_bf16 v[44:47], a[24:27], a[168:171], v[44:47]
    ds_read_b64_tr_b16 a[20:21], v2 offset:20608
    v_mfma_f32_16x16x32_bf16 v[48:51], a[24:27], a[172:175], v[48:51]
    v_mfma_f32_16x16x32_bf16 v[60:63], a[28:31], a[172:175], v[60:63]
    ds_read_b64_tr_b16 a[22:23], v2 offset:25728
    s_waitcnt lgkmcnt(8)
    v_mfma_f32_16x16x32_bf16 v[64:67], a[0:3], a[80:83], v[64:67]
    ds_read_b64_tr_b16 a[24:25], v1 offset:30848
    v_mfma_f32_16x16x32_bf16 v[76:79], a[4:7], a[80:83], v[76:79]
    v_mfma_f32_16x16x32_bf16 v[80:83], a[4:7], a[84:87], v[80:83]
    ds_read_b64_tr_b16 a[26:27], v1 offset:35968
    v_mfma_f32_16x16x32_bf16 v[68:71], a[0:3], a[84:87], v[68:71]
    ds_read_b64_tr_b16 a[28:29], v2 offset:30848
    v_mfma_f32_16x16x32_bf16 v[72:75], a[0:3], a[88:91], v[72:75]
    v_cvt_pk_bf16_f32 v172, v40, v41
    v_mfma_f32_16x16x32_bf16 v[84:87], a[4:7], a[88:91], v[84:87]
    ds_read_b64_tr_b16 a[30:31], v2 offset:35968
    s_waitcnt lgkmcnt(8)
    v_mfma_f32_16x16x32_bf16 v[64:67], a[8:11], a[92:95], v[64:67]
    ds_read_b64_tr_b16 a[0:1], v3 offset:128
    v_mfma_f32_16x16x32_bf16 v[76:79], a[12:15], a[92:95], v[76:79]
    v_cvt_pk_bf16_f32 v174, v52, v53
    v_mfma_f32_16x16x32_bf16 v[80:83], a[12:15], a[96:99], v[80:83]
    ds_read_b64_tr_b16 a[2:3], v3 offset:5248
    v_cvt_pk_bf16_f32 v173, v42, v43
    v_mfma_f32_16x16x32_bf16 v[68:71], a[8:11], a[96:99], v[68:71]
    ds_read_b64_tr_b16 a[4:5], v4 offset:128
    v_mfma_f32_16x16x32_bf16 v[72:75], a[8:11], a[100:103], v[72:75]
    v_cvt_pk_bf16_f32 v175, v54, v55
    v_mfma_f32_16x16x32_bf16 v[84:87], a[12:15], a[100:103], v[84:87]
    ds_read_b64_tr_b16 a[6:7], v4 offset:5248
    s_waitcnt lgkmcnt(8)
    v_mfma_f32_16x16x32_bf16 v[64:67], a[16:19], a[104:107], v[64:67]
    ds_read_b64_tr_b16 a[8:9], v3 offset:10368
    v_permlane16_swap_b32 v172, v174
    v_mfma_f32_16x16x32_bf16 v[76:79], a[20:23], a[104:107], v[76:79]
    v_permlane16_swap_b32 v173, v175
    v_mfma_f32_16x16x32_bf16 v[80:83], a[20:23], a[108:111], v[80:83]
    ds_read_b64_tr_b16 a[10:11], v3 offset:15488
    v_mfma_f32_16x16x32_bf16 v[68:71], a[16:19], a[108:111], v[68:71]
    ds_read_b64_tr_b16 a[12:13], v4 offset:10368
    s_cmp_eq_u32 s80, 3
    s_cselect_b32 s75, 0x40000000, s39
    buffer_store_dwordx4 v[172:175], v7, s[24:27], s75 offen offset:0 sc1
    v_mfma_f32_16x16x32_bf16 v[72:75], a[16:19], a[112:115], v[72:75]
    v_cvt_pk_bf16_f32 v176, v44, v45
    v_mfma_f32_16x16x32_bf16 v[84:87], a[20:23], a[112:115], v[84:87]
    ds_read_b64_tr_b16 a[14:15], v4 offset:15488
    s_waitcnt lgkmcnt(8)
    v_mfma_f32_16x16x32_bf16 v[64:67], a[24:27], a[116:119], v[64:67]
    ds_read_b64_tr_b16 a[16:17], v3 offset:20608
    v_mfma_f32_16x16x32_bf16 v[76:79], a[28:31], a[116:119], v[76:79]
    v_cvt_pk_bf16_f32 v178, v56, v57
    v_mfma_f32_16x16x32_bf16 v[80:83], a[28:31], a[120:123], v[80:83]
    ds_read_b64_tr_b16 a[18:19], v3 offset:25728
    v_cvt_pk_bf16_f32 v177, v46, v47
    v_mfma_f32_16x16x32_bf16 v[68:71], a[24:27], a[120:123], v[68:71]
    ds_read_b64_tr_b16 a[20:21], v4 offset:20608
    v_mfma_f32_16x16x32_bf16 v[72:75], a[24:27], a[124:127], v[72:75]
    v_cvt_pk_bf16_f32 v179, v58, v59
    v_mfma_f32_16x16x32_bf16 v[84:87], a[28:31], a[124:127], v[84:87]
    ds_read_b64_tr_b16 a[22:23], v4 offset:25728
    s_waitcnt lgkmcnt(8)
    v_mfma_f32_16x16x32_bf16 v[64:67], a[0:3], a[128:131], v[64:67]
    ds_read_b64_tr_b16 a[24:25], v3 offset:30848
    v_permlane16_swap_b32 v176, v178
    v_mfma_f32_16x16x32_bf16 v[76:79], a[4:7], a[128:131], v[76:79]
    v_permlane16_swap_b32 v177, v179
    v_mfma_f32_16x16x32_bf16 v[80:83], a[4:7], a[132:135], v[80:83]
    ds_read_b64_tr_b16 a[26:27], v3 offset:35968
    v_mfma_f32_16x16x32_bf16 v[68:71], a[0:3], a[132:135], v[68:71]
    ds_read_b64_tr_b16 a[28:29], v4 offset:30848
    s_cmp_eq_u32 s80, 4
    s_cselect_b32 s75, 0x40000000, s39
    buffer_store_dwordx4 v[176:179], v7, s[24:27], s75 offen offset:1024 sc1
    v_mfma_f32_16x16x32_bf16 v[72:75], a[0:3], a[136:139], v[72:75]
    v_cvt_pk_bf16_f32 v180, v48, v49
    v_mfma_f32_16x16x32_bf16 v[84:87], a[4:7], a[136:139], v[84:87]
    ds_read_b64_tr_b16 a[30:31], v4 offset:35968
    s_waitcnt lgkmcnt(8)
    v_mfma_f32_16x16x32_bf16 v[64:67], a[8:11], a[140:143], v[64:67]
    ds_read_b64_tr_b16 a[0:1], v1 offset:192
    v_mfma_f32_16x16x32_bf16 v[76:79], a[12:15], a[140:143], v[76:79]
    v_cvt_pk_bf16_f32 v182, v60, v61
    v_mfma_f32_16x16x32_bf16 v[80:83], a[12:15], a[144:147], v[80:83]
    ds_read_b64_tr_b16 a[2:3], v1 offset:5312
    v_cvt_pk_bf16_f32 v181, v50, v51
    v_mfma_f32_16x16x32_bf16 v[68:71], a[8:11], a[144:147], v[68:71]
    ds_read_b64_tr_b16 a[4:5], v2 offset:192
    v_mfma_f32_16x16x32_bf16 v[72:75], a[8:11], a[148:151], v[72:75]
    v_cvt_pk_bf16_f32 v183, v62, v63
    v_mfma_f32_16x16x32_bf16 v[84:87], a[12:15], a[148:151], v[84:87]
    ds_read_b64_tr_b16 a[6:7], v2 offset:5312
    s_waitcnt lgkmcnt(8)
    v_mfma_f32_16x16x32_bf16 v[64:67], a[16:19], a[152:155], v[64:67]
    ds_read_b64_tr_b16 a[8:9], v1 offset:10432
    v_permlane16_swap_b32 v180, v182
    v_mfma_f32_16x16x32_bf16 v[76:79], a[20:23], a[152:155], v[76:79]
    v_permlane16_swap_b32 v181, v183
    v_mfma_f32_16x16x32_bf16 v[80:83], a[20:23], a[156:159], v[80:83]
    ds_read_b64_tr_b16 a[10:11], v1 offset:15552
    v_mfma_f32_16x16x32_bf16 v[68:71], a[16:19], a[156:159], v[68:71]
    ds_read_b64_tr_b16 a[12:13], v2 offset:10432
    s_cmp_eq_u32 s80, 5
    s_cselect_b32 s75, 0x40000000, s39
    buffer_store_dwordx4 v[180:183], v7, s[24:27], s75 offen offset:2048 sc1
    v_mfma_f32_16x16x32_bf16 v[72:75], a[16:19], a[160:163], v[72:75]
    s_add_u32 s39, s39, 3072
    v_mfma_f32_16x16x32_bf16 v[84:87], a[20:23], a[160:163], v[84:87]
    ds_read_b64_tr_b16 a[14:15], v2 offset:15552
    s_waitcnt lgkmcnt(8)
    v_mfma_f32_16x16x32_bf16 v[64:67], a[24:27], a[164:167], v[64:67]
    ds_read_b64_tr_b16 a[16:17], v1 offset:20672
    v_mfma_f32_16x16x32_bf16 v[76:79], a[28:31], a[164:167], v[76:79]
    v_mfma_f32_16x16x32_bf16 v[80:83], a[28:31], a[168:171], v[80:83]
    ds_read_b64_tr_b16 a[18:19], v1 offset:25792
    v_mfma_f32_16x16x32_bf16 v[68:71], a[24:27], a[168:171], v[68:71]
    ds_read_b64_tr_b16 a[20:21], v2 offset:20672
    v_mfma_f32_16x16x32_bf16 v[72:75], a[24:27], a[172:175], v[72:75]
    v_mfma_f32_16x16x32_bf16 v[84:87], a[28:31], a[172:175], v[84:87]
    ds_read_b64_tr_b16 a[22:23], v2 offset:25792
    s_waitcnt lgkmcnt(8)
    v_mfma_f32_16x16x32_bf16 v[88:91], a[0:3], a[80:83], v[88:91]
    ds_read_b64_tr_b16 a[24:25], v1 offset:30912
    v_mfma_f32_16x16x32_bf16 v[100:103], a[4:7], a[80:83], v[100:103]
    v_mfma_f32_16x16x32_bf16 v[104:107], a[4:7], a[84:87], v[104:107]
    ds_read_b64_tr_b16 a[26:27], v1 offset:36032
    v_mfma_f32_16x16x32_bf16 v[92:95], a[0:3], a[84:87], v[92:95]
    ds_read_b64_tr_b16 a[28:29], v2 offset:30912
    v_mfma_f32_16x16x32_bf16 v[96:99], a[0:3], a[88:91], v[96:99]
    v_cvt_pk_bf16_f32 v184, v64, v65
    v_cvt_pk_bf16_f32 v186, v76, v77
    v_mfma_f32_16x16x32_bf16 v[108:111], a[4:7], a[88:91], v[108:111]
    ds_read_b64_tr_b16 a[30:31], v2 offset:36032
    s_waitcnt lgkmcnt(8)
    v_mfma_f32_16x16x32_bf16 v[88:91], a[8:11], a[92:95], v[88:91]
    ds_read_b64_tr_b16 a[0:1], v3 offset:192
    v_cvt_pk_bf16_f32 v185, v66, v67
    v_mfma_f32_16x16x32_bf16 v[100:103], a[12:15], a[92:95], v[100:103]
    v_cvt_pk_bf16_f32 v187, v78, v79
    v_permlane16_swap_b32 v184, v186
    v_mfma_f32_16x16x32_bf16 v[104:107], a[12:15], a[96:99], v[104:107]
    ds_read_b64_tr_b16 a[2:3], v3 offset:5312
    v_permlane16_swap_b32 v185, v187
    s_cmp_eq_u32 s80, 6
    s_cselect_b32 s75, 0x40000000, s39
    buffer_store_dwordx4 v[184:187], v7, s[24:27], s75 offen offset:0 sc1
    v_mfma_f32_16x16x32_bf16 v[92:95], a[8:11], a[96:99], v[92:95]
    ds_read_b64_tr_b16 a[4:5], v4 offset:192
    v_cvt_pk_bf16_f32 v188, v68, v69
    v_mfma_f32_16x16x32_bf16 v[96:99], a[8:11], a[100:103], v[96:99]
    v_cvt_pk_bf16_f32 v190, v80, v81
    v_cvt_pk_bf16_f32 v189, v70, v71
    v_mfma_f32_16x16x32_bf16 v[108:111], a[12:15], a[100:103], v[108:111]
    ds_read_b64_tr_b16 a[6:7], v4 offset:5312
    s_waitcnt lgkmcnt(8)
    v_mfma_f32_16x16x32_bf16 v[88:91], a[16:19], a[104:107], v[88:91]
    ds_read_b64_tr_b16 a[8:9], v3 offset:10432
    v_cvt_pk_bf16_f32 v191, v82, v83
    v_mfma_f32_16x16x32_bf16 v[100:103], a[20:23], a[104:107], v[100:103]
    v_permlane16_swap_b32 v188, v190
    v_permlane16_swap_b32 v189, v191
    v_mfma_f32_16x16x32_bf16 v[104:107], a[20:23], a[108:111], v[104:107]
    ds_read_b64_tr_b16 a[10:11], v3 offset:15552
    s_cmp_eq_u32 s80, 7
    s_cselect_b32 s75, 0x40000000, s39
    buffer_store_dwordx4 v[188:191], v7, s[24:27], s75 offen offset:1024 sc1
    v_mfma_f32_16x16x32_bf16 v[92:95], a[16:19], a[108:111], v[92:95]
    ds_read_b64_tr_b16 a[12:13], v4 offset:10432
    v_cvt_pk_bf16_f32 v192, v72, v73
    v_mfma_f32_16x16x32_bf16 v[96:99], a[16:19], a[112:115], v[96:99]
    v_cvt_pk_bf16_f32 v194, v84, v85
    v_cvt_pk_bf16_f32 v193, v74, v75
    v_cvt_pk_bf16_f32 v195, v86, v87
    v_mfma_f32_16x16x32_bf16 v[108:111], a[20:23], a[112:115], v[108:111]
    ds_read_b64_tr_b16 a[14:15], v4 offset:15552
    s_waitcnt lgkmcnt(8)
    v_mfma_f32_16x16x32_bf16 v[88:91], a[24:27], a[116:119], v[88:91]
    ds_read_b64_tr_b16 a[16:17], v3 offset:20672
    v_permlane16_swap_b32 v192, v194
    v_mfma_f32_16x16x32_bf16 v[100:103], a[28:31], a[116:119], v[100:103]
    v_permlane16_swap_b32 v193, v195
    s_cmp_eq_u32 s80, 0
    s_cselect_b32 s75, 0x40000000, s39
    buffer_store_dwordx4 v[192:195], v7, s[24:27], s75 offen offset:2048 sc1
    v_mfma_f32_16x16x32_bf16 v[104:107], a[28:31], a[120:123], v[104:107]
    ds_read_b64_tr_b16 a[18:19], v3 offset:25792
    s_add_u32 s39, s39, 3072
    v_mfma_f32_16x16x32_bf16 v[92:95], a[24:27], a[120:123], v[92:95]
    ds_read_b64_tr_b16 a[20:21], v4 offset:20672
    v_mfma_f32_16x16x32_bf16 v[96:99], a[24:27], a[124:127], v[96:99]
    v_mfma_f32_16x16x32_bf16 v[108:111], a[28:31], a[124:127], v[108:111]
    ds_read_b64_tr_b16 a[22:23], v4 offset:25792
    s_waitcnt lgkmcnt(8)
    v_mfma_f32_16x16x32_bf16 v[88:91], a[0:3], a[128:131], v[88:91]
    ds_read_b64_tr_b16 a[24:25], v3 offset:30912
    v_mfma_f32_16x16x32_bf16 v[100:103], a[4:7], a[128:131], v[100:103]
    v_mfma_f32_16x16x32_bf16 v[104:107], a[4:7], a[132:135], v[104:107]
    ds_read_b64_tr_b16 a[26:27], v3 offset:36032
    v_mfma_f32_16x16x32_bf16 v[92:95], a[0:3], a[132:135], v[92:95]
    ds_read_b64_tr_b16 a[28:29], v4 offset:30912
    v_mfma_f32_16x16x32_bf16 v[96:99], a[0:3], a[136:139], v[96:99]
    v_mfma_f32_16x16x32_bf16 v[108:111], a[4:7], a[136:139], v[108:111]
    ds_read_b64_tr_b16 a[30:31], v4 offset:36032
    s_waitcnt lgkmcnt(8)
    v_mfma_f32_16x16x32_bf16 v[88:91], a[8:11], a[140:143], v[88:91]
    ds_read_b64_tr_b16 a[0:1], v1 offset:256
    v_mfma_f32_16x16x32_bf16 v[100:103], a[12:15], a[140:143], v[100:103]
    v_mfma_f32_16x16x32_bf16 v[104:107], a[12:15], a[144:147], v[104:107]
    ds_read_b64_tr_b16 a[2:3], v1 offset:5376
    v_mfma_f32_16x16x32_bf16 v[92:95], a[8:11], a[144:147], v[92:95]
    ds_read_b64_tr_b16 a[4:5], v2 offset:256
    v_mfma_f32_16x16x32_bf16 v[96:99], a[8:11], a[148:151], v[96:99]
    v_mfma_f32_16x16x32_bf16 v[108:111], a[12:15], a[148:151], v[108:111]
    ds_read_b64_tr_b16 a[6:7], v2 offset:5376
    s_waitcnt lgkmcnt(8)
    v_mfma_f32_16x16x32_bf16 v[88:91], a[16:19], a[152:155], v[88:91]
    ds_read_b64_tr_b16 a[8:9], v1 offset:10496
    v_mfma_f32_16x16x32_bf16 v[100:103], a[20:23], a[152:155], v[100:103]
    v_mfma_f32_16x16x32_bf16 v[104:107], a[20:23], a[156:159], v[104:107]
    ds_read_b64_tr_b16 a[10:11], v1 offset:15616
    v_mfma_f32_16x16x32_bf16 v[92:95], a[16:19], a[156:159], v[92:95]
    ds_read_b64_tr_b16 a[12:13], v2 offset:10496
    v_mfma_f32_16x16x32_bf16 v[96:99], a[16:19], a[160:163], v[96:99]
    v_mfma_f32_16x16x32_bf16 v[108:111], a[20:23], a[160:163], v[108:111]
    ds_read_b64_tr_b16 a[14:15], v2 offset:15616
    s_waitcnt lgkmcnt(8)
    v_mfma_f32_16x16x32_bf16 v[88:91], a[24:27], a[164:167], v[88:91]
    ds_read_b64_tr_b16 a[16:17], v1 offset:20736
    v_mfma_f32_16x16x32_bf16 v[100:103], a[28:31], a[164:167], v[100:103]
    v_mfma_f32_16x16x32_bf16 v[104:107], a[28:31], a[168:171], v[104:107]
    ds_read_b64_tr_b16 a[18:19], v1 offset:25856
    v_mfma_f32_16x16x32_bf16 v[92:95], a[24:27], a[168:171], v[92:95]
    ds_read_b64_tr_b16 a[20:21], v2 offset:20736
    v_mfma_f32_16x16x32_bf16 v[96:99], a[24:27], a[172:175], v[96:99]
    v_mfma_f32_16x16x32_bf16 v[108:111], a[28:31], a[172:175], v[108:111]
    ds_read_b64_tr_b16 a[22:23], v2 offset:25856
    s_waitcnt lgkmcnt(8)
    v_mfma_f32_16x16x32_bf16 v[112:115], a[0:3], a[80:83], v[112:115]
    ds_read_b64_tr_b16 a[24:25], v1 offset:30976
    v_mfma_f32_16x16x32_bf16 v[124:127], a[4:7], a[80:83], v[124:127]
    v_mfma_f32_16x16x32_bf16 v[128:131], a[4:7], a[84:87], v[128:131]
    ds_read_b64_tr_b16 a[26:27], v1 offset:36096
    v_mfma_f32_16x16x32_bf16 v[116:119], a[0:3], a[84:87], v[116:119]
    ds_read_b64_tr_b16 a[28:29], v2 offset:30976
    v_mfma_f32_16x16x32_bf16 v[120:123], a[0:3], a[88:91], v[120:123]
    v_cvt_pk_bf16_f32 v196, v88, v89
    v_mfma_f32_16x16x32_bf16 v[132:135], a[4:7], a[88:91], v[132:135]
    ds_read_b64_tr_b16 a[30:31], v2 offset:36096
    s_waitcnt lgkmcnt(8)
    v_mfma_f32_16x16x32_bf16 v[112:115], a[8:11], a[92:95], v[112:115]
    ds_read_b64_tr_b16 a[0:1], v3 offset:256
    v_mfma_f32_16x16x32_bf16 v[124:127], a[12:15], a[92:95], v[124:127]
    v_cvt_pk_bf16_f32 v198, v100, v101
    v_mfma_f32_16x16x32_bf16 v[128:131], a[12:15], a[96:99], v[128:131]
    ds_read_b64_tr_b16 a[2:3], v3 offset:5376
    v_mfma_f32_16x16x32_bf16 v[116:119], a[8:11], a[96:99], v[116:119]
    ds_read_b64_tr_b16 a[4:5], v4 offset:256
    v_cvt_pk_bf16_f32 v197, v90, v91
    v_mfma_f32_16x16x32_bf16 v[120:123], a[8:11], a[100:103], v[120:123]
    v_cvt_pk_bf16_f32 v199, v102, v103
    v_mfma_f32_16x16x32_bf16 v[132:135], a[12:15], a[100:103], v[132:135]
    ds_read_b64_tr_b16 a[6:7], v4 offset:5376
    s_waitcnt lgkmcnt(8)
    v_mfma_f32_16x16x32_bf16 v[112:115], a[16:19], a[104:107], v[112:115]
    ds_read_b64_tr_b16 a[8:9], v3 offset:10496
    v_mfma_f32_16x16x32_bf16 v[124:127], a[20:23], a[104:107], v[124:127]
    v_permlane16_swap_b32 v196, v198
    v_mfma_f32_16x16x32_bf16 v[128:131], a[20:23], a[108:111], v[128:131]
    ds_read_b64_tr_b16 a[10:11], v3 offset:15616
    v_mfma_f32_16x16x32_bf16 v[116:119], a[16:19], a[108:111], v[116:119]
    ds_read_b64_tr_b16 a[12:13], v4 offset:10496
    v_permlane16_swap_b32 v197, v199
    v_mfma_f32_16x16x32_bf16 v[120:123], a[16:19], a[112:115], v[120:123]
    s_cmp_eq_u32 s80, 1
    s_cselect_b32 s75, 0x40000000, s39
    buffer_store_dwordx4 v[196:199], v7, s[24:27], s75 offen offset:0 sc1
    v_mfma_f32_16x16x32_bf16 v[132:135], a[20:23], a[112:115], v[132:135]
    ds_read_b64_tr_b16 a[14:15], v4 offset:15616
    s_waitcnt lgkmcnt(8)
    v_mfma_f32_16x16x32_bf16 v[112:115], a[24:27], a[116:119], v[112:115]
    ds_read_b64_tr_b16 a[16:17], v3 offset:20736
    s_waitcnt vmcnt(1)
    s_barrier
    s_cmp_lg_u32 s3, 0
    s_cbranch_scc1 L_nf_C
    buffer_store_dword v253, off, s[24:27], s54 offset:0 sc1
L_nf_C:
    v_mfma_f32_16x16x32_bf16 v[124:127], a[28:31], a[116:119], v[124:127]
    v_mfma_f32_16x16x32_bf16 v[128:131], a[28:31], a[120:123], v[128:131]
    ds_read_b64_tr_b16 a[18:19], v3 offset:25856
    v_cvt_pk_bf16_f32 v200, v92, v93
    v_mfma_f32_16x16x32_bf16 v[116:119], a[24:27], a[120:123], v[116:119]
    ds_read_b64_tr_b16 a[20:21], v4 offset:20736
    v_mfma_f32_16x16x32_bf16 v[120:123], a[24:27], a[124:127], v[120:123]
    v_cvt_pk_bf16_f32 v202, v104, v105
    v_mfma_f32_16x16x32_bf16 v[132:135], a[28:31], a[124:127], v[132:135]
    ds_read_b64_tr_b16 a[22:23], v4 offset:25856
    s_waitcnt lgkmcnt(8)
    v_mfma_f32_16x16x32_bf16 v[112:115], a[0:3], a[128:131], v[112:115]
    ds_read_b64_tr_b16 a[24:25], v3 offset:30976
    v_cvt_pk_bf16_f32 v201, v94, v95
    v_mfma_f32_16x16x32_bf16 v[124:127], a[4:7], a[128:131], v[124:127]
    v_mfma_f32_16x16x32_bf16 v[128:131], a[4:7], a[132:135], v[128:131]
    ds_read_b64_tr_b16 a[26:27], v3 offset:36096
    v_cvt_pk_bf16_f32 v203, v106, v107
    v_mfma_f32_16x16x32_bf16 v[116:119], a[0:3], a[132:135], v[116:119]
    ds_read_b64_tr_b16 a[28:29], v4 offset:30976
    v_mfma_f32_16x16x32_bf16 v[120:123], a[0:3], a[136:139], v[120:123]
    v_permlane16_swap_b32 v200, v202
    v_mfma_f32_16x16x32_bf16 v[132:135], a[4:7], a[136:139], v[132:135]
    ds_read_b64_tr_b16 a[30:31], v4 offset:36096
    s_waitcnt lgkmcnt(8)
    v_mfma_f32_16x16x32_bf16 v[112:115], a[8:11], a[140:143], v[112:115]
    v_permlane16_swap_b32 v201, v203
    v_mfma_f32_16x16x32_bf16 v[124:127], a[12:15], a[140:143], v[124:127]
    s_cmp_eq_u32 s80, 2
    s_cselect_b32 s75, 0x40000000, s39
    buffer_store_dwordx4 v[200:203], v7, s[24:27], s75 offen offset:1024 sc1
    v_mfma_f32_16x16x32_bf16 v[128:131], a[12:15], a[144:147], v[128:131]
    v_cvt_pk_bf16_f32 v204, v96, v97
    v_mfma_f32_16x16x32_bf16 v[116:119], a[8:11], a[144:147], v[116:119]
    v_mfma_f32_16x16x32_bf16 v[120:123], a[8:11], a[148:151], v[120:123]
    v_cvt_pk_bf16_f32 v206, v108, v109
    v_mfma_f32_16x16x32_bf16 v[132:135], a[12:15], a[148:151], v[132:135]
    v_cvt_pk_bf16_f32 v205, v98, v99
    s_waitcnt lgkmcnt(4)
    v_mfma_f32_16x16x32_bf16 v[112:115], a[16:19], a[152:155], v[112:115]
    v_mfma_f32_16x16x32_bf16 v[124:127], a[20:23], a[152:155], v[124:127]
    v_cvt_pk_bf16_f32 v207, v110, v111
    v_mfma_f32_16x16x32_bf16 v[128:131], a[20:23], a[156:159], v[128:131]
    v_permlane16_swap_b32 v204, v206
    v_mfma_f32_16x16x32_bf16 v[116:119], a[16:19], a[156:159], v[116:119]
    v_permlane16_swap_b32 v205, v207
    v_mfma_f32_16x16x32_bf16 v[120:123], a[16:19], a[160:163], v[120:123]
    s_cmp_eq_u32 s80, 3
    s_cselect_b32 s75, 0x40000000, s39
    buffer_store_dwordx4 v[204:207], v7, s[24:27], s75 offen offset:2048 sc1
    v_mfma_f32_16x16x32_bf16 v[132:135], a[20:23], a[160:163], v[132:135]
    s_waitcnt lgkmcnt(0)
    v_mfma_f32_16x16x32_bf16 v[112:115], a[24:27], a[164:167], v[112:115]
    s_add_u32 s39, s39, 3072
    v_mfma_f32_16x16x32_bf16 v[124:127], a[28:31], a[164:167], v[124:127]
    v_mfma_f32_16x16x32_bf16 v[128:131], a[28:31], a[168:171], v[128:131]
    v_mfma_f32_16x16x32_bf16 v[116:119], a[24:27], a[168:171], v[116:119]
    v_mfma_f32_16x16x32_bf16 v[120:123], a[24:27], a[172:175], v[120:123]
    v_mfma_f32_16x16x32_bf16 v[132:135], a[28:31], a[172:175], v[132:135]
    s_nop 1
    v_cvt_pk_bf16_f32 v208, v112, v113
    s_nop 0
    v_cvt_pk_bf16_f32 v210, v124, v125
    v_cvt_pk_bf16_f32 v209, v114, v115
    v_cvt_pk_bf16_f32 v211, v126, v127
    v_permlane16_swap_b32 v208, v210
    s_nop 0
    v_permlane16_swap_b32 v209, v211
    s_cmp_eq_u32 s80, 4
    s_cselect_b32 s75, 0x40000000, s39
    buffer_store_dwordx4 v[208:211], v7, s[24:27], s75 offen offset:0 sc1
    v_cvt_pk_bf16_f32 v212, v116, v117
    v_cvt_pk_bf16_f32 v214, v128, v129
    v_cvt_pk_bf16_f32 v213, v118, v119
    v_cvt_pk_bf16_f32 v215, v130, v131
    v_permlane16_swap_b32 v212, v214
    s_nop 0
    v_permlane16_swap_b32 v213, v215
    s_cmp_eq_u32 s80, 5
    s_cselect_b32 s75, 0x40000000, s39
    buffer_store_dwordx4 v[212:215], v7, s[24:27], s75 offen offset:1024 sc1
    v_cvt_pk_bf16_f32 v216, v120, v121
    v_cvt_pk_bf16_f32 v218, v132, v133
    v_cvt_pk_bf16_f32 v217, v122, v123
    v_cvt_pk_bf16_f32 v219, v134, v135
    v_permlane16_swap_b32 v216, v218
    s_nop 0
    v_permlane16_swap_b32 v217, v219
    s_cmp_eq_u32 s80, 6
    s_cselect_b32 s75, 0x40000000, s39
    buffer_store_dwordx4 v[216:219], v7, s[24:27], s75 offen offset:2048 sc1
    s_add_u32 s39, s39, 3072
    buffer_load_dword v243, v242, s[24:27], 0 offen offset:0 sc1
    s_mul_i32 s74, s80, 61440
    s_add_u32 s94, s94, s74
    s_add_u32 s95, s95, s74
    s_add_u32 s53, s68, 491520
    s_lshl_b32 s74, s80, 2
    s_set_gpr_idx_on s74, gpr_idx(SRC0)
    s_nop 1
    v_mov_b32 v224, v160
    v_mov_b32 v225, v161
    v_mov_b32 v226, v162
    v_mov_b32 v227, v163
    v_mov_b32 v228, v192
    v_mov_b32 v229, v193
    v_mov_b32 v230, v194
    v_mov_b32 v231, v195
    s_set_gpr_idx_off
    s_nop 1
    s_waitcnt vmcnt(0)
    s_barrier
    s_cmp_lg_u32 s3, 0
    s_cbranch_scc1 L_nf_D
    buffer_store_dword v253, off, s[24:27], s54 offset:64 sc1
L_nf_D:
    s_waitcnt vmcnt(63)
    v_cmp_eq_u32 vcc, s82, v243
    s_nop 0
    s_and_b32 s74, vcc_lo, 0xff
    s_cmp_eq_u32 s74, 0xff
    s_cbranch_scc1 L_got_C
    s_mov_b32 s84, 0x200000
L_wait_C:
    buffer_load_dword v243, v242, s[24:27], 0 offen offset:0 sc1
    s_waitcnt vmcnt(0)
    v_cmp_eq_u32 vcc, s82, v243
    s_nop 0
    s_and_b32 s74, vcc_lo, 0xff
    s_cmp_eq_u32 s74, 0xff
    s_cbranch_scc1 L_got_C
    s_sub_u32 s84, s84, 1
    s_cmp_lg_u32 s84, 0
    s_cbranch_scc1 L_wait_C
L_got_C:
    s_add_u32 s94, s94, 61440
    s_cmp_ge_u32 s94, s53
    s_cselect_b32 s74, 491520, 0
    s_sub_u32 s94, s94, s74
    buffer_load_dwordx4 v[20:23], v7, s[24:27], s94 offen sc1
    s_add_u32 s94, s94, 61440
    s_cmp_ge_u32 s94, s53
    s_cselect_b32 s74, 491520, 0
    s_sub_u32 s94, s94, s74
    buffer_load_dwordx4 v[24:27], v7, s[24:27], s94 offen sc1
    s_add_u32 s94, s94, 61440
    s_cmp_ge_u32 s94, s53
    s_cselect_b32 s74, 491520, 0
    s_sub_u32 s94, s94, s74
    buffer_load_dwordx4 v[28:31], v7, s[24:27], s94 offen sc1
    s_add_u32 s94, s94, 61440
    s_cmp_ge_u32 s94, s53
    s_cselect_b32 s74, 491520, 0
    s_sub_u32 s94, s94, s74
    buffer_load_dwordx4 v[32:35], v7, s[24:27], s94 offen sc1
    s_add_u32 s94, s94, 61440
    s_cmp_ge_u32 s94, s53
    s_cselect_b32 s74, 491520, 0
    s_sub_u32 s94, s94, s74
    buffer_load_dwordx4 v[36:39], v7, s[24:27], s94 offen sc1
    s_add_u32 s94, s94, 61440
    s_cmp_ge_u32 s94, s53
    s_cselect_b32 s74, 491520, 0
    s_sub_u32 s94, s94, s74
    buffer_load_dwordx4 v[40:43], v7, s[24:27], s94 offen sc1
    s_add_u32 s94, s94, 61440
    s_cmp_ge_u32 s94, s53
    s_cselect_b32 s74, 491520, 0
    s_sub_u32 s94, s94, s74
    buffer_load_dwordx4 v[44:47], v7, s[24:27], s94 offen sc1
    s_cmp_eq_u32 s80, 7
    s_cbranch_scc1 L_one
    s_and_b32 s74, vcc_lo, 0xff00
    s_cmp_eq_u32 s74, 0xff00
    s_cbranch_scc1 L_both
    buffer_load_dword v243, v242, s[24:27], 0 offen offset:0 sc1
    s_waitcnt vmcnt(0)
    v_cmp_eq_u32 vcc, s82, v243
    s_nop 0
    s_and_b32 s74, vcc_lo, 0xff00
    s_cmp_eq_u32 s74, 0xff00
    s_cbranch_scc1 L_got_D
    s_mov_b32 s84, 0x200000
L_wait_D:
    buffer_load_dword v243, v242, s[24:27], 0 offen offset:0 sc1
    s_waitcnt vmcnt(0)
    v_cmp_eq_u32 vcc, s82, v243
    s_nop 0
    s_and_b32 s74, vcc_lo, 0xff00
    s_cmp_eq_u32 s74, 0xff00
    s_cbranch_scc1 L_got_D
    s_sub_u32 s84, s84, 1
    s_cmp_lg_u32 s84, 0
    s_cbranch_scc1 L_wait_D
L_got_D:
L_both:
    s_add_u32 s95, s95, 61440
    s_cmp_ge_u32 s95, s53
    s_cselect_b32 s74, 491520, 0
    s_sub_u32 s95, s95, s74
    buffer_load_dwordx4 v[52:55], v7, s[24:27], s95 offen sc1
    s_add_u32 s95, s95, 61440
    s_cmp_ge_u32 s95, s53
    s_cselect_b32 s74, 491520, 0
    s_sub_u32 s95, s95, s74
    buffer_load_dwordx4 v[56:59], v7, s[24:27], s95 offen sc1
    s_add_u32 s95, s95, 61440
    s_cmp_ge_u32 s95, s53
    s_cselect_b32 s74, 491520, 0
    s_sub_u32 s95, s95, s74
    buffer_load_dwordx4 v[60:63], v7, s[24:27], s95 offen sc1
    s_add_u32 s95, s95, 61440
    s_cmp_ge_u32 s95, s53
    s_cselect_b32 s74, 491520, 0
    s_sub_u32 s95, s95, s74
    buffer_load_dwordx4 v[64:67], v7, s[24:27], s95 offen sc1
    s_add_u32 s95, s95, 61440
    s_cmp_ge_u32 s95, s53
    s_cselect_b32 s74, 491520, 0
    s_sub_u32 s95, s95, s74
    buffer_load_dwordx4 v[68:71], v7, s[24:27], s95 offen sc1
    s_add_u32 s95, s95, 61440
    s_cmp_ge_u32 s95, s53
    s_cselect_b32 s74, 491520, 0
    s_sub_u32 s95, s95, s74
    buffer_load_dwordx4 v[72:75], v7, s[24:27], s95 offen sc1
    s_add_u32 s95, s95, 61440
    s_cmp_ge_u32 s95, s53
    s_cselect_b32 s74, 491520, 0
    s_sub_u32 s95, s95, s74
    buffer_load_dwordx4 v[76:79], v7, s[24:27], s95 offen sc1
    v_lshlrev_b32 v80, 16, v224
    v_and_b32 v81, s73, v224
    v_lshlrev_b32 v82, 16, v225
    v_and_b32 v83, s73, v225
    v_lshlrev_b32 v84, 16, v226
    v_and_b32 v85, s73, v226
    v_lshlrev_b32 v86, 16, v227
    v_and_b32 v87, s73, v227
    s_waitcnt vmcnt(13)
    v_lshlrev_b32 v10, 16, v20
    v_and_b32 v11, s73, v20
    v_pk_add_f32 v[80:81], v[80:81], v[10:11]
    v_lshlrev_b32 v12, 16, v21
    v_and_b32 v13, s73, v21
    v_pk_add_f32 v[82:83], v[82:83], v[12:13]
    v_lshlrev_b32 v10, 16, v22
    v_and_b32 v11, s73, v22
    v_pk_add_f32 v[84:85], v[84:85], v[10:11]
    v_lshlrev_b32 v12, 16, v23
    v_and_b32 v13, s73, v23
    v_pk_add_f32 v[86:87], v[86:87], v[12:13]
    s_waitcnt vmcnt(12)
    v_lshlrev_b32 v10, 16, v24
    v_and_b32 v11, s73, v24
    v_pk_add_f32 v[80:81], v[80:81], v[10:11]
    v_lshlrev_b32 v12, 16, v25
    v_and_b32 v13, s73, v25
    v_pk_add_f32 v[82:83], v[82:83], v[12:13]
    v_lshlrev_b32 v10, 16, v26
    v_and_b32 v11, s73, v26
    v_pk_add_f32 v[84:85], v[84:85], v[10:11]
    v_lshlrev_b32 v12, 16, v27
    v_and_b32 v13, s73, v27
    v_pk_add_f32 v[86:87], v[86:87], v[12:13]
    s_waitcnt vmcnt(11)
    v_lshlrev_b32 v10, 16, v28
    v_and_b32 v11, s73, v28
    v_pk_add_f32 v[80:81], v[80:81], v[10:11]
    v_lshlrev_b32 v12, 16, v29
    v_and_b32 v13, s73, v29
    v_pk_add_f32 v[82:83], v[82:83], v[12:13]
    v_lshlrev_b32 v10, 16, v30
    v_and_b32 v11, s73, v30
    v_pk_add_f32 v[84:85], v[84:85], v[10:11]
    v_lshlrev_b32 v12, 16, v31
    v_and_b32 v13, s73, v31
    v_pk_add_f32 v[86:87], v[86:87], v[12:13]
    s_waitcnt vmcnt(10)
    v_lshlrev_b32 v10, 16, v32
    v_and_b32 v11, s73, v32
    v_pk_add_f32 v[80:81], v[80:81], v[10:11]
    v_lshlrev_b32 v12, 16, v33
    v_and_b32 v13, s73, v33
    v_pk_add_f32 v[82:83], v[82:83], v[12:13]
    v_lshlrev_b32 v10, 16, v34
    v_and_b32 v11, s73, v34
    v_pk_add_f32 v[84:85], v[84:85], v[10:11]
    v_lshlrev_b32 v12, 16, v35
    v_and_b32 v13, s73, v35
    v_pk_add_f32 v[86:87], v[86:87], v[12:13]
    s_waitcnt vmcnt(9)
    v_lshlrev_b32 v10, 16, v36
    v_and_b32 v11, s73, v36
    v_pk_add_f32 v[80:81], v[80:81], v[10:11]
    v_lshlrev_b32 v12, 16, v37
    v_and_b32 v13, s73, v37
    v_pk_add_f32 v[82:83], v[82:83], v[12:13]
    v_lshlrev_b32 v10, 16, v38
    v_and_b32 v11, s73, v38
    v_pk_add_f32 v[84:85], v[84:85], v[10:11]
    v_lshlrev_b32 v12, 16, v39
    v_and_b32 v13, s73, v39
    v_pk_add_f32 v[86:87], v[86:87], v[12:13]
    s_waitcnt vmcnt(8)
    v_lshlrev_b32 v10, 16, v40
    v_and_b32 v11, s73, v40
    v_pk_add_f32 v[80:81], v[80:81], v[10:11]
    v_lshlrev_b32 v12, 16, v41
    v_and_b32 v13, s73, v41
    v_pk_add_f32 v[82:83], v[82:83], v[12:13]
    v_lshlrev_b32 v10, 16, v42
    v_and_b32 v11, s73, v42
    v_pk_add_f32 v[84:85], v[84:85], v[10:11]
    v_lshlrev_b32 v12, 16, v43
    v_and_b32 v13, s73, v43
    v_pk_add_f32 v[86:87], v[86:87], v[12:13]
    s_waitcnt vmcnt(7)
    v_lshlrev_b32 v10, 16, v44
    v_and_b32 v11, s73, v44
    v_pk_add_f32 v[80:81], v[80:81], v[10:11]
    v_lshlrev_b32 v12, 16, v45
    v_and_b32 v13, s73, v45
    v_pk_add_f32 v[82:83], v[82:83], v[12:13]
    v_lshlrev_b32 v10, 16, v46
    v_and_b32 v11, s73, v46
    v_pk_add_f32 v[84:85], v[84:85], v[10:11]
    v_lshlrev_b32 v12, 16, v47
    v_and_b32 v13, s73, v47
    v_pk_add_f32 v[86:87], v[86:87], v[12:13]
    v_cvt_pk_bf16_f32 v16, v80, v81
    v_cvt_pk_bf16_f32 v17, v82, v83
    v_cvt_pk_bf16_f32 v18, v84, v85
    v_cvt_pk_bf16_f32 v19, v86, v87
    buffer_store_dwordx4 v[16:19], v5, s[64:67], s69 offen
    v_lshlrev_b32 v80, 16, v228
    v_and_b32 v81, s73, v228
    v_lshlrev_b32 v82, 16, v229
    v_and_b32 v83, s73, v229
    v_lshlrev_b32 v84, 16, v230
    v_and_b32 v85, s73, v230
    v_lshlrev_b32 v86, 16, v231
    v_and_b32 v87, s73, v231
    s_waitcnt vmcnt(7)
    v_lshlrev_b32 v10, 16, v52
    v_and_b32 v11, s73, v52
    v_pk_add_f32 v[80:81], v[80:81], v[10:11]
    v_lshlrev_b32 v12, 16, v53
    v_and_b32 v13, s73, v53
    v_pk_add_f32 v[82:83], v[82:83], v[12:13]
    v_lshlrev_b32 v10, 16, v54
    v_and_b32 v11, s73, v54
    v_pk_add_f32 v[84:85], v[84:85], v[10:11]
    v_lshlrev_b32 v12, 16, v55
    v_and_b32 v13, s73, v55
    v_pk_add_f32 v[86:87], v[86:87], v[12:13]
    s_waitcnt vmcnt(6)
    v_lshlrev_b32 v10, 16, v56
    v_and_b32 v11, s73, v56
    v_pk_add_f32 v[80:81], v[80:81], v[10:11]
    v_lshlrev_b32 v12, 16, v57
    v_and_b32 v13, s73, v57
    v_pk_add_f32 v[82:83], v[82:83], v[12:13]
    v_lshlrev_b32 v10, 16, v58
    v_and_b32 v11, s73, v58
    v_pk_add_f32 v[84:85], v[84:85], v[10:11]
    v_lshlrev_b32 v12, 16, v59
    v_and_b32 v13, s73, v59
    v_pk_add_f32 v[86:87], v[86:87], v[12:13]
    s_waitcnt vmcnt(5)
    v_lshlrev_b32 v10, 16, v60
    v_and_b32 v11, s73, v60
    v_pk_add_f32 v[80:81], v[80:81], v[10:11]
    v_lshlrev_b32 v12, 16, v61
    v_and_b32 v13, s73, v61
    v_pk_add_f32 v[82:83], v[82:83], v[12:13]
    v_lshlrev_b32 v10, 16, v62
    v_and_b32 v11, s73, v62
    v_pk_add_f32 v[84:85], v[84:85], v[10:11]
    v_lshlrev_b32 v12, 16, v63
    v_and_b32 v13, s73, v63
    v_pk_add_f32 v[86:87], v[86:87], v[12:13]
    s_waitcnt vmcnt(4)
    v_lshlrev_b32 v10, 16, v64
    v_and_b32 v11, s73, v64
    v_pk_add_f32 v[80:81], v[80:81], v[10:11]
    v_lshlrev_b32 v12, 16, v65
    v_and_b32 v13, s73, v65
    v_pk_add_f32 v[82:83], v[82:83], v[12:13]
    v_lshlrev_b32 v10, 16, v66
    v_and_b32 v11, s73, v66
    v_pk_add_f32 v[84:85], v[84:85], v[10:11]
    v_lshlrev_b32 v12, 16, v67
    v_and_b32 v13, s73, v67
    v_pk_add_f32 v[86:87], v[86:87], v[12:13]
    s_waitcnt vmcnt(3)
    v_lshlrev_b32 v10, 16, v68
    v_and_b32 v11, s73, v68
    v_pk_add_f32 v[80:81], v[80:81], v[10:11]
    v_lshlrev_b32 v12, 16, v69
    v_and_b32 v13, s73, v69
    v_pk_add_f32 v[82:83], v[82:83], v[12:13]
    v_lshlrev_b32 v10, 16, v70
    v_and_b32 v11, s73, v70
    v_pk_add_f32 v[84:85], v[84:85], v[10:11]
    v_lshlrev_b32 v12, 16, v71
    v_and_b32 v13, s73, v71
    v_pk_add_f32 v[86:87], v[86:87], v[12:13]
    s_waitcnt vmcnt(2)
    v_lshlrev_b32 v10, 16, v72
    v_and_b32 v11, s73, v72
    v_pk_add_f32 v[80:81], v[80:81], v[10:11]
    v_lshlrev_b32 v12, 16, v73
    v_and_b32 v13, s73, v73
    v_pk_add_f32 v[82:83], v[82:83], v[12:13]
    v_lshlrev_b32 v10, 16, v74
    v_and_b32 v11, s73, v74
    v_pk_add_f32 v[84:85], v[84:85], v[10:11]
    v_lshlrev_b32 v12, 16, v75
    v_and_b32 v13, s73, v75
    v_pk_add_f32 v[86:87], v[86:87], v[12:13]
    s_waitcnt vmcnt(1)
    v_lshlrev_b32 v10, 16, v76
    v_and_b32 v11, s73, v76
    v_pk_add_f32 v[80:81], v[80:81], v[10:11]
    v_lshlrev_b32 v12, 16, v77
    v_and_b32 v13, s73, v77
    v_pk_add_f32 v[82:83], v[82:83], v[12:13]
    v_lshlrev_b32 v10, 16, v78
    v_and_b32 v11, s73, v78
    v_pk_add_f32 v[84:85], v[84:85], v[10:11]
    v_lshlrev_b32 v12, 16, v79
    v_and_b32 v13, s73, v79
    v_pk_add_f32 v[86:87], v[86:87], v[12:13]
    v_cvt_pk_bf16_f32 v48, v80, v81
    v_cvt_pk_bf16_f32 v49, v82, v83
    v_cvt_pk_bf16_f32 v50, v84, v85
    v_cvt_pk_bf16_f32 v51, v86, v87
    buffer_store_dwordx4 v[48:51], v5, s[64:67], s70 offen
    s_branch L_red_done
L_one:
    v_lshlrev_b32 v80, 16, v224
    v_and_b32 v81, s73, v224
    v_lshlrev_b32 v82, 16, v225
    v_and_b32 v83, s73, v225
    v_lshlrev_b32 v84, 16, v226
    v_and_b32 v85, s73, v226
    v_lshlrev_b32 v86, 16, v227
    v_and_b32 v87, s73, v227
    s_waitcnt vmcnt(6)
    v_lshlrev_b32 v10, 16, v20
    v_and_b32 v11, s73, v20
    v_pk_add_f32 v[80:81], v[80:81], v[10:11]
    v_lshlrev_b32 v12, 16, v21
    v_and_b32 v13, s73, v21
    v_pk_add_f32 v[82:83], v[82:83], v[12:13]
    v_lshlrev_b32 v10, 16, v22
    v_and_b32 v11, s73, v22
    v_pk_add_f32 v[84:85], v[84:85], v[10:11]
    v_lshlrev_b32 v12, 16, v23
    v_and_b32 v13, s73, v23
    v_pk_add_f32 v[86:87], v[86:87], v[12:13]
    s_waitcnt vmcnt(5)
    v_lshlrev_b32 v10, 16, v24
    v_and_b32 v11, s73, v24
    v_pk_add_f32 v[80:81], v[80:81], v[10:11]
    v_lshlrev_b32 v12, 16, v25
    v_and_b32 v13, s73, v25
    v_pk_add_f32 v[82:83], v[82:83], v[12:13]
    v_lshlrev_b32 v10, 16, v26
    v_and_b32 v11, s73, v26
    v_pk_add_f32 v[84:85], v[84:85], v[10:11]
    v_lshlrev_b32 v12, 16, v27
    v_and_b32 v13, s73, v27
    v_pk_add_f32 v[86:87], v[86:87], v[12:13]
    s_waitcnt vmcnt(4)
    v_lshlrev_b32 v10, 16, v28
    v_and_b32 v11, s73, v28
    v_pk_add_f32 v[80:81], v[80:81], v[10:11]
    v_lshlrev_b32 v12, 16, v29
    v_and_b32 v13, s73, v29
    v_pk_add_f32 v[82:83], v[82:83], v[12:13]
    v_lshlrev_b32 v10, 16, v30
    v_and_b32 v11, s73, v30
    v_pk_add_f32 v[84:85], v[84:85], v[10:11]
    v_lshlrev_b32 v12, 16, v31
    v_and_b32 v13, s73, v31
    v_pk_add_f32 v[86:87], v[86:87], v[12:13]
    s_waitcnt vmcnt(3)
    v_lshlrev_b32 v10, 16, v32
    v_and_b32 v11, s73, v32
    v_pk_add_f32 v[80:81], v[80:81], v[10:11]
    v_lshlrev_b32 v12, 16, v33
    v_and_b32 v13, s73, v33
    v_pk_add_f32 v[82:83], v[82:83], v[12:13]
    v_lshlrev_b32 v10, 16, v34
    v_and_b32 v11, s73, v34
    v_pk_add_f32 v[84:85], v[84:85], v[10:11]
    v_lshlrev_b32 v12, 16, v35
    v_and_b32 v13, s73, v35
    v_pk_add_f32 v[86:87], v[86:87], v[12:13]
    s_waitcnt vmcnt(2)
    v_lshlrev_b32 v10, 16, v36
    v_and_b32 v11, s73, v36
    v_pk_add_f32 v[80:81], v[80:81], v[10:11]
    v_lshlrev_b32 v12, 16, v37
    v_and_b32 v13, s73, v37
    v_pk_add_f32 v[82:83], v[82:83], v[12:13]
    v_lshlrev_b32 v10, 16, v38
    v_and_b32 v11, s73, v38
    v_pk_add_f32 v[84:85], v[84:85], v[10:11]
    v_lshlrev_b32 v12, 16, v39
    v_and_b32 v13, s73, v39
    v_pk_add_f32 v[86:87], v[86:87], v[12:13]
    s_waitcnt vmcnt(1)
    v_lshlrev_b32 v10, 16, v40
    v_and_b32 v11, s73, v40
    v_pk_add_f32 v[80:81], v[80:81], v[10:11]
    v_lshlrev_b32 v12, 16, v41
    v_and_b32 v13, s73, v41
    v_pk_add_f32 v[82:83], v[82:83], v[12:13]
    v_lshlrev_b32 v10, 16, v42
    v_and_b32 v11, s73, v42
    v_pk_add_f32 v[84:85], v[84:85], v[10:11]
    v_lshlrev_b32 v12, 16, v43
    v_and_b32 v13, s73, v43
    v_pk_add_f32 v[86:87], v[86:87], v[12:13]
    s_waitcnt vmcnt(0)
    v_lshlrev_b32 v10, 16, v44
    v_and_b32 v11, s73, v44
    v_pk_add_f32 v[80:81], v[80:81], v[10:11]
    v_lshlrev_b32 v12, 16, v45
    v_and_b32 v13, s73, v45
    v_pk_add_f32 v[82:83], v[82:83], v[12:13]
    v_lshlrev_b32 v10, 16, v46
    v_and_b32 v11, s73, v46
    v_pk_add_f32 v[84:85], v[84:85], v[10:11]
    v_lshlrev_b32 v12, 16, v47
    v_and_b32 v13, s73, v47
    v_pk_add_f32 v[86:87], v[86:87], v[12:13]
    v_cvt_pk_bf16_f32 v16, v80, v81
    v_cvt_pk_bf16_f32 v17, v82, v83
    v_cvt_pk_bf16_f32 v18, v84, v85
    v_cvt_pk_bf16_f32 v19, v86, v87
    buffer_store_dwordx4 v[16:19], v5, s[64:67], s69 offen
L_red_done:
    s_endpgm
L_slow_A:
    s_mov_b32 s84, 0x200000
L_spin_A:
    buffer_load_dword v243, v242, s[24:27], 0 offen offset:0 sc1
    s_waitcnt vmcnt(0)
    v_cmp_eq_u32 vcc, s82, v243
    s_nop 0
    s_cmp_eq_u64 vcc, exec
    s_cbranch_scc1 L_spun_A
    s_sub_u32 s84, s84, 1
    s_cmp_lg_u32 s84, 0
    s_cbranch_scc1 L_spin_A
L_spun_A:
    s_branch L_ok_A
L_slow_B:
    s_mov_b32 s84, 0x200000
L_spin_B:
    buffer_load_dword v243, v242, s[24:27], 0 offen offset:64 sc1
    s_waitcnt vmcnt(0)
    v_cmp_eq_u32 vcc, s82, v243
    s_nop 0
    s_cmp_eq_u64 vcc, exec
    s_cbranch_scc1 L_spun_B
    s_sub_u32 s84, s84, 1
    s_cmp_lg_u32 s84, 0
    s_cbranch_scc1 L_spin_B
L_spun_B:
    s_branch L_ok_B
L_nonce_slow:
    s_mov_b32 s84, 0x200000
L_spin_nonce:
    buffer_load_dword v243, off, s[76:79], 0 sc1
    s_waitcnt vmcnt(0)
    v_readfirstlane_b32 s82, v243
    s_nop 0
    s_cmp_lg_u32 s82, 0
    s_cbranch_scc1 L_spun_nonce
    s_sub_u32 s84, s84, 1
    s_cmp_lg_u32 s84, 0
    s_cbranch_scc1 L_spin_nonce
L_spun_nonce:
    s_branch L_nonce_ok
L_safe:
    s_mov_b32 s85, 1
    s_waitcnt vmcnt(0) lgkmcnt(0)
    s_barrier
    s_cmp_lt_u32 s3, 2
    s_cselect_b32 s38, 12288, 0
    s_cmp_ge_u32 s3, 2
    s_cbranch_scc1 L_safe_nok0
    s_add_u32 m0, s30, 147456
    s_nop 0
    buffer_load_dwordx4 v244, s[12:15], 0 offen offset:0 nt lds
    buffer_load_dwordx4 v245, s[12:15], 0 offen offset:1024 nt lds
    buffer_load_dwordx4 v246, s[12:15], 0 offen offset:2048 nt lds
    buffer_load_dwordx4 v247, s[12:15], 0 offen offset:3072 nt lds
    s_add_u32 m0, s30, 151552
    s_nop 0
    buffer_load_dwordx4 v248, s[12:15], 0 offen offset:0 nt lds
    buffer_load_dwordx4 v249, s[12:15], 0 offen offset:1024 nt lds
L_safe_nok0:
    s_add_u32 s47, s30, 49152
    s_add_u32 s42, s30, 98304
    s_mov_b32 s36, s30
    s_add_u32 m0, s47, 0
    s_nop 0
    buffer_load_dwordx4 v244, s[12:15], s38 offen offset:0 nt lds
    buffer_load_dwordx4 v245, s[12:15], s38 offen offset:1024 nt lds
    buffer_load_dwordx4 v246, s[12:15], s38 offen offset:2048 nt lds
    buffer_load_dwordx4 v247, s[12:15], s38 offen offset:3072 nt lds
    s_add_u32 m0, s47, 4096
    s_nop 0
    buffer_load_dwordx4 v248, s[12:15], s38 offen offset:0 nt lds
    buffer_load_dwordx4 v249, s[12:15], s38 offen offset:1024 nt lds
    s_add_u32 s38, s38, 12288
    s_add_u32 m0, s47, 24576
    s_nop 0
    buffer_load_dwordx4 v244, s[12:15], s38 offen offset:0 nt lds
    buffer_load_dwordx4 v245, s[12:15], s38 offen offset:1024 nt lds
    buffer_load_dwordx4 v246, s[12:15], s38 offen offset:2048 nt lds
    buffer_load_dwordx4 v247, s[12:15], s38 offen offset:3072 nt lds
    s_add_u32 m0, s47, 28672
    s_nop 0
    buffer_load_dwordx4 v248, s[12:15], s38 offen offset:0 nt lds
    buffer_load_dwordx4 v249, s[12:15], s38 offen offset:1024 nt lds
    s_add_u32 s38, s38, 12288
    s_add_u32 m0, s42, 0
    s_nop 0
    buffer_load_dwordx4 v244, s[12:15], s38 offen offset:0 nt lds
    buffer_load_dwordx4 v245, s[12:15], s38 offen offset:1024 nt lds
    buffer_load_dwordx4 v246, s[12:15], s38 offen offset:2048 nt lds
    buffer_load_dwordx4 v247, s[12:15], s38 offen offset:3072 nt lds
    s_add_u32 m0, s42, 4096
    s_nop 0
    buffer_load_dwordx4 v248, s[12:15], s38 offen offset:0 nt lds
    buffer_load_dwordx4 v249, s[12:15], s38 offen offset:1024 nt lds
    s_add_u32 s38, s38, 12288
    v_and_b32 v12, 63, v0
    v_and_b32 v13, 15, v12
    v_lshrrev_b32 v14, 1, v13
    v_lshrrev_b32 v15, 4, v12
    v_xor_b32 v14, v14, v15
    v_mul_u32_u24 v13, 384, v13
    v_lshl_add_u32 v10, v14, 4, v13
    v_add_u32 v10, 147456, v10
    v_xor_b32 v11, 64, v10
    v_add_u32 v1, -98304, v10
    v_xor_b32 v2, 64, v1
    v_and_b32 v12, 63, v0
    v_lshrrev_b32 v13, 2, v12
    v_mul_u32_u24 v15, 384, v13
    v_and_b32 v14, 2, v13
    v_lshlrev_b32 v14, 1, v14
    v_bfe_u32 v13, v13, 2, 1
    v_lshl_or_b32 v14, v13, 1, v14
    v_bfe_u32 v13, v12, 1, 1
    v_xor_b32 v14, v14, v13
    v_lshl_add_u32 v15, v14, 4, v15
    v_and_b32 v13, 1, v12
    v_lshl_add_u32 v15, v13, 3, v15
    v_add_u32 v3, 61440, v15
    v_xor_b32 v4, 32, v3
    v_xor_b32 v5, 64, v3
    v_xor_b32 v6, 96, v3
    v_accvgpr_write_b32 a32, 0
    v_accvgpr_write_b32 a33, 0
    v_accvgpr_write_b32 a34, 0
    v_accvgpr_write_b32 a35, 0
    v_accvgpr_write_b32 a36, 0
    v_accvgpr_write_b32 a37, 0
    v_accvgpr_write_b32 a38, 0
    v_accvgpr_write_b32 a39, 0
    v_accvgpr_write_b32 a40, 0
    v_accvgpr_write_b32 a41, 0
    v_accvgpr_write_b32 a42, 0
    v_accvgpr_write_b32 a43, 0
    v_accvgpr_write_b32 a44, 0
    v_accvgpr_write_b32 a45, 0
    v_accvgpr_write_b32 a46, 0
    v_accvgpr_write_b32 a47, 0
    v_accvgpr_write_b32 a48, 0
    v_accvgpr_write_b32 a49, 0
    v_accvgpr_write_b32 a50, 0
    v_accvgpr_write_b32 a51, 0
    v_accvgpr_write_b32 a52, 0
    v_accvgpr_write_b32 a53, 0
    v_accvgpr_write_b32 a54, 0
    v_accvgpr_write_b32 a55, 0
    v_accvgpr_write_b32 a56, 0
    v_accvgpr_write_b32 a57, 0
    v_accvgpr_write_b32 a58, 0
    v_accvgpr_write_b32 a59, 0
    v_accvgpr_write_b32 a60, 0
    v_accvgpr_write_b32 a61, 0
    v_accvgpr_write_b32 a62, 0
    v_accvgpr_write_b32 a63, 0
    v_accvgpr_write_b32 a64, 0
    v_accvgpr_write_b32 a65, 0
    v_accvgpr_write_b32 a66, 0
    v_accvgpr_write_b32 a67, 0
    v_accvgpr_write_b32 a68, 0
    v_accvgpr_write_b32 a69, 0
    v_accvgpr_write_b32 a70, 0
    v_accvgpr_write_b32 a71, 0
    v_accvgpr_write_b32 a72, 0
    v_accvgpr_write_b32 a73, 0
    v_accvgpr_write_b32 a74, 0
    v_accvgpr_write_b32 a75, 0
    v_accvgpr_write_b32 a76, 0
    v_accvgpr_write_b32 a77, 0
    v_accvgpr_write_b32 a78, 0
    v_accvgpr_write_b32 a79, 0
    v_accvgpr_write_b32 a80, 0
    v_accvgpr_write_b32 a81, 0
    v_accvgpr_write_b32 a82, 0
    v_accvgpr_write_b32 a83, 0
    v_accvgpr_write_b32 a84, 0
    v_accvgpr_write_b32 a85, 0
    v_accvgpr_write_b32 a86, 0
    v_accvgpr_write_b32 a87, 0
    v_accvgpr_write_b32 a88, 0
    v_accvgpr_write_b32 a89, 0
    v_accvgpr_write_b32 a90, 0
    v_accvgpr_write_b32 a91, 0
    v_accvgpr_write_b32 a92, 0
    v_accvgpr_write_b32 a93, 0
    v_accvgpr_write_b32 a94, 0
    v_accvgpr_write_b32 a95, 0
    v_accvgpr_write_b32 a96, 0
    v_accvgpr_write_b32 a97, 0
    v_accvgpr_write_b32 a98, 0
    v_accvgpr_write_b32 a99, 0
    v_accvgpr_write_b32 a100, 0
    v_accvgpr_write_b32 a101, 0
    v_accvgpr_write_b32 a102, 0
    v_accvgpr_write_b32 a103, 0
    v_accvgpr_write_b32 a104, 0
    v_accvgpr_write_b32 a105, 0
    v_accvgpr_write_b32 a106, 0
    v_accvgpr_write_b32 a107, 0
    v_accvgpr_write_b32 a108, 0
    v_accvgpr_write_b32 a109, 0
    v_accvgpr_write_b32 a110, 0
    v_accvgpr_write_b32 a111, 0
    v_accvgpr_write_b32 a112, 0
    v_accvgpr_write_b32 a113, 0
    v_accvgpr_write_b32 a114, 0
    v_accvgpr_write_b32 a115, 0
    v_accvgpr_write_b32 a116, 0
    v_accvgpr_write_b32 a117, 0
    v_accvgpr_write_b32 a118, 0
    v_accvgpr_write_b32 a119, 0
    v_accvgpr_write_b32 a120, 0
    v_accvgpr_write_b32 a121, 0
    v_accvgpr_write_b32 a122, 0
    v_accvgpr_write_b32 a123, 0
    v_accvgpr_write_b32 a124, 0
    v_accvgpr_write_b32 a125, 0
    v_accvgpr_write_b32 a126, 0
    v_accvgpr_write_b32 a127, 0
    v_accvgpr_write_b32 a128, 0
    v_accvgpr_write_b32 a129, 0
    v_accvgpr_write_b32 a130, 0
    v_accvgpr_write_b32 a131, 0
    v_accvgpr_write_b32 a132, 0
    v_accvgpr_write_b32 a133, 0
    v_accvgpr_write_b32 a134, 0
    v_accvgpr_write_b32 a135, 0
    v_accvgpr_write_b32 a136, 0
    v_accvgpr_write_b32 a137, 0
    v_accvgpr_write_b32 a138, 0
    v_accvgpr_write_b32 a139, 0
    v_accvgpr_write_b32 a140, 0
    v_accvgpr_write_b32 a141, 0
    v_accvgpr_write_b32 a142, 0
    v_accvgpr_write_b32 a143, 0
    v_accvgpr_write_b32 a144, 0
    v_accvgpr_write_b32 a145, 0
    v_accvgpr_write_b32 a146, 0
    v_accvgpr_write_b32 a147, 0
    v_accvgpr_write_b32 a148, 0
    v_accvgpr_write_b32 a149, 0
    v_accvgpr_write_b32 a150, 0
    v_accvgpr_write_b32 a151, 0
    v_accvgpr_write_b32 a152, 0
    v_accvgpr_write_b32 a153, 0
    v_accvgpr_write_b32 a154, 0
    v_accvgpr_write_b32 a155, 0
    v_accvgpr_write_b32 a156, 0
    v_accvgpr_write_b32 a157, 0
    v_accvgpr_write_b32 a158, 0
    v_accvgpr_write_b32 a159, 0
    v_accvgpr_write_b32 a160, 0
    v_accvgpr_write_b32 a161, 0
    v_accvgpr_write_b32 a162, 0
    v_accvgpr_write_b32 a163, 0
    v_accvgpr_write_b32 a164, 0
    v_accvgpr_write_b32 a165, 0
    v_accvgpr_write_b32 a166, 0
    v_accvgpr_write_b32 a167, 0
    v_accvgpr_write_b32 a168, 0
    v_accvgpr_write_b32 a169, 0
    v_accvgpr_write_b32 a170, 0
    v_accvgpr_write_b32 a171, 0
    v_accvgpr_write_b32 a172, 0
    v_accvgpr_write_b32 a173, 0
    v_accvgpr_write_b32 a174, 0
    v_accvgpr_write_b32 a175, 0
    v_mov_b32 v7, 0
    v_mov_b32 v8, 0
    v_mov_b32 v9, 0
    s_waitcnt vmcnt(18)
    s_barrier
    ds_read_b128 a[0:3], v10 offset:0
    ds_read_b128 a[4:7], v10 offset:6144
    s_waitcnt lgkmcnt(1)
    v_mfma_f32_16x16x32_bf16 v[160:163], a[0:3], v[16:19], 0
    s_waitcnt lgkmcnt(0)
    v_mfma_f32_16x16x32_bf16 v[164:167], a[4:7], v[16:19], 0
    v_mfma_f32_16x16x32_bf16 v[172:175], a[4:7], v[20:23], 0
    v_mfma_f32_16x16x32_bf16 v[168:171], a[0:3], v[20:23], 0
    v_mfma_f32_16x16x32_bf16 v[176:179], a[0:3], v[24:27], 0
    v_mfma_f32_16x16x32_bf16 v[180:183], a[4:7], v[24:27], 0
    ds_read_b128 a[8:11], v11 offset:0
    ds_read_b128 a[12:15], v11 offset:6144
    s_waitcnt lgkmcnt(1)
    v_mfma_f32_16x16x32_bf16 v[160:163], a[8:11], v[40:43], v[160:163]
    s_waitcnt lgkmcnt(0)
    v_mfma_f32_16x16x32_bf16 v[164:167], a[12:15], v[40:43], v[164:167]
    v_mfma_f32_16x16x32_bf16 v[172:175], a[12:15], v[44:47], v[172:175]
    v_mfma_f32_16x16x32_bf16 v[168:171], a[8:11], v[44:47], v[168:171]
    v_mfma_f32_16x16x32_bf16 v[176:179], a[8:11], v[48:51], v[176:179]
    v_mfma_f32_16x16x32_bf16 v[180:183], a[12:15], v[48:51], v[180:183]
    ds_read_b128 a[16:19], v10 offset:128
    ds_read_b128 a[20:23], v10 offset:6272
    s_waitcnt lgkmcnt(1)
    v_mfma_f32_16x16x32_bf16 v[160:163], a[16:19], v[64:67], v[160:163]
    s_waitcnt lgkmcnt(0)
    v_mfma_f32_16x16x32_bf16 v[164:167], a[20:23], v[64:67], v[164:167]
    v_mfma_f32_16x16x32_bf16 v[172:175], a[20:23], v[68:71], v[172:175]
    v_mfma_f32_16x16x32_bf16 v[168:171], a[16:19], v[68:71], v[168:171]
    v_mfma_f32_16x16x32_bf16 v[176:179], a[16:19], v[72:75], v[176:179]
    v_mfma_f32_16x16x32_bf16 v[180:183], a[20:23], v[72:75], v[180:183]
    ds_read_b128 a[24:27], v11 offset:128
    ds_read_b128 a[28:31], v11 offset:6272
    s_waitcnt lgkmcnt(1)
    v_mfma_f32_16x16x32_bf16 v[160:163], a[24:27], v[88:91], v[160:163]
    s_waitcnt lgkmcnt(0)
    v_mfma_f32_16x16x32_bf16 v[164:167], a[28:31], v[88:91], v[164:167]
    v_mfma_f32_16x16x32_bf16 v[172:175], a[28:31], v[92:95], v[172:175]
    v_mfma_f32_16x16x32_bf16 v[168:171], a[24:27], v[92:95], v[168:171]
    v_mfma_f32_16x16x32_bf16 v[176:179], a[24:27], v[96:99], v[176:179]
    v_mfma_f32_16x16x32_bf16 v[180:183], a[28:31], v[96:99], v[180:183]
    ds_read_b128 a[0:3], v10 offset:256
    ds_read_b128 a[4:7], v10 offset:6400
    s_waitcnt lgkmcnt(1)
    v_mfma_f32_16x16x32_bf16 v[160:163], a[0:3], v[112:115], v[160:163]
    s_waitcnt lgkmcnt(0)
    v_mfma_f32_16x16x32_bf16 v[164:167], a[4:7], v[112:115], v[164:167]
    v_mfma_f32_16x16x32_bf16 v[172:175], a[4:7], v[116:119], v[172:175]
    v_mfma_f32_16x16x32_bf16 v[168:171], a[0:3], v[116:119], v[168:171]
    v_mfma_f32_16x16x32_bf16 v[176:179], a[0:3], v[120:123], v[176:179]
    v_mfma_f32_16x16x32_bf16 v[180:183], a[4:7], v[120:123], v[180:183]
    ds_read_b128 a[8:11], v11 offset:256
    ds_read_b128 a[12:15], v11 offset:6400
    s_waitcnt lgkmcnt(1)
    v_mfma_f32_16x16x32_bf16 v[160:163], a[8:11], v[136:139], v[160:163]
    s_waitcnt lgkmcnt(0)
    v_mfma_f32_16x16x32_bf16 v[164:167], a[12:15], v[136:139], v[164:167]
    v_mfma_f32_16x16x32_bf16 v[172:175], a[12:15], v[140:143], v[172:175]
    v_mfma_f32_16x16x32_bf16 v[168:171], a[8:11], v[140:143], v[168:171]
    v_mfma_f32_16x16x32_bf16 v[176:179], a[8:11], v[144:147], v[176:179]
    v_mfma_f32_16x16x32_bf16 v[180:183], a[12:15], v[144:147], v[180:183]
    s_waitcnt vmcnt(6) lgkmcnt(0)
    s_barrier
    ds_read_b128 a[0:3], v1 offset:0
    ds_read_b128 a[4:7], v1 offset:6144
    ds_read_b128 a[8:11], v2 offset:0
    ds_read_b128 a[12:15], v2 offset:6144
    ds_read_b128 a[16:19], v1 offset:128
    ds_read_b128 a[20:23], v1 offset:6272
    v_max3_f32 v10, v160, v161, v162
    v_max3_f32 v10, v10, v163, v164
    v_max3_f32 v10, v10, v165, v166
    v_max_f32 v10, v10, v167
    v_max3_f32 v11, v168, v169, v170
    v_max3_f32 v11, v11, v171, v172
    v_max3_f32 v11, v11, v173, v174
    v_max_f32 v11, v11, v175
    v_max3_f32 v12, v176, v177, v178
    v_max3_f32 v12, v12, v179, v180
    v_max3_f32 v12, v12, v181, v182
    v_max_f32 v12, v12, v183
    v_mov_b32 v13, v10
    v_mov_b32 v14, v11
    v_mov_b32 v15, v12
    v_permlane32_swap_b32 v10, v13
    v_permlane32_swap_b32 v11, v14
    v_permlane32_swap_b32 v12, v15
    v_max_f32 v10, v10, v13
    v_max_f32 v11, v11, v14
    v_max_f32 v12, v12, v15
    v_mov_b32 v13, v10
    v_mov_b32 v14, v11
    v_mov_b32 v15, v12
    v_permlane16_swap_b32 v10, v13
    v_permlane16_swap_b32 v11, v14
    v_permlane16_swap_b32 v12, v15
    v_max_f32 v10, v10, v13
    v_max_f32 v11, v11, v14
    v_max_f32 v12, v12, v15
    v_sub_f32 v28, 0, v10
    v_sub_f32 v29, 0, v10
    v_sub_f32 v30, 0, v10
    v_sub_f32 v31, 0, v10
    v_sub_f32 v160, v160, v10
    v_sub_f32 v161, v161, v10
    v_sub_f32 v162, v162, v10
    v_sub_f32 v163, v163, v10
    v_sub_f32 v164, v164, v10
    v_sub_f32 v165, v165, v10
    v_sub_f32 v166, v166, v10
    v_sub_f32 v167, v167, v10
    v_sub_f32 v32, 0, v11
    v_sub_f32 v33, 0, v11
    v_sub_f32 v34, 0, v11
    v_sub_f32 v35, 0, v11
    v_sub_f32 v168, v168, v11
    v_sub_f32 v169, v169, v11
    v_sub_f32 v170, v170, v11
    v_sub_f32 v171, v171, v11
    v_sub_f32 v172, v172, v11
    v_sub_f32 v173, v173, v11
    v_sub_f32 v174, v174, v11
    v_sub_f32 v175, v175, v11
    v_sub_f32 v36, 0, v12
    v_sub_f32 v37, 0, v12
    v_sub_f32 v38, 0, v12
    v_sub_f32 v39, 0, v12
    v_sub_f32 v176, v176, v12
    v_sub_f32 v177, v177, v12
    v_sub_f32 v178, v178, v12
    v_sub_f32 v179, v179, v12
    v_sub_f32 v180, v180, v12
    v_sub_f32 v181, v181, v12
    v_sub_f32 v182, v182, v12
    v_sub_f32 v183, v183, v12
    s_mov_b32 s41, 14
L_safe_loop:
    s_waitcnt lgkmcnt(4)
    v_mfma_f32_16x16x32_bf16 v[184:187], a[0:3], v[16:19], v[28:31]
    ds_read_b128 a[24:27], v2 offset:128
    v_mfma_f32_16x16x32_bf16 v[188:191], a[4:7], v[16:19], v[28:31]
    s_add_u32 m0, s42, 24576
    v_exp_f32 v160, v160
    v_mfma_f32_16x16x32_bf16 v[196:199], a[4:7], v[20:23], v[32:35]
    s_waitcnt vmcnt(4)
    buffer_load_dwordx4 v244, s[12:15], s38 offen offset:0 nt lds
    v_add_f32 v7, v7, v160
    v_mfma_f32_16x16x32_bf16 v[192:195], a[0:3], v[20:23], v[32:35]
    ds_read_b128 a[28:31], v2 offset:6272
    v_exp_f32 v161, v161
    v_mfma_f32_16x16x32_bf16 v[200:203], a[0:3], v[24:27], v[36:39]
    v_exp_f32 v162, v162
    v_mfma_f32_16x16x32_bf16 v[204:207], a[4:7], v[24:27], v[36:39]
    v_cvt_pk_bf16_f32 v52, v160, v161
    s_waitcnt lgkmcnt(4)
    v_mfma_f32_16x16x32_bf16 v[184:187], a[8:11], v[40:43], v[184:187]
    ds_read_b128 a[0:3], v1 offset:256
    v_exp_f32 v163, v163
    v_mfma_f32_16x16x32_bf16 v[188:191], a[12:15], v[40:43], v[188:191]
    v_exp_f32 v164, v164
    v_mfma_f32_16x16x32_bf16 v[196:199], a[12:15], v[44:47], v[196:199]
    v_exp_f32 v165, v165
    v_mfma_f32_16x16x32_bf16 v[192:195], a[8:11], v[44:47], v[192:195]
    ds_read_b128 a[4:7], v1 offset:6400
    v_exp_f32 v166, v166
    v_mfma_f32_16x16x32_bf16 v[200:203], a[8:11], v[48:51], v[200:203]
    v_exp_f32 v167, v167
    v_mfma_f32_16x16x32_bf16 v[204:207], a[12:15], v[48:51], v[204:207]
    v_exp_f32 v168, v168
    s_waitcnt lgkmcnt(4)
    v_mfma_f32_16x16x32_bf16 v[184:187], a[16:19], v[64:67], v[184:187]
    ds_read_b128 a[8:11], v2 offset:256
    v_exp_f32 v169, v169
    v_mfma_f32_16x16x32_bf16 v[188:191], a[20:23], v[64:67], v[188:191]
    v_exp_f32 v170, v170
    v_mfma_f32_16x16x32_bf16 v[196:199], a[20:23], v[68:71], v[196:199]
    s_waitcnt vmcnt(4)
    buffer_load_dwordx4 v245, s[12:15], s38 offen offset:1024 nt lds
    v_cvt_pk_bf16_f32 v53, v162, v163
    v_mfma_f32_16x16x32_bf16 v[192:195], a[16:19], v[68:71], v[192:195]
    ds_read_b128 a[12:15], v2 offset:6400
    v_exp_f32 v171, v171
    v_mfma_f32_16x16x32_bf16 v[200:203], a[16:19], v[72:75], v[200:203]
    v_exp_f32 v172, v172
    v_mfma_f32_16x16x32_bf16 v[204:207], a[20:23], v[72:75], v[204:207]
    v_cvt_pk_bf16_f32 v54, v164, v165
    v_cvt_pk_bf16_f32 v55, v166, v167
    s_waitcnt lgkmcnt(4)
    v_mfma_f32_16x16x32_bf16 v[184:187], a[24:27], v[88:91], v[184:187]
    ds_read_b64_tr_b16 a[16:17], v3 offset:0
    v_exp_f32 v173, v173
    v_mfma_f32_16x16x32_bf16 v[188:191], a[28:31], v[88:91], v[188:191]
    v_exp_f32 v174, v174
    v_mfma_f32_16x16x32_bf16 v[196:199], a[28:31], v[92:95], v[196:199]
    ds_read_b64_tr_b16 a[18:19], v3 offset:6144
    v_cvt_pk_bf16_f32 v56, v168, v169
    v_mfma_f32_16x16x32_bf16 v[192:195], a[24:27], v[92:95], v[192:195]
    ds_read_b64_tr_b16 a[20:21], v4 offset:0
    v_exp_f32 v175, v175
    v_mfma_f32_16x16x32_bf16 v[200:203], a[24:27], v[96:99], v[200:203]
    v_exp_f32 v176, v176
    v_mfma_f32_16x16x32_bf16 v[204:207], a[28:31], v[96:99], v[204:207]
    ds_read_b64_tr_b16 a[22:23], v4 offset:6144
    s_waitcnt lgkmcnt(6)
    v_mfma_f32_16x16x32_bf16 v[184:187], a[0:3], v[112:115], v[184:187]
    ds_read_b64_tr_b16 a[24:25], v5 offset:0
    v_exp_f32 v177, v177
    v_mfma_f32_16x16x32_bf16 v[188:191], a[4:7], v[112:115], v[188:191]
    v_exp_f32 v178, v178
    v_mfma_f32_16x16x32_bf16 v[196:199], a[4:7], v[116:119], v[196:199]
    ds_read_b64_tr_b16 a[26:27], v5 offset:6144
    v_exp_f32 v179, v179
    v_mfma_f32_16x16x32_bf16 v[192:195], a[0:3], v[116:119], v[192:195]
    ds_read_b64_tr_b16 a[28:29], v6 offset:0
    s_waitcnt vmcnt(4)
    buffer_load_dwordx4 v246, s[12:15], s38 offen offset:2048 nt lds
    v_mfma_f32_16x16x32_bf16 v[200:203], a[0:3], v[120:123], v[200:203]
    v_exp_f32 v180, v180
    v_mfma_f32_16x16x32_bf16 v[204:207], a[4:7], v[120:123], v[204:207]
    ds_read_b64_tr_b16 a[30:31], v6 offset:6144
    v_cvt_pk_bf16_f32 v57, v170, v171
    s_waitcnt lgkmcnt(8)
    v_mfma_f32_16x16x32_bf16 v[184:187], a[8:11], v[136:139], v[184:187]
    ds_read_b64_tr_b16 a[0:1], v3 offset:128
    v_exp_f32 v181, v181
    v_mfma_f32_16x16x32_bf16 v[188:191], a[12:15], v[136:139], v[188:191]
    v_exp_f32 v182, v182
    v_mfma_f32_16x16x32_bf16 v[196:199], a[12:15], v[140:143], v[196:199]
    ds_read_b64_tr_b16 a[2:3], v3 offset:6272
    v_exp_f32 v183, v183
    v_mfma_f32_16x16x32_bf16 v[192:195], a[8:11], v[140:143], v[192:195]
    ds_read_b64_tr_b16 a[4:5], v4 offset:128
    v_cvt_pk_bf16_f32 v58, v172, v173
    v_mfma_f32_16x16x32_bf16 v[200:203], a[8:11], v[144:147], v[200:203]
    v_cvt_pk_bf16_f32 v59, v174, v175
    v_cvt_pk_bf16_f32 v60, v176, v177
    v_cvt_pk_bf16_f32 v61, v178, v179
    v_cvt_pk_bf16_f32 v62, v180, v181
    v_cvt_pk_bf16_f32 v63, v182, v183
    v_mfma_f32_16x16x32_bf16 v[204:207], a[12:15], v[144:147], v[204:207]
    ds_read_b64_tr_b16 a[6:7], v4 offset:6272
    s_waitcnt lgkmcnt(8)
    v_mfma_f32_16x16x32_bf16 a[32:35], a[16:19], v[52:55], a[32:35]
    ds_read_b64_tr_b16 a[8:9], v5 offset:128
    v_add_f32 v7, v7, v161
    v_mfma_f32_16x16x32_bf16 a[44:47], a[20:23], v[52:55], a[44:47]
    v_add_f32 v7, v7, v162
    v_mfma_f32_16x16x32_bf16 a[48:51], a[20:23], v[56:59], a[48:51]
    ds_read_b64_tr_b16 a[10:11], v5 offset:6272
    v_mfma_f32_16x16x32_bf16 a[36:39], a[16:19], v[56:59], a[36:39]
    ds_read_b64_tr_b16 a[12:13], v6 offset:128
    v_add_f32 v7, v7, v163
    v_mfma_f32_16x16x32_bf16 a[40:43], a[16:19], v[60:63], a[40:43]
    s_waitcnt vmcnt(4)
    buffer_load_dwordx4 v247, s[12:15], s38 offen offset:3072 nt lds
    v_mfma_f32_16x16x32_bf16 a[52:55], a[20:23], v[60:63], a[52:55]
    ds_read_b64_tr_b16 a[14:15], v6 offset:6272
    s_waitcnt lgkmcnt(8)
    v_mfma_f32_16x16x32_bf16 a[64:67], a[24:27], v[60:63], a[64:67]
    ds_read_b64_tr_b16 a[16:17], v3 offset:256
    v_add_f32 v7, v7, v164
    v_mfma_f32_16x16x32_bf16 a[76:79], a[28:31], v[60:63], a[76:79]
    v_add_f32 v7, v7, v165
    v_mfma_f32_16x16x32_bf16 a[72:75], a[28:31], v[56:59], a[72:75]
    ds_read_b64_tr_b16 a[18:19], v3 offset:6400
    v_mfma_f32_16x16x32_bf16 a[60:63], a[24:27], v[56:59], a[60:63]
    ds_read_b64_tr_b16 a[20:21], v4 offset:256
    v_add_f32 v7, v7, v166
    v_mfma_f32_16x16x32_bf16 a[56:59], a[24:27], v[52:55], a[56:59]
    v_add_f32 v7, v7, v167
    v_mfma_f32_16x16x32_bf16 a[68:71], a[28:31], v[52:55], a[68:71]
    ds_read_b64_tr_b16 a[22:23], v4 offset:6400
    s_waitcnt lgkmcnt(8)
    v_mfma_f32_16x16x32_bf16 a[80:83], a[0:3], v[52:55], a[80:83]
    ds_read_b64_tr_b16 a[24:25], v5 offset:256
    v_mfma_f32_16x16x32_bf16 a[92:95], a[4:7], v[52:55], a[92:95]
    v_add_f32 v8, v8, v168
    v_mfma_f32_16x16x32_bf16 a[96:99], a[4:7], v[56:59], a[96:99]
    ds_read_b64_tr_b16 a[26:27], v5 offset:6400
    v_add_f32 v8, v8, v169
    v_mfma_f32_16x16x32_bf16 a[84:87], a[0:3], v[56:59], a[84:87]
    ds_read_b64_tr_b16 a[28:29], v6 offset:256
    v_mfma_f32_16x16x32_bf16 a[88:91], a[0:3], v[60:63], a[88:91]
    s_add_u32 m0, s42, 28672
    v_add_f32 v8, v8, v170
    v_mfma_f32_16x16x32_bf16 a[100:103], a[4:7], v[60:63], a[100:103]
    ds_read_b64_tr_b16 a[30:31], v6 offset:6400
    s_waitcnt vmcnt(4)
    buffer_load_dwordx4 v248, s[12:15], s38 offen offset:0 nt lds
    s_waitcnt lgkmcnt(8)
    v_mfma_f32_16x16x32_bf16 a[112:115], a[8:11], v[60:63], a[112:115]
    ds_read_b128 a[0:3], v1 offset:24576
    v_mfma_f32_16x16x32_bf16 a[124:127], a[12:15], v[60:63], a[124:127]
    v_add_f32 v8, v8, v171
    v_add_f32 v8, v8, v172
    v_mfma_f32_16x16x32_bf16 a[120:123], a[12:15], v[56:59], a[120:123]
    v_add_f32 v8, v8, v173
    v_mfma_f32_16x16x32_bf16 a[108:111], a[8:11], v[56:59], a[108:111]
    ds_read_b128 a[4:7], v1 offset:30720
    v_mfma_f32_16x16x32_bf16 a[104:107], a[8:11], v[52:55], a[104:107]
    v_add_f32 v8, v8, v174
    v_mfma_f32_16x16x32_bf16 a[116:119], a[12:15], v[52:55], a[116:119]
    v_add_f32 v8, v8, v175
    s_waitcnt lgkmcnt(6)
    v_mfma_f32_16x16x32_bf16 a[128:131], a[16:19], v[52:55], a[128:131]
    ds_read_b128 a[8:11], v2 offset:24576
    v_mfma_f32_16x16x32_bf16 a[140:143], a[20:23], v[52:55], a[140:143]
    v_add_f32 v9, v9, v176
    v_mfma_f32_16x16x32_bf16 a[144:147], a[20:23], v[56:59], a[144:147]
    v_add_f32 v9, v9, v177
    v_mfma_f32_16x16x32_bf16 a[132:135], a[16:19], v[56:59], a[132:135]
    ds_read_b128 a[12:15], v2 offset:30720
    v_add_f32 v9, v9, v178
    v_mfma_f32_16x16x32_bf16 a[136:139], a[16:19], v[60:63], a[136:139]
    v_add_f32 v9, v9, v179
    v_mfma_f32_16x16x32_bf16 a[148:151], a[20:23], v[60:63], a[148:151]
    s_waitcnt lgkmcnt(4)
    v_mfma_f32_16x16x32_bf16 a[160:163], a[24:27], v[60:63], a[160:163]
    ds_read_b128 a[16:19], v1 offset:24704
    s_waitcnt vmcnt(4)
    buffer_load_dwordx4 v249, s[12:15], s38 offen offset:1024 nt lds
    v_mfma_f32_16x16x32_bf16 a[172:175], a[28:31], v[60:63], a[172:175]
    s_add_u32 s38, s38, 12288
    v_add_f32 v9, v9, v180
    v_mfma_f32_16x16x32_bf16 a[168:171], a[28:31], v[56:59], a[168:171]
    v_add_f32 v9, v9, v181
    v_mfma_f32_16x16x32_bf16 a[156:159], a[24:27], v[56:59], a[156:159]
    ds_read_b128 a[20:23], v1 offset:30848
    v_mfma_f32_16x16x32_bf16 a[152:155], a[24:27], v[52:55], a[152:155]
    v_add_f32 v9, v9, v182
    v_mfma_f32_16x16x32_bf16 a[164:167], a[28:31], v[52:55], a[164:167]
    v_add_f32 v9, v9, v183
    v_max3_f32 v10, v184, v185, v186
    v_max3_f32 v10, v10, v187, v188
    v_max3_f32 v10, v10, v189, v190
    v_max_f32 v10, v10, v191
    v_max3_f32 v11, v192, v193, v194
    v_max3_f32 v11, v11, v195, v196
    v_max3_f32 v11, v11, v197, v198
    v_max_f32 v11, v11, v199
    v_max3_f32 v12, v200, v201, v202
    v_max3_f32 v12, v12, v203, v204
    v_max3_f32 v12, v12, v205, v206
    v_max_f32 v12, v12, v207
    v_max3_f32 v13, v10, v11, v12
    v_cmp_lt_f32 vcc, 0, v13
    s_nop 0
    s_cbranch_vccz L_safe_skip_a
    v_mov_b32 v13, v10
    v_mov_b32 v14, v11
    v_mov_b32 v15, v12
    v_permlane32_swap_b32 v10, v13
    v_permlane32_swap_b32 v11, v14
    v_permlane32_swap_b32 v12, v15
    v_max_f32 v10, v10, v13
    v_max_f32 v11, v11, v14
    v_max_f32 v12, v12, v15
    v_mov_b32 v13, v10
    v_mov_b32 v14, v11
    v_mov_b32 v15, v12
    v_permlane16_swap_b32 v10, v13
    v_permlane16_swap_b32 v11, v14
    v_permlane16_swap_b32 v12, v15
    v_max_f32 v10, v10, v13
    v_max_f32 v11, v11, v14
    v_max_f32 v12, v12, v15
    v_max_f32 v10, 0, v10
    v_max_f32 v11, 0, v11
    v_max_f32 v12, 0, v12
    v_sub_f32 v13, 0, v10
    v_sub_f32 v14, 0, v11
    v_sub_f32 v15, 0, v12
    v_exp_f32 v13, v13
    v_exp_f32 v14, v14
    v_exp_f32 v15, v15
    v_sub_f32 v184, v184, v10
    v_sub_f32 v185, v185, v10
    v_sub_f32 v186, v186, v10
    v_sub_f32 v187, v187, v10
    v_sub_f32 v188, v188, v10
    v_sub_f32 v189, v189, v10
    v_sub_f32 v190, v190, v10
    v_sub_f32 v191, v191, v10
    v_sub_f32 v28, v28, v10
    v_sub_f32 v29, v29, v10
    v_sub_f32 v30, v30, v10
    v_sub_f32 v31, v31, v10
    v_mul_f32 v7, v7, v13
    v_sub_f32 v192, v192, v11
    v_sub_f32 v193, v193, v11
    v_sub_f32 v194, v194, v11
    v_sub_f32 v195, v195, v11
    v_sub_f32 v196, v196, v11
    v_sub_f32 v197, v197, v11
    v_sub_f32 v198, v198, v11
    v_sub_f32 v199, v199, v11
    v_sub_f32 v32, v32, v11
    v_sub_f32 v33, v33, v11
    v_sub_f32 v34, v34, v11
    v_sub_f32 v35, v35, v11
    v_mul_f32 v8, v8, v14
    v_sub_f32 v200, v200, v12
    v_sub_f32 v201, v201, v12
    v_sub_f32 v202, v202, v12
    v_sub_f32 v203, v203, v12
    v_sub_f32 v204, v204, v12
    v_sub_f32 v205, v205, v12
    v_sub_f32 v206, v206, v12
    v_sub_f32 v207, v207, v12
    v_sub_f32 v36, v36, v12
    v_sub_f32 v37, v37, v12
    v_sub_f32 v38, v38, v12
    v_sub_f32 v39, v39, v12
    v_mul_f32 v9, v9, v15
    v_accvgpr_read_b32 v76, a32
    v_accvgpr_read_b32 v77, a33
    v_accvgpr_read_b32 v78, a34
    v_accvgpr_read_b32 v79, a35
    v_accvgpr_read_b32 v80, a36
    v_accvgpr_read_b32 v81, a37
    v_accvgpr_read_b32 v82, a38
    v_accvgpr_read_b32 v83, a39
    v_accvgpr_read_b32 v84, a40
    v_accvgpr_read_b32 v85, a41
    v_accvgpr_read_b32 v86, a42
    v_accvgpr_read_b32 v87, a43
    v_mul_f32 v76, v76, v13
    v_mul_f32 v77, v77, v13
    v_mul_f32 v78, v78, v13
    v_mul_f32 v79, v79, v13
    v_mul_f32 v80, v80, v14
    v_mul_f32 v81, v81, v14
    v_mul_f32 v82, v82, v14
    v_mul_f32 v83, v83, v14
    v_mul_f32 v84, v84, v15
    v_mul_f32 v85, v85, v15
    v_mul_f32 v86, v86, v15
    v_mul_f32 v87, v87, v15
    v_accvgpr_write_b32 a32, v76
    v_accvgpr_write_b32 a33, v77
    v_accvgpr_write_b32 a34, v78
    v_accvgpr_write_b32 a35, v79
    v_accvgpr_write_b32 a36, v80
    v_accvgpr_write_b32 a37, v81
    v_accvgpr_write_b32 a38, v82
    v_accvgpr_write_b32 a39, v83
    v_accvgpr_write_b32 a40, v84
    v_accvgpr_write_b32 a41, v85
    v_accvgpr_write_b32 a42, v86
    v_accvgpr_write_b32 a43, v87
    v_accvgpr_read_b32 v76, a44
    v_accvgpr_read_b32 v77, a45
    v_accvgpr_read_b32 v78, a46
    v_accvgpr_read_b32 v79, a47
    v_accvgpr_read_b32 v80, a48
    v_accvgpr_read_b32 v81, a49
    v_accvgpr_read_b32 v82, a50
    v_accvgpr_read_b32 v83, a51
    v_accvgpr_read_b32 v84, a52
    v_accvgpr_read_b32 v85, a53
    v_accvgpr_read_b32 v86, a54
    v_accvgpr_read_b32 v87, a55
    v_mul_f32 v76, v76, v13
    v_mul_f32 v77, v77, v13
    v_mul_f32 v78, v78, v13
    v_mul_f32 v79, v79, v13
    v_mul_f32 v80, v80, v14
    v_mul_f32 v81, v81, v14
    v_mul_f32 v82, v82, v14
    v_mul_f32 v83, v83, v14
    v_mul_f32 v84, v84, v15
    v_mul_f32 v85, v85, v15
    v_mul_f32 v86, v86, v15
    v_mul_f32 v87, v87, v15
    v_accvgpr_write_b32 a44, v76
    v_accvgpr_write_b32 a45, v77
    v_accvgpr_write_b32 a46, v78
    v_accvgpr_write_b32 a47, v79
    v_accvgpr_write_b32 a48, v80
    v_accvgpr_write_b32 a49, v81
    v_accvgpr_write_b32 a50, v82
    v_accvgpr_write_b32 a51, v83
    v_accvgpr_write_b32 a52, v84
    v_accvgpr_write_b32 a53, v85
    v_accvgpr_write_b32 a54, v86
    v_accvgpr_write_b32 a55, v87
    v_accvgpr_read_b32 v76, a56
    v_accvgpr_read_b32 v77, a57
    v_accvgpr_read_b32 v78, a58
    v_accvgpr_read_b32 v79, a59
    v_accvgpr_read_b32 v80, a60
    v_accvgpr_read_b32 v81, a61
    v_accvgpr_read_b32 v82, a62
    v_accvgpr_read_b32 v83, a63
    v_accvgpr_read_b32 v84, a64
    v_accvgpr_read_b32 v85, a65
    v_accvgpr_read_b32 v86, a66
    v_accvgpr_read_b32 v87, a67
    v_mul_f32 v76, v76, v13
    v_mul_f32 v77, v77, v13
    v_mul_f32 v78, v78, v13
    v_mul_f32 v79, v79, v13
    v_mul_f32 v80, v80, v14
    v_mul_f32 v81, v81, v14
    v_mul_f32 v82, v82, v14
    v_mul_f32 v83, v83, v14
    v_mul_f32 v84, v84, v15
    v_mul_f32 v85, v85, v15
    v_mul_f32 v86, v86, v15
    v_mul_f32 v87, v87, v15
    v_accvgpr_write_b32 a56, v76
    v_accvgpr_write_b32 a57, v77
    v_accvgpr_write_b32 a58, v78
    v_accvgpr_write_b32 a59, v79
    v_accvgpr_write_b32 a60, v80
    v_accvgpr_write_b32 a61, v81
    v_accvgpr_write_b32 a62, v82
    v_accvgpr_write_b32 a63, v83
    v_accvgpr_write_b32 a64, v84
    v_accvgpr_write_b32 a65, v85
    v_accvgpr_write_b32 a66, v86
    v_accvgpr_write_b32 a67, v87
    v_accvgpr_read_b32 v76, a68
    v_accvgpr_read_b32 v77, a69
    v_accvgpr_read_b32 v78, a70
    v_accvgpr_read_b32 v79, a71
    v_accvgpr_read_b32 v80, a72
    v_accvgpr_read_b32 v81, a73
    v_accvgpr_read_b32 v82, a74
    v_accvgpr_read_b32 v83, a75
    v_accvgpr_read_b32 v84, a76
    v_accvgpr_read_b32 v85, a77
    v_accvgpr_read_b32 v86, a78
    v_accvgpr_read_b32 v87, a79
    v_mul_f32 v76, v76, v13
    v_mul_f32 v77, v77, v13
    v_mul_f32 v78, v78, v13
    v_mul_f32 v79, v79, v13
    v_mul_f32 v80, v80, v14
    v_mul_f32 v81, v81, v14
    v_mul_f32 v82, v82, v14
    v_mul_f32 v83, v83, v14
    v_mul_f32 v84, v84, v15
    v_mul_f32 v85, v85, v15
    v_mul_f32 v86, v86, v15
    v_mul_f32 v87, v87, v15
    v_accvgpr_write_b32 a68, v76
    v_accvgpr_write_b32 a69, v77
    v_accvgpr_write_b32 a70, v78
    v_accvgpr_write_b32 a71, v79
    v_accvgpr_write_b32 a72, v80
    v_accvgpr_write_b32 a73, v81
    v_accvgpr_write_b32 a74, v82
    v_accvgpr_write_b32 a75, v83
    v_accvgpr_write_b32 a76, v84
    v_accvgpr_write_b32 a77, v85
    v_accvgpr_write_b32 a78, v86
    v_accvgpr_write_b32 a79, v87
    v_accvgpr_read_b32 v76, a80
    v_accvgpr_read_b32 v77, a81
    v_accvgpr_read_b32 v78, a82
    v_accvgpr_read_b32 v79, a83
    v_accvgpr_read_b32 v80, a84
    v_accvgpr_read_b32 v81, a85
    v_accvgpr_read_b32 v82, a86
    v_accvgpr_read_b32 v83, a87
    v_accvgpr_read_b32 v84, a88
    v_accvgpr_read_b32 v85, a89
    v_accvgpr_read_b32 v86, a90
    v_accvgpr_read_b32 v87, a91
    v_mul_f32 v76, v76, v13
    v_mul_f32 v77, v77, v13
    v_mul_f32 v78, v78, v13
    v_mul_f32 v79, v79, v13
    v_mul_f32 v80, v80, v14
    v_mul_f32 v81, v81, v14
    v_mul_f32 v82, v82, v14
    v_mul_f32 v83, v83, v14
    v_mul_f32 v84, v84, v15
    v_mul_f32 v85, v85, v15
    v_mul_f32 v86, v86, v15
    v_mul_f32 v87, v87, v15
    v_accvgpr_write_b32 a80, v76
    v_accvgpr_write_b32 a81, v77
    v_accvgpr_write_b32 a82, v78
    v_accvgpr_write_b32 a83, v79
    v_accvgpr_write_b32 a84, v80
    v_accvgpr_write_b32 a85, v81
    v_accvgpr_write_b32 a86, v82
    v_accvgpr_write_b32 a87, v83
    v_accvgpr_write_b32 a88, v84
    v_accvgpr_write_b32 a89, v85
    v_accvgpr_write_b32 a90, v86
    v_accvgpr_write_b32 a91, v87
    v_accvgpr_read_b32 v76, a92
    v_accvgpr_read_b32 v77, a93
    v_accvgpr_read_b32 v78, a94
    v_accvgpr_read_b32 v79, a95
    v_accvgpr_read_b32 v80, a96
    v_accvgpr_read_b32 v81, a97
    v_accvgpr_read_b32 v82, a98
    v_accvgpr_read_b32 v83, a99
    v_accvgpr_read_b32 v84, a100
    v_accvgpr_read_b32 v85, a101
    v_accvgpr_read_b32 v86, a102
    v_accvgpr_read_b32 v87, a103
    v_mul_f32 v76, v76, v13
    v_mul_f32 v77, v77, v13
    v_mul_f32 v78, v78, v13
    v_mul_f32 v79, v79, v13
    v_mul_f32 v80, v80, v14
    v_mul_f32 v81, v81, v14
    v_mul_f32 v82, v82, v14
    v_mul_f32 v83, v83, v14
    v_mul_f32 v84, v84, v15
    v_mul_f32 v85, v85, v15
    v_mul_f32 v86, v86, v15
    v_mul_f32 v87, v87, v15
    v_accvgpr_write_b32 a92, v76
    v_accvgpr_write_b32 a93, v77
    v_accvgpr_write_b32 a94, v78
    v_accvgpr_write_b32 a95, v79
    v_accvgpr_write_b32 a96, v80
    v_accvgpr_write_b32 a97, v81
    v_accvgpr_write_b32 a98, v82
    v_accvgpr_write_b32 a99, v83
    v_accvgpr_write_b32 a100, v84
    v_accvgpr_write_b32 a101, v85
    v_accvgpr_write_b32 a102, v86
    v_accvgpr_write_b32 a103, v87
    v_accvgpr_read_b32 v76, a104
    v_accvgpr_read_b32 v77, a105
    v_accvgpr_read_b32 v78, a106
    v_accvgpr_read_b32 v79, a107
    v_accvgpr_read_b32 v80, a108
    v_accvgpr_read_b32 v81, a109
    v_accvgpr_read_b32 v82, a110
    v_accvgpr_read_b32 v83, a111
    v_accvgpr_read_b32 v84, a112
    v_accvgpr_read_b32 v85, a113
    v_accvgpr_read_b32 v86, a114
    v_accvgpr_read_b32 v87, a115
    v_mul_f32 v76, v76, v13
    v_mul_f32 v77, v77, v13
    v_mul_f32 v78, v78, v13
    v_mul_f32 v79, v79, v13
    v_mul_f32 v80, v80, v14
    v_mul_f32 v81, v81, v14
    v_mul_f32 v82, v82, v14
    v_mul_f32 v83, v83, v14
    v_mul_f32 v84, v84, v15
    v_mul_f32 v85, v85, v15
    v_mul_f32 v86, v86, v15
    v_mul_f32 v87, v87, v15
    v_accvgpr_write_b32 a104, v76
    v_accvgpr_write_b32 a105, v77
    v_accvgpr_write_b32 a106, v78
    v_accvgpr_write_b32 a107, v79
    v_accvgpr_write_b32 a108, v80
    v_accvgpr_write_b32 a109, v81
    v_accvgpr_write_b32 a110, v82
    v_accvgpr_write_b32 a111, v83
    v_accvgpr_write_b32 a112, v84
    v_accvgpr_write_b32 a113, v85
    v_accvgpr_write_b32 a114, v86
    v_accvgpr_write_b32 a115, v87
    v_accvgpr_read_b32 v76, a116
    v_accvgpr_read_b32 v77, a117
    v_accvgpr_read_b32 v78, a118
    v_accvgpr_read_b32 v79, a119
    v_accvgpr_read_b32 v80, a120
    v_accvgpr_read_b32 v81, a121
    v_accvgpr_read_b32 v82, a122
    v_accvgpr_read_b32 v83, a123
    v_accvgpr_read_b32 v84, a124
    v_accvgpr_read_b32 v85, a125
    v_accvgpr_read_b32 v86, a126
    v_accvgpr_read_b32 v87, a127
    v_mul_f32 v76, v76, v13
    v_mul_f32 v77, v77, v13
    v_mul_f32 v78, v78, v13
    v_mul_f32 v79, v79, v13
    v_mul_f32 v80, v80, v14
    v_mul_f32 v81, v81, v14
    v_mul_f32 v82, v82, v14
    v_mul_f32 v83, v83, v14
    v_mul_f32 v84, v84, v15
    v_mul_f32 v85, v85, v15
    v_mul_f32 v86, v86, v15
    v_mul_f32 v87, v87, v15
    v_accvgpr_write_b32 a116, v76
    v_accvgpr_write_b32 a117, v77
    v_accvgpr_write_b32 a118, v78
    v_accvgpr_write_b32 a119, v79
    v_accvgpr_write_b32 a120, v80
    v_accvgpr_write_b32 a121, v81
    v_accvgpr_write_b32 a122, v82
    v_accvgpr_write_b32 a123, v83
    v_accvgpr_write_b32 a124, v84
    v_accvgpr_write_b32 a125, v85
    v_accvgpr_write_b32 a126, v86
    v_accvgpr_write_b32 a127, v87
    v_accvgpr_read_b32 v76, a128
    v_accvgpr_read_b32 v77, a129
    v_accvgpr_read_b32 v78, a130
    v_accvgpr_read_b32 v79, a131
    v_accvgpr_read_b32 v80, a132
    v_accvgpr_read_b32 v81, a133
    v_accvgpr_read_b32 v82, a134
    v_accvgpr_read_b32 v83, a135
    v_accvgpr_read_b32 v84, a136
    v_accvgpr_read_b32 v85, a137
    v_accvgpr_read_b32 v86, a138
    v_accvgpr_read_b32 v87, a139
    v_mul_f32 v76, v76, v13
    v_mul_f32 v77, v77, v13
    v_mul_f32 v78, v78, v13
    v_mul_f32 v79, v79, v13
    v_mul_f32 v80, v80, v14
    v_mul_f32 v81, v81, v14
    v_mul_f32 v82, v82, v14
    v_mul_f32 v83, v83, v14
    v_mul_f32 v84, v84, v15
    v_mul_f32 v85, v85, v15
    v_mul_f32 v86, v86, v15
    v_mul_f32 v87, v87, v15
    v_accvgpr_write_b32 a128, v76
    v_accvgpr_write_b32 a129, v77
    v_accvgpr_write_b32 a130, v78
    v_accvgpr_write_b32 a131, v79
    v_accvgpr_write_b32 a132, v80
    v_accvgpr_write_b32 a133, v81
    v_accvgpr_write_b32 a134, v82
    v_accvgpr_write_b32 a135, v83
    v_accvgpr_write_b32 a136, v84
    v_accvgpr_write_b32 a137, v85
    v_accvgpr_write_b32 a138, v86
    v_accvgpr_write_b32 a139, v87
    v_accvgpr_read_b32 v76, a140
    v_accvgpr_read_b32 v77, a141
    v_accvgpr_read_b32 v78, a142
    v_accvgpr_read_b32 v79, a143
    v_accvgpr_read_b32 v80, a144
    v_accvgpr_read_b32 v81, a145
    v_accvgpr_read_b32 v82, a146
    v_accvgpr_read_b32 v83, a147
    v_accvgpr_read_b32 v84, a148
    v_accvgpr_read_b32 v85, a149
    v_accvgpr_read_b32 v86, a150
    v_accvgpr_read_b32 v87, a151
    v_mul_f32 v76, v76, v13
    v_mul_f32 v77, v77, v13
    v_mul_f32 v78, v78, v13
    v_mul_f32 v79, v79, v13
    v_mul_f32 v80, v80, v14
    v_mul_f32 v81, v81, v14
    v_mul_f32 v82, v82, v14
    v_mul_f32 v83, v83, v14
    v_mul_f32 v84, v84, v15
    v_mul_f32 v85, v85, v15
    v_mul_f32 v86, v86, v15
    v_mul_f32 v87, v87, v15
    v_accvgpr_write_b32 a140, v76
    v_accvgpr_write_b32 a141, v77
    v_accvgpr_write_b32 a142, v78
    v_accvgpr_write_b32 a143, v79
    v_accvgpr_write_b32 a144, v80
    v_accvgpr_write_b32 a145, v81
    v_accvgpr_write_b32 a146, v82
    v_accvgpr_write_b32 a147, v83
    v_accvgpr_write_b32 a148, v84
    v_accvgpr_write_b32 a149, v85
    v_accvgpr_write_b32 a150, v86
    v_accvgpr_write_b32 a151, v87
    v_accvgpr_read_b32 v76, a152
    v_accvgpr_read_b32 v77, a153
    v_accvgpr_read_b32 v78, a154
    v_accvgpr_read_b32 v79, a155
    v_accvgpr_read_b32 v80, a156
    v_accvgpr_read_b32 v81, a157
    v_accvgpr_read_b32 v82, a158
    v_accvgpr_read_b32 v83, a159
    v_accvgpr_read_b32 v84, a160
    v_accvgpr_read_b32 v85, a161
    v_accvgpr_read_b32 v86, a162
    v_accvgpr_read_b32 v87, a163
    v_mul_f32 v76, v76, v13
    v_mul_f32 v77, v77, v13
    v_mul_f32 v78, v78, v13
    v_mul_f32 v79, v79, v13
    v_mul_f32 v80, v80, v14
    v_mul_f32 v81, v81, v14
    v_mul_f32 v82, v82, v14
    v_mul_f32 v83, v83, v14
    v_mul_f32 v84, v84, v15
    v_mul_f32 v85, v85, v15
    v_mul_f32 v86, v86, v15
    v_mul_f32 v87, v87, v15
    v_accvgpr_write_b32 a152, v76
    v_accvgpr_write_b32 a153, v77
    v_accvgpr_write_b32 a154, v78
    v_accvgpr_write_b32 a155, v79
    v_accvgpr_write_b32 a156, v80
    v_accvgpr_write_b32 a157, v81
    v_accvgpr_write_b32 a158, v82
    v_accvgpr_write_b32 a159, v83
    v_accvgpr_write_b32 a160, v84
    v_accvgpr_write_b32 a161, v85
    v_accvgpr_write_b32 a162, v86
    v_accvgpr_write_b32 a163, v87
    v_accvgpr_read_b32 v76, a164
    v_accvgpr_read_b32 v77, a165
    v_accvgpr_read_b32 v78, a166
    v_accvgpr_read_b32 v79, a167
    v_accvgpr_read_b32 v80, a168
    v_accvgpr_read_b32 v81, a169
    v_accvgpr_read_b32 v82, a170
    v_accvgpr_read_b32 v83, a171
    v_accvgpr_read_b32 v84, a172
    v_accvgpr_read_b32 v85, a173
    v_accvgpr_read_b32 v86, a174
    v_accvgpr_read_b32 v87, a175
    v_mul_f32 v76, v76, v13
    v_mul_f32 v77, v77, v13
    v_mul_f32 v78, v78, v13
    v_mul_f32 v79, v79, v13
    v_mul_f32 v80, v80, v14
    v_mul_f32 v81, v81, v14
    v_mul_f32 v82, v82, v14
    v_mul_f32 v83, v83, v14
    v_mul_f32 v84, v84, v15
    v_mul_f32 v85, v85, v15
    v_mul_f32 v86, v86, v15
    v_mul_f32 v87, v87, v15
    v_accvgpr_write_b32 a164, v76
    v_accvgpr_write_b32 a165, v77
    v_accvgpr_write_b32 a166, v78
    v_accvgpr_write_b32 a167, v79
    v_accvgpr_write_b32 a168, v80
    v_accvgpr_write_b32 a169, v81
    v_accvgpr_write_b32 a170, v82
    v_accvgpr_write_b32 a171, v83
    v_accvgpr_write_b32 a172, v84
    v_accvgpr_write_b32 a173, v85
    v_accvgpr_write_b32 a174, v86
    v_accvgpr_write_b32 a175, v87
L_safe_skip_a:
    s_nop 1
    s_waitcnt lgkmcnt(4)
    v_mfma_f32_16x16x32_bf16 v[160:163], a[0:3], v[16:19], v[28:31]
    ds_read_b128 a[24:27], v2 offset:24704
    v_mfma_f32_16x16x32_bf16 v[164:167], a[4:7], v[16:19], v[28:31]
    s_add_u32 m0, s36, 0
    v_exp_f32 v184, v184
    v_mfma_f32_16x16x32_bf16 v[172:175], a[4:7], v[20:23], v[32:35]
    s_waitcnt vmcnt(4)
    buffer_load_dwordx4 v244, s[12:15], s38 offen offset:0 nt lds
    v_add_f32 v7, v7, v184
    v_mfma_f32_16x16x32_bf16 v[168:171], a[0:3], v[20:23], v[32:35]
    ds_read_b128 a[28:31], v2 offset:30848
    v_exp_f32 v185, v185
    v_mfma_f32_16x16x32_bf16 v[176:179], a[0:3], v[24:27], v[36:39]
    v_exp_f32 v186, v186
    v_mfma_f32_16x16x32_bf16 v[180:183], a[4:7], v[24:27], v[36:39]
    v_exp_f32 v187, v187
    s_waitcnt lgkmcnt(4)
    v_mfma_f32_16x16x32_bf16 v[160:163], a[8:11], v[40:43], v[160:163]
    ds_read_b128 a[0:3], v1 offset:24832
    v_exp_f32 v188, v188
    v_mfma_f32_16x16x32_bf16 v[164:167], a[12:15], v[40:43], v[164:167]
    v_exp_f32 v189, v189
    v_mfma_f32_16x16x32_bf16 v[172:175], a[12:15], v[44:47], v[172:175]
    v_exp_f32 v190, v190
    v_cvt_pk_bf16_f32 v52, v184, v185
    v_mfma_f32_16x16x32_bf16 v[168:171], a[8:11], v[44:47], v[168:171]
    ds_read_b128 a[4:7], v1 offset:30976
    v_exp_f32 v191, v191
    v_mfma_f32_16x16x32_bf16 v[176:179], a[8:11], v[48:51], v[176:179]
    s_waitcnt vmcnt(4)
    buffer_load_dwordx4 v245, s[12:15], s38 offen offset:1024 nt lds
    v_cvt_pk_bf16_f32 v53, v186, v187
    v_mfma_f32_16x16x32_bf16 v[180:183], a[12:15], v[48:51], v[180:183]
    v_cvt_pk_bf16_f32 v54, v188, v189
    s_waitcnt lgkmcnt(4)
    v_mfma_f32_16x16x32_bf16 v[160:163], a[16:19], v[64:67], v[160:163]
    ds_read_b128 a[8:11], v2 offset:24832
    v_exp_f32 v192, v192
    v_mfma_f32_16x16x32_bf16 v[164:167], a[20:23], v[64:67], v[164:167]
    v_exp_f32 v193, v193
    v_mfma_f32_16x16x32_bf16 v[172:175], a[20:23], v[68:71], v[172:175]
    v_exp_f32 v194, v194
    v_mfma_f32_16x16x32_bf16 v[168:171], a[16:19], v[68:71], v[168:171]
    ds_read_b128 a[12:15], v2 offset:30976
    v_exp_f32 v195, v195
    v_mfma_f32_16x16x32_bf16 v[176:179], a[16:19], v[72:75], v[176:179]
    v_exp_f32 v196, v196
    v_mfma_f32_16x16x32_bf16 v[180:183], a[20:23], v[72:75], v[180:183]
    v_exp_f32 v197, v197
    s_waitcnt lgkmcnt(4)
    v_mfma_f32_16x16x32_bf16 v[160:163], a[24:27], v[88:91], v[160:163]
    ds_read_b64_tr_b16 a[16:17], v3 offset:24576
    v_exp_f32 v198, v198
    v_mfma_f32_16x16x32_bf16 v[164:167], a[28:31], v[88:91], v[164:167]
    s_waitcnt vmcnt(4)
    buffer_load_dwordx4 v246, s[12:15], s38 offen offset:2048 nt lds
    v_cvt_pk_bf16_f32 v55, v190, v191
    v_mfma_f32_16x16x32_bf16 v[172:175], a[28:31], v[92:95], v[172:175]
    ds_read_b64_tr_b16 a[18:19], v3 offset:30720
    v_exp_f32 v199, v199
    v_mfma_f32_16x16x32_bf16 v[168:171], a[24:27], v[92:95], v[168:171]
    ds_read_b64_tr_b16 a[20:21], v4 offset:24576
    v_cvt_pk_bf16_f32 v56, v192, v193
    v_mfma_f32_16x16x32_bf16 v[176:179], a[24:27], v[96:99], v[176:179]
    v_exp_f32 v200, v200
    v_mfma_f32_16x16x32_bf16 v[180:183], a[28:31], v[96:99], v[180:183]
    ds_read_b64_tr_b16 a[22:23], v4 offset:30720
    s_waitcnt lgkmcnt(6)
    v_mfma_f32_16x16x32_bf16 v[160:163], a[0:3], v[112:115], v[160:163]
    ds_read_b64_tr_b16 a[24:25], v5 offset:24576
    v_exp_f32 v201, v201
    v_mfma_f32_16x16x32_bf16 v[164:167], a[4:7], v[112:115], v[164:167]
    v_exp_f32 v202, v202
    v_cvt_pk_bf16_f32 v57, v194, v195
    v_mfma_f32_16x16x32_bf16 v[172:175], a[4:7], v[116:119], v[172:175]
    ds_read_b64_tr_b16 a[26:27], v5 offset:30720
    v_exp_f32 v203, v203
    v_mfma_f32_16x16x32_bf16 v[168:171], a[0:3], v[116:119], v[168:171]
    ds_read_b64_tr_b16 a[28:29], v6 offset:24576
    v_exp_f32 v204, v204
    v_mfma_f32_16x16x32_bf16 v[176:179], a[0:3], v[120:123], v[176:179]
    s_waitcnt vmcnt(4)
    buffer_load_dwordx4 v247, s[12:15], s38 offen offset:3072 nt lds
    v_exp_f32 v205, v205
    v_mfma_f32_16x16x32_bf16 v[180:183], a[4:7], v[120:123], v[180:183]
    ds_read_b64_tr_b16 a[30:31], v6 offset:30720
    s_waitcnt lgkmcnt(8)
    v_mfma_f32_16x16x32_bf16 v[160:163], a[8:11], v[136:139], v[160:163]
    ds_read_b64_tr_b16 a[0:1], v3 offset:24704
    v_exp_f32 v206, v206
    v_mfma_f32_16x16x32_bf16 v[164:167], a[12:15], v[136:139], v[164:167]
    v_exp_f32 v207, v207
    v_mfma_f32_16x16x32_bf16 v[172:175], a[12:15], v[140:143], v[172:175]
    ds_read_b64_tr_b16 a[2:3], v3 offset:30848
    v_cvt_pk_bf16_f32 v58, v196, v197
    v_mfma_f32_16x16x32_bf16 v[168:171], a[8:11], v[140:143], v[168:171]
    ds_read_b64_tr_b16 a[4:5], v4 offset:24704
    v_cvt_pk_bf16_f32 v59, v198, v199
    v_mfma_f32_16x16x32_bf16 v[176:179], a[8:11], v[144:147], v[176:179]
    v_cvt_pk_bf16_f32 v60, v200, v201
    v_cvt_pk_bf16_f32 v61, v202, v203
    v_cvt_pk_bf16_f32 v62, v204, v205
    v_cvt_pk_bf16_f32 v63, v206, v207
    v_mfma_f32_16x16x32_bf16 v[180:183], a[12:15], v[144:147], v[180:183]
    ds_read_b64_tr_b16 a[6:7], v4 offset:30848
    s_waitcnt lgkmcnt(8)
    v_mfma_f32_16x16x32_bf16 a[32:35], a[16:19], v[52:55], a[32:35]
    ds_read_b64_tr_b16 a[8:9], v5 offset:24704
    s_add_u32 m0, s36, 4096
    v_mfma_f32_16x16x32_bf16 a[44:47], a[20:23], v[52:55], a[44:47]
    s_waitcnt vmcnt(4)
    buffer_load_dwordx4 v248, s[12:15], s38 offen offset:0 nt lds
    v_add_f32 v7, v7, v185
    v_mfma_f32_16x16x32_bf16 a[48:51], a[20:23], v[56:59], a[48:51]
    ds_read_b64_tr_b16 a[10:11], v5 offset:30848
    v_add_f32 v7, v7, v186
    v_mfma_f32_16x16x32_bf16 a[36:39], a[16:19], v[56:59], a[36:39]
    ds_read_b64_tr_b16 a[12:13], v6 offset:24704
    v_mfma_f32_16x16x32_bf16 a[40:43], a[16:19], v[60:63], a[40:43]
    v_add_f32 v7, v7, v187
    v_add_f32 v7, v7, v188
    v_mfma_f32_16x16x32_bf16 a[52:55], a[20:23], v[60:63], a[52:55]
    ds_read_b64_tr_b16 a[14:15], v6 offset:30848
    s_waitcnt lgkmcnt(8)
    v_mfma_f32_16x16x32_bf16 a[64:67], a[24:27], v[60:63], a[64:67]
    ds_read_b64_tr_b16 a[16:17], v3 offset:24832
    v_mfma_f32_16x16x32_bf16 a[76:79], a[28:31], v[60:63], a[76:79]
    v_add_f32 v7, v7, v189
    v_mfma_f32_16x16x32_bf16 a[72:75], a[28:31], v[56:59], a[72:75]
    ds_read_b64_tr_b16 a[18:19], v3 offset:30976
    v_add_f32 v7, v7, v190
    v_mfma_f32_16x16x32_bf16 a[60:63], a[24:27], v[56:59], a[60:63]
    ds_read_b64_tr_b16 a[20:21], v4 offset:24832
    v_add_f32 v7, v7, v191
    v_mfma_f32_16x16x32_bf16 a[56:59], a[24:27], v[52:55], a[56:59]
    s_waitcnt vmcnt(4)
    buffer_load_dwordx4 v249, s[12:15], s38 offen offset:1024 nt lds
    v_mfma_f32_16x16x32_bf16 a[68:71], a[28:31], v[52:55], a[68:71]
    ds_read_b64_tr_b16 a[22:23], v4 offset:30976
    s_add_u32 s38, s38, 12288
    s_waitcnt lgkmcnt(8)
    v_mfma_f32_16x16x32_bf16 a[80:83], a[0:3], v[52:55], a[80:83]
    ds_read_b64_tr_b16 a[24:25], v5 offset:24832
    s_sub_u32 s46, s42, s47
    v_mfma_f32_16x16x32_bf16 a[92:95], a[4:7], v[52:55], a[92:95]
    s_mov_b32 s42, s36
    v_add_f32 v8, v8, v192
    v_mfma_f32_16x16x32_bf16 a[96:99], a[4:7], v[56:59], a[96:99]
    ds_read_b64_tr_b16 a[26:27], v5 offset:30976
    v_add_f32 v8, v8, v193
    v_mfma_f32_16x16x32_bf16 a[84:87], a[0:3], v[56:59], a[84:87]
    ds_read_b64_tr_b16 a[28:29], v6 offset:24832
    s_mov_b32 s36, s47
    v_mfma_f32_16x16x32_bf16 a[88:91], a[0:3], v[60:63], a[88:91]
    s_add_u32 s47, s47, s46
    v_mfma_f32_16x16x32_bf16 a[100:103], a[4:7], v[60:63], a[100:103]
    ds_read_b64_tr_b16 a[30:31], v6 offset:30976
    s_waitcnt lgkmcnt(8)
    v_mfma_f32_16x16x32_bf16 a[112:115], a[8:11], v[60:63], a[112:115]
    v_add_u32 v1, s46, v1
    v_add_u32 v2, s46, v2
    v_mfma_f32_16x16x32_bf16 a[124:127], a[12:15], v[60:63], a[124:127]
    v_add_f32 v8, v8, v194
    v_add_f32 v8, v8, v195
    v_mfma_f32_16x16x32_bf16 a[120:123], a[12:15], v[56:59], a[120:123]
    v_add_u32 v3, s46, v3
    v_add_u32 v4, s46, v4
    v_mfma_f32_16x16x32_bf16 a[108:111], a[8:11], v[56:59], a[108:111]
    v_add_u32 v5, s46, v5
    v_add_u32 v6, s46, v6
    v_mfma_f32_16x16x32_bf16 a[104:107], a[8:11], v[52:55], a[104:107]
    v_add_f32 v8, v8, v196
    v_mfma_f32_16x16x32_bf16 a[116:119], a[12:15], v[52:55], a[116:119]
    s_waitcnt vmcnt(6) lgkmcnt(0)
    s_barrier
    v_mfma_f32_16x16x32_bf16 a[128:131], a[16:19], v[52:55], a[128:131]
    ds_read_b128 a[0:3], v1 offset:0
    ds_read_b128 a[4:7], v1 offset:6144
    v_mfma_f32_16x16x32_bf16 a[140:143], a[20:23], v[52:55], a[140:143]
    v_add_f32 v8, v8, v197
    v_mfma_f32_16x16x32_bf16 a[144:147], a[20:23], v[56:59], a[144:147]
    ds_read_b128 a[8:11], v2 offset:0
    v_add_f32 v8, v8, v198
    v_mfma_f32_16x16x32_bf16 a[132:135], a[16:19], v[56:59], a[132:135]
    ds_read_b128 a[12:15], v2 offset:6144
    v_add_f32 v8, v8, v199
    v_mfma_f32_16x16x32_bf16 a[136:139], a[16:19], v[60:63], a[136:139]
    v_add_f32 v9, v9, v200
    v_mfma_f32_16x16x32_bf16 a[148:151], a[20:23], v[60:63], a[148:151]
    v_add_f32 v9, v9, v201
    v_mfma_f32_16x16x32_bf16 a[160:163], a[24:27], v[60:63], a[160:163]
    ds_read_b128 a[16:19], v1 offset:128
    v_add_f32 v9, v9, v202
    v_mfma_f32_16x16x32_bf16 a[172:175], a[28:31], v[60:63], a[172:175]
    v_add_f32 v9, v9, v203
    v_mfma_f32_16x16x32_bf16 a[168:171], a[28:31], v[56:59], a[168:171]
    v_add_f32 v9, v9, v204
    v_mfma_f32_16x16x32_bf16 a[156:159], a[24:27], v[56:59], a[156:159]
    ds_read_b128 a[20:23], v1 offset:6272
    v_add_f32 v9, v9, v205
    v_mfma_f32_16x16x32_bf16 a[152:155], a[24:27], v[52:55], a[152:155]
    v_add_f32 v9, v9, v206
    v_mfma_f32_16x16x32_bf16 a[164:167], a[28:31], v[52:55], a[164:167]
    v_add_f32 v9, v9, v207
    v_max3_f32 v10, v160, v161, v162
    v_max3_f32 v10, v10, v163, v164
    v_max3_f32 v10, v10, v165, v166
    v_max_f32 v10, v10, v167
    v_max3_f32 v11, v168, v169, v170
    v_max3_f32 v11, v11, v171, v172
    v_max3_f32 v11, v11, v173, v174
    v_max_f32 v11, v11, v175
    v_max3_f32 v12, v176, v177, v178
    v_max3_f32 v12, v12, v179, v180
    v_max3_f32 v12, v12, v181, v182
    v_max_f32 v12, v12, v183
    v_max3_f32 v13, v10, v11, v12
    v_cmp_lt_f32 vcc, 0, v13
    s_nop 0
    s_cbranch_vccz L_safe_skip_b
    v_mov_b32 v13, v10
    v_mov_b32 v14, v11
    v_mov_b32 v15, v12
    v_permlane32_swap_b32 v10, v13
    v_permlane32_swap_b32 v11, v14
    v_permlane32_swap_b32 v12, v15
    v_max_f32 v10, v10, v13
    v_max_f32 v11, v11, v14
    v_max_f32 v12, v12, v15
    v_mov_b32 v13, v10
    v_mov_b32 v14, v11
    v_mov_b32 v15, v12
    v_permlane16_swap_b32 v10, v13
    v_permlane16_swap_b32 v11, v14
    v_permlane16_swap_b32 v12, v15
    v_max_f32 v10, v10, v13
    v_max_f32 v11, v11, v14
    v_max_f32 v12, v12, v15
    v_max_f32 v10, 0, v10
    v_max_f32 v11, 0, v11
    v_max_f32 v12, 0, v12
    v_sub_f32 v13, 0, v10
    v_sub_f32 v14, 0, v11
    v_sub_f32 v15, 0, v12
    v_exp_f32 v13, v13
    v_exp_f32 v14, v14
    v_exp_f32 v15, v15
    v_sub_f32 v160, v160, v10
    v_sub_f32 v161, v161, v10
    v_sub_f32 v162, v162, v10
    v_sub_f32 v163, v163, v10
    v_sub_f32 v164, v164, v10
    v_sub_f32 v165, v165, v10
    v_sub_f32 v166, v166, v10
    v_sub_f32 v167, v167, v10
    v_sub_f32 v28, v28, v10
    v_sub_f32 v29, v29, v10
    v_sub_f32 v30, v30, v10
    v_sub_f32 v31, v31, v10
    v_mul_f32 v7, v7, v13
    v_sub_f32 v168, v168, v11
    v_sub_f32 v169, v169, v11
    v_sub_f32 v170, v170, v11
    v_sub_f32 v171, v171, v11
    v_sub_f32 v172, v172, v11
    v_sub_f32 v173, v173, v11
    v_sub_f32 v174, v174, v11
    v_sub_f32 v175, v175, v11
    v_sub_f32 v32, v32, v11
    v_sub_f32 v33, v33, v11
    v_sub_f32 v34, v34, v11
    v_sub_f32 v35, v35, v11
    v_mul_f32 v8, v8, v14
    v_sub_f32 v176, v176, v12
    v_sub_f32 v177, v177, v12
    v_sub_f32 v178, v178, v12
    v_sub_f32 v179, v179, v12
    v_sub_f32 v180, v180, v12
    v_sub_f32 v181, v181, v12
    v_sub_f32 v182, v182, v12
    v_sub_f32 v183, v183, v12
    v_sub_f32 v36, v36, v12
    v_sub_f32 v37, v37, v12
    v_sub_f32 v38, v38, v12
    v_sub_f32 v39, v39, v12
    v_mul_f32 v9, v9, v15
    v_accvgpr_read_b32 v76, a32
    v_accvgpr_read_b32 v77, a33
    v_accvgpr_read_b32 v78, a34
    v_accvgpr_read_b32 v79, a35
    v_accvgpr_read_b32 v80, a36
    v_accvgpr_read_b32 v81, a37
    v_accvgpr_read_b32 v82, a38
    v_accvgpr_read_b32 v83, a39
    v_accvgpr_read_b32 v84, a40
    v_accvgpr_read_b32 v85, a41
    v_accvgpr_read_b32 v86, a42
    v_accvgpr_read_b32 v87, a43
    v_mul_f32 v76, v76, v13
    v_mul_f32 v77, v77, v13
    v_mul_f32 v78, v78, v13
    v_mul_f32 v79, v79, v13
    v_mul_f32 v80, v80, v14
    v_mul_f32 v81, v81, v14
    v_mul_f32 v82, v82, v14
    v_mul_f32 v83, v83, v14
    v_mul_f32 v84, v84, v15
    v_mul_f32 v85, v85, v15
    v_mul_f32 v86, v86, v15
    v_mul_f32 v87, v87, v15
    v_accvgpr_write_b32 a32, v76
    v_accvgpr_write_b32 a33, v77
    v_accvgpr_write_b32 a34, v78
    v_accvgpr_write_b32 a35, v79
    v_accvgpr_write_b32 a36, v80
    v_accvgpr_write_b32 a37, v81
    v_accvgpr_write_b32 a38, v82
    v_accvgpr_write_b32 a39, v83
    v_accvgpr_write_b32 a40, v84
    v_accvgpr_write_b32 a41, v85
    v_accvgpr_write_b32 a42, v86
    v_accvgpr_write_b32 a43, v87
    v_accvgpr_read_b32 v76, a44
    v_accvgpr_read_b32 v77, a45
    v_accvgpr_read_b32 v78, a46
    v_accvgpr_read_b32 v79, a47
    v_accvgpr_read_b32 v80, a48
    v_accvgpr_read_b32 v81, a49
    v_accvgpr_read_b32 v82, a50
    v_accvgpr_read_b32 v83, a51
    v_accvgpr_read_b32 v84, a52
    v_accvgpr_read_b32 v85, a53
    v_accvgpr_read_b32 v86, a54
    v_accvgpr_read_b32 v87, a55
    v_mul_f32 v76, v76, v13
    v_mul_f32 v77, v77, v13
    v_mul_f32 v78, v78, v13
    v_mul_f32 v79, v79, v13
    v_mul_f32 v80, v80, v14
    v_mul_f32 v81, v81, v14
    v_mul_f32 v82, v82, v14
    v_mul_f32 v83, v83, v14
    v_mul_f32 v84, v84, v15
    v_mul_f32 v85, v85, v15
    v_mul_f32 v86, v86, v15
    v_mul_f32 v87, v87, v15
    v_accvgpr_write_b32 a44, v76
    v_accvgpr_write_b32 a45, v77
    v_accvgpr_write_b32 a46, v78
    v_accvgpr_write_b32 a47, v79
    v_accvgpr_write_b32 a48, v80
    v_accvgpr_write_b32 a49, v81
    v_accvgpr_write_b32 a50, v82
    v_accvgpr_write_b32 a51, v83
    v_accvgpr_write_b32 a52, v84
    v_accvgpr_write_b32 a53, v85
    v_accvgpr_write_b32 a54, v86
    v_accvgpr_write_b32 a55, v87
    v_accvgpr_read_b32 v76, a56
    v_accvgpr_read_b32 v77, a57
    v_accvgpr_read_b32 v78, a58
    v_accvgpr_read_b32 v79, a59
    v_accvgpr_read_b32 v80, a60
    v_accvgpr_read_b32 v81, a61
    v_accvgpr_read_b32 v82, a62
    v_accvgpr_read_b32 v83, a63
    v_accvgpr_read_b32 v84, a64
    v_accvgpr_read_b32 v85, a65
    v_accvgpr_read_b32 v86, a66
    v_accvgpr_read_b32 v87, a67
    v_mul_f32 v76, v76, v13
    v_mul_f32 v77, v77, v13
    v_mul_f32 v78, v78, v13
    v_mul_f32 v79, v79, v13
    v_mul_f32 v80, v80, v14
    v_mul_f32 v81, v81, v14
    v_mul_f32 v82, v82, v14
    v_mul_f32 v83, v83, v14
    v_mul_f32 v84, v84, v15
    v_mul_f32 v85, v85, v15
    v_mul_f32 v86, v86, v15
    v_mul_f32 v87, v87, v15
    v_accvgpr_write_b32 a56, v76
    v_accvgpr_write_b32 a57, v77
    v_accvgpr_write_b32 a58, v78
    v_accvgpr_write_b32 a59, v79
    v_accvgpr_write_b32 a60, v80
    v_accvgpr_write_b32 a61, v81
    v_accvgpr_write_b32 a62, v82
    v_accvgpr_write_b32 a63, v83
    v_accvgpr_write_b32 a64, v84
    v_accvgpr_write_b32 a65, v85
    v_accvgpr_write_b32 a66, v86
    v_accvgpr_write_b32 a67, v87
    v_accvgpr_read_b32 v76, a68
    v_accvgpr_read_b32 v77, a69
    v_accvgpr_read_b32 v78, a70
    v_accvgpr_read_b32 v79, a71
    v_accvgpr_read_b32 v80, a72
    v_accvgpr_read_b32 v81, a73
    v_accvgpr_read_b32 v82, a74
    v_accvgpr_read_b32 v83, a75
    v_accvgpr_read_b32 v84, a76
    v_accvgpr_read_b32 v85, a77
    v_accvgpr_read_b32 v86, a78
    v_accvgpr_read_b32 v87, a79
    v_mul_f32 v76, v76, v13
    v_mul_f32 v77, v77, v13
    v_mul_f32 v78, v78, v13
    v_mul_f32 v79, v79, v13
    v_mul_f32 v80, v80, v14
    v_mul_f32 v81, v81, v14
    v_mul_f32 v82, v82, v14
    v_mul_f32 v83, v83, v14
    v_mul_f32 v84, v84, v15
    v_mul_f32 v85, v85, v15
    v_mul_f32 v86, v86, v15
    v_mul_f32 v87, v87, v15
    v_accvgpr_write_b32 a68, v76
    v_accvgpr_write_b32 a69, v77
    v_accvgpr_write_b32 a70, v78
    v_accvgpr_write_b32 a71, v79
    v_accvgpr_write_b32 a72, v80
    v_accvgpr_write_b32 a73, v81
    v_accvgpr_write_b32 a74, v82
    v_accvgpr_write_b32 a75, v83
    v_accvgpr_write_b32 a76, v84
    v_accvgpr_write_b32 a77, v85
    v_accvgpr_write_b32 a78, v86
    v_accvgpr_write_b32 a79, v87
    v_accvgpr_read_b32 v76, a80
    v_accvgpr_read_b32 v77, a81
    v_accvgpr_read_b32 v78, a82
    v_accvgpr_read_b32 v79, a83
    v_accvgpr_read_b32 v80, a84
    v_accvgpr_read_b32 v81, a85
    v_accvgpr_read_b32 v82, a86
    v_accvgpr_read_b32 v83, a87
    v_accvgpr_read_b32 v84, a88
    v_accvgpr_read_b32 v85, a89
    v_accvgpr_read_b32 v86, a90
    v_accvgpr_read_b32 v87, a91
    v_mul_f32 v76, v76, v13
    v_mul_f32 v77, v77, v13
    v_mul_f32 v78, v78, v13
    v_mul_f32 v79, v79, v13
    v_mul_f32 v80, v80, v14
    v_mul_f32 v81, v81, v14
    v_mul_f32 v82, v82, v14
    v_mul_f32 v83, v83, v14
    v_mul_f32 v84, v84, v15
    v_mul_f32 v85, v85, v15
    v_mul_f32 v86, v86, v15
    v_mul_f32 v87, v87, v15
    v_accvgpr_write_b32 a80, v76
    v_accvgpr_write_b32 a81, v77
    v_accvgpr_write_b32 a82, v78
    v_accvgpr_write_b32 a83, v79
    v_accvgpr_write_b32 a84, v80
    v_accvgpr_write_b32 a85, v81
    v_accvgpr_write_b32 a86, v82
    v_accvgpr_write_b32 a87, v83
    v_accvgpr_write_b32 a88, v84
    v_accvgpr_write_b32 a89, v85
    v_accvgpr_write_b32 a90, v86
    v_accvgpr_write_b32 a91, v87
    v_accvgpr_read_b32 v76, a92
    v_accvgpr_read_b32 v77, a93
    v_accvgpr_read_b32 v78, a94
    v_accvgpr_read_b32 v79, a95
    v_accvgpr_read_b32 v80, a96
    v_accvgpr_read_b32 v81, a97
    v_accvgpr_read_b32 v82, a98
    v_accvgpr_read_b32 v83, a99
    v_accvgpr_read_b32 v84, a100
    v_accvgpr_read_b32 v85, a101
    v_accvgpr_read_b32 v86, a102
    v_accvgpr_read_b32 v87, a103
    v_mul_f32 v76, v76, v13
    v_mul_f32 v77, v77, v13
    v_mul_f32 v78, v78, v13
    v_mul_f32 v79, v79, v13
    v_mul_f32 v80, v80, v14
    v_mul_f32 v81, v81, v14
    v_mul_f32 v82, v82, v14
    v_mul_f32 v83, v83, v14
    v_mul_f32 v84, v84, v15
    v_mul_f32 v85, v85, v15
    v_mul_f32 v86, v86, v15
    v_mul_f32 v87, v87, v15
    v_accvgpr_write_b32 a92, v76
    v_accvgpr_write_b32 a93, v77
    v_accvgpr_write_b32 a94, v78
    v_accvgpr_write_b32 a95, v79
    v_accvgpr_write_b32 a96, v80
    v_accvgpr_write_b32 a97, v81
    v_accvgpr_write_b32 a98, v82
    v_accvgpr_write_b32 a99, v83
    v_accvgpr_write_b32 a100, v84
    v_accvgpr_write_b32 a101, v85
    v_accvgpr_write_b32 a102, v86
    v_accvgpr_write_b32 a103, v87
    v_accvgpr_read_b32 v76, a104
    v_accvgpr_read_b32 v77, a105
    v_accvgpr_read_b32 v78, a106
    v_accvgpr_read_b32 v79, a107
    v_accvgpr_read_b32 v80, a108
    v_accvgpr_read_b32 v81, a109
    v_accvgpr_read_b32 v82, a110
    v_accvgpr_read_b32 v83, a111
    v_accvgpr_read_b32 v84, a112
    v_accvgpr_read_b32 v85, a113
    v_accvgpr_read_b32 v86, a114
    v_accvgpr_read_b32 v87, a115
    v_mul_f32 v76, v76, v13
    v_mul_f32 v77, v77, v13
    v_mul_f32 v78, v78, v13
    v_mul_f32 v79, v79, v13
    v_mul_f32 v80, v80, v14
    v_mul_f32 v81, v81, v14
    v_mul_f32 v82, v82, v14
    v_mul_f32 v83, v83, v14
    v_mul_f32 v84, v84, v15
    v_mul_f32 v85, v85, v15
    v_mul_f32 v86, v86, v15
    v_mul_f32 v87, v87, v15
    v_accvgpr_write_b32 a104, v76
    v_accvgpr_write_b32 a105, v77
    v_accvgpr_write_b32 a106, v78
    v_accvgpr_write_b32 a107, v79
    v_accvgpr_write_b32 a108, v80
    v_accvgpr_write_b32 a109, v81
    v_accvgpr_write_b32 a110, v82
    v_accvgpr_write_b32 a111, v83
    v_accvgpr_write_b32 a112, v84
    v_accvgpr_write_b32 a113, v85
    v_accvgpr_write_b32 a114, v86
    v_accvgpr_write_b32 a115, v87
    v_accvgpr_read_b32 v76, a116
    v_accvgpr_read_b32 v77, a117
    v_accvgpr_read_b32 v78, a118
    v_accvgpr_read_b32 v79, a119
    v_accvgpr_read_b32 v80, a120
    v_accvgpr_read_b32 v81, a121
    v_accvgpr_read_b32 v82, a122
    v_accvgpr_read_b32 v83, a123
    v_accvgpr_read_b32 v84, a124
    v_accvgpr_read_b32 v85, a125
    v_accvgpr_read_b32 v86, a126
    v_accvgpr_read_b32 v87, a127
    v_mul_f32 v76, v76, v13
    v_mul_f32 v77, v77, v13
    v_mul_f32 v78, v78, v13
    v_mul_f32 v79, v79, v13
    v_mul_f32 v80, v80, v14
    v_mul_f32 v81, v81, v14
    v_mul_f32 v82, v82, v14
    v_mul_f32 v83, v83, v14
    v_mul_f32 v84, v84, v15
    v_mul_f32 v85, v85, v15
    v_mul_f32 v86, v86, v15
    v_mul_f32 v87, v87, v15
    v_accvgpr_write_b32 a116, v76
    v_accvgpr_write_b32 a117, v77
    v_accvgpr_write_b32 a118, v78
    v_accvgpr_write_b32 a119, v79
    v_accvgpr_write_b32 a120, v80
    v_accvgpr_write_b32 a121, v81
    v_accvgpr_write_b32 a122, v82
    v_accvgpr_write_b32 a123, v83
    v_accvgpr_write_b32 a124, v84
    v_accvgpr_write_b32 a125, v85
    v_accvgpr_write_b32 a126, v86
    v_accvgpr_write_b32 a127, v87
    v_accvgpr_read_b32 v76, a128
    v_accvgpr_read_b32 v77, a129
    v_accvgpr_read_b32 v78, a130
    v_accvgpr_read_b32 v79, a131
    v_accvgpr_read_b32 v80, a132
    v_accvgpr_read_b32 v81, a133
    v_accvgpr_read_b32 v82, a134
    v_accvgpr_read_b32 v83, a135
    v_accvgpr_read_b32 v84, a136
    v_accvgpr_read_b32 v85, a137
    v_accvgpr_read_b32 v86, a138
    v_accvgpr_read_b32 v87, a139
    v_mul_f32 v76, v76, v13
    v_mul_f32 v77, v77, v13
    v_mul_f32 v78, v78, v13
    v_mul_f32 v79, v79, v13
    v_mul_f32 v80, v80, v14
    v_mul_f32 v81, v81, v14
    v_mul_f32 v82, v82, v14
    v_mul_f32 v83, v83, v14
    v_mul_f32 v84, v84, v15
    v_mul_f32 v85, v85, v15
    v_mul_f32 v86, v86, v15
    v_mul_f32 v87, v87, v15
    v_accvgpr_write_b32 a128, v76
    v_accvgpr_write_b32 a129, v77
    v_accvgpr_write_b32 a130, v78
    v_accvgpr_write_b32 a131, v79
    v_accvgpr_write_b32 a132, v80
    v_accvgpr_write_b32 a133, v81
    v_accvgpr_write_b32 a134, v82
    v_accvgpr_write_b32 a135, v83
    v_accvgpr_write_b32 a136, v84
    v_accvgpr_write_b32 a137, v85
    v_accvgpr_write_b32 a138, v86
    v_accvgpr_write_b32 a139, v87
    v_accvgpr_read_b32 v76, a140
    v_accvgpr_read_b32 v77, a141
    v_accvgpr_read_b32 v78, a142
    v_accvgpr_read_b32 v79, a143
    v_accvgpr_read_b32 v80, a144
    v_accvgpr_read_b32 v81, a145
    v_accvgpr_read_b32 v82, a146
    v_accvgpr_read_b32 v83, a147
    v_accvgpr_read_b32 v84, a148
    v_accvgpr_read_b32 v85, a149
    v_accvgpr_read_b32 v86, a150
    v_accvgpr_read_b32 v87, a151
    v_mul_f32 v76, v76, v13
    v_mul_f32 v77, v77, v13
    v_mul_f32 v78, v78, v13
    v_mul_f32 v79, v79, v13
    v_mul_f32 v80, v80, v14
    v_mul_f32 v81, v81, v14
    v_mul_f32 v82, v82, v14
    v_mul_f32 v83, v83, v14
    v_mul_f32 v84, v84, v15
    v_mul_f32 v85, v85, v15
    v_mul_f32 v86, v86, v15
    v_mul_f32 v87, v87, v15
    v_accvgpr_write_b32 a140, v76
    v_accvgpr_write_b32 a141, v77
    v_accvgpr_write_b32 a142, v78
    v_accvgpr_write_b32 a143, v79
    v_accvgpr_write_b32 a144, v80
    v_accvgpr_write_b32 a145, v81
    v_accvgpr_write_b32 a146, v82
    v_accvgpr_write_b32 a147, v83
    v_accvgpr_write_b32 a148, v84
    v_accvgpr_write_b32 a149, v85
    v_accvgpr_write_b32 a150, v86
    v_accvgpr_write_b32 a151, v87
    v_accvgpr_read_b32 v76, a152
    v_accvgpr_read_b32 v77, a153
    v_accvgpr_read_b32 v78, a154
    v_accvgpr_read_b32 v79, a155
    v_accvgpr_read_b32 v80, a156
    v_accvgpr_read_b32 v81, a157
    v_accvgpr_read_b32 v82, a158
    v_accvgpr_read_b32 v83, a159
    v_accvgpr_read_b32 v84, a160
    v_accvgpr_read_b32 v85, a161
    v_accvgpr_read_b32 v86, a162
    v_accvgpr_read_b32 v87, a163
    v_mul_f32 v76, v76, v13
    v_mul_f32 v77, v77, v13
    v_mul_f32 v78, v78, v13
    v_mul_f32 v79, v79, v13
    v_mul_f32 v80, v80, v14
    v_mul_f32 v81, v81, v14
    v_mul_f32 v82, v82, v14
    v_mul_f32 v83, v83, v14
    v_mul_f32 v84, v84, v15
    v_mul_f32 v85, v85, v15
    v_mul_f32 v86, v86, v15
    v_mul_f32 v87, v87, v15
    v_accvgpr_write_b32 a152, v76
    v_accvgpr_write_b32 a153, v77
    v_accvgpr_write_b32 a154, v78
    v_accvgpr_write_b32 a155, v79
    v_accvgpr_write_b32 a156, v80
    v_accvgpr_write_b32 a157, v81
    v_accvgpr_write_b32 a158, v82
    v_accvgpr_write_b32 a159, v83
    v_accvgpr_write_b32 a160, v84
    v_accvgpr_write_b32 a161, v85
    v_accvgpr_write_b32 a162, v86
    v_accvgpr_write_b32 a163, v87
    v_accvgpr_read_b32 v76, a164
    v_accvgpr_read_b32 v77, a165
    v_accvgpr_read_b32 v78, a166
    v_accvgpr_read_b32 v79, a167
    v_accvgpr_read_b32 v80, a168
    v_accvgpr_read_b32 v81, a169
    v_accvgpr_read_b32 v82, a170
    v_accvgpr_read_b32 v83, a171
    v_accvgpr_read_b32 v84, a172
    v_accvgpr_read_b32 v85, a173
    v_accvgpr_read_b32 v86, a174
    v_accvgpr_read_b32 v87, a175
    v_mul_f32 v76, v76, v13
    v_mul_f32 v77, v77, v13
    v_mul_f32 v78, v78, v13
    v_mul_f32 v79, v79, v13
    v_mul_f32 v80, v80, v14
    v_mul_f32 v81, v81, v14
    v_mul_f32 v82, v82, v14
    v_mul_f32 v83, v83, v14
    v_mul_f32 v84, v84, v15
    v_mul_f32 v85, v85, v15
    v_mul_f32 v86, v86, v15
    v_mul_f32 v87, v87, v15
    v_accvgpr_write_b32 a164, v76
    v_accvgpr_write_b32 a165, v77
    v_accvgpr_write_b32 a166, v78
    v_accvgpr_write_b32 a167, v79
    v_accvgpr_write_b32 a168, v80
    v_accvgpr_write_b32 a169, v81
    v_accvgpr_write_b32 a170, v82
    v_accvgpr_write_b32 a171, v83
    v_accvgpr_write_b32 a172, v84
    v_accvgpr_write_b32 a173, v85
    v_accvgpr_write_b32 a174, v86
    v_accvgpr_write_b32 a175, v87
L_safe_skip_b:
    s_nop 1
    s_sub_u32 s41, s41, 1
    s_cmp_lg_u32 s41, 0
    s_cbranch_scc1 L_safe_loop
    s_waitcnt lgkmcnt(4)
    v_mfma_f32_16x16x32_bf16 v[184:187], a[0:3], v[16:19], v[28:31]
    ds_read_b128 a[24:27], v2 offset:128
    v_mfma_f32_16x16x32_bf16 v[188:191], a[4:7], v[16:19], v[28:31]
    s_add_u32 m0, s42, 24576
    v_exp_f32 v160, v160
    v_mfma_f32_16x16x32_bf16 v[196:199], a[4:7], v[20:23], v[32:35]
    buffer_load_dwordx4 v244, s[12:15], s38 offen offset:0 nt lds
    v_add_f32 v7, v7, v160
    v_mfma_f32_16x16x32_bf16 v[192:195], a[0:3], v[20:23], v[32:35]
    ds_read_b128 a[28:31], v2 offset:6272
    v_exp_f32 v161, v161
    v_mfma_f32_16x16x32_bf16 v[200:203], a[0:3], v[24:27], v[36:39]
    v_exp_f32 v162, v162
    v_mfma_f32_16x16x32_bf16 v[204:207], a[4:7], v[24:27], v[36:39]
    v_cvt_pk_bf16_f32 v52, v160, v161
    s_waitcnt lgkmcnt(4)
    v_mfma_f32_16x16x32_bf16 v[184:187], a[8:11], v[40:43], v[184:187]
    ds_read_b128 a[0:3], v1 offset:256
    v_exp_f32 v163, v163
    v_mfma_f32_16x16x32_bf16 v[188:191], a[12:15], v[40:43], v[188:191]
    v_exp_f32 v164, v164
    v_mfma_f32_16x16x32_bf16 v[196:199], a[12:15], v[44:47], v[196:199]
    v_exp_f32 v165, v165
    v_cvt_pk_bf16_f32 v53, v162, v163
    v_mfma_f32_16x16x32_bf16 v[192:195], a[8:11], v[44:47], v[192:195]
    ds_read_b128 a[4:7], v1 offset:6400
    v_exp_f32 v166, v166
    v_mfma_f32_16x16x32_bf16 v[200:203], a[8:11], v[48:51], v[200:203]
    buffer_load_dwordx4 v245, s[12:15], s38 offen offset:1024 nt lds
    v_cvt_pk_bf16_f32 v54, v164, v165
    v_mfma_f32_16x16x32_bf16 v[204:207], a[12:15], v[48:51], v[204:207]
    v_exp_f32 v167, v167
    s_waitcnt lgkmcnt(4)
    v_mfma_f32_16x16x32_bf16 v[184:187], a[16:19], v[64:67], v[184:187]
    ds_read_b128 a[8:11], v2 offset:256
    v_exp_f32 v168, v168
    v_mfma_f32_16x16x32_bf16 v[188:191], a[20:23], v[64:67], v[188:191]
    v_exp_f32 v169, v169
    v_mfma_f32_16x16x32_bf16 v[196:199], a[20:23], v[68:71], v[196:199]
    v_exp_f32 v170, v170
    v_cvt_pk_bf16_f32 v55, v166, v167
    v_mfma_f32_16x16x32_bf16 v[192:195], a[16:19], v[68:71], v[192:195]
    ds_read_b128 a[12:15], v2 offset:6400
    v_exp_f32 v171, v171
    v_mfma_f32_16x16x32_bf16 v[200:203], a[16:19], v[72:75], v[200:203]
    v_exp_f32 v172, v172
    v_mfma_f32_16x16x32_bf16 v[204:207], a[20:23], v[72:75], v[204:207]
    v_cvt_pk_bf16_f32 v56, v168, v169
    s_waitcnt lgkmcnt(4)
    v_mfma_f32_16x16x32_bf16 v[184:187], a[24:27], v[88:91], v[184:187]
    ds_read_b64_tr_b16 a[16:17], v3 offset:0
    buffer_load_dwordx4 v246, s[12:15], s38 offen offset:2048 nt lds
    v_mfma_f32_16x16x32_bf16 v[188:191], a[28:31], v[88:91], v[188:191]
    v_exp_f32 v173, v173
    v_cvt_pk_bf16_f32 v57, v170, v171
    v_mfma_f32_16x16x32_bf16 v[196:199], a[28:31], v[92:95], v[196:199]
    ds_read_b64_tr_b16 a[18:19], v3 offset:6144
    v_exp_f32 v174, v174
    v_mfma_f32_16x16x32_bf16 v[192:195], a[24:27], v[92:95], v[192:195]
    ds_read_b64_tr_b16 a[20:21], v4 offset:0
    v_exp_f32 v175, v175
    v_mfma_f32_16x16x32_bf16 v[200:203], a[24:27], v[96:99], v[200:203]
    v_exp_f32 v176, v176
    v_mfma_f32_16x16x32_bf16 v[204:207], a[28:31], v[96:99], v[204:207]
    ds_read_b64_tr_b16 a[22:23], v4 offset:6144
    s_waitcnt lgkmcnt(6)
    v_mfma_f32_16x16x32_bf16 v[184:187], a[0:3], v[112:115], v[184:187]
    ds_read_b64_tr_b16 a[24:25], v5 offset:0
    v_exp_f32 v177, v177
    v_mfma_f32_16x16x32_bf16 v[188:191], a[4:7], v[112:115], v[188:191]
    v_exp_f32 v178, v178
    v_mfma_f32_16x16x32_bf16 v[196:199], a[4:7], v[116:119], v[196:199]
    ds_read_b64_tr_b16 a[26:27], v5 offset:6144
    buffer_load_dwordx4 v247, s[12:15], s38 offen offset:3072 nt lds
    v_cvt_pk_bf16_f32 v58, v172, v173
    v_mfma_f32_16x16x32_bf16 v[192:195], a[0:3], v[116:119], v[192:195]
    ds_read_b64_tr_b16 a[28:29], v6 offset:0
    v_exp_f32 v179, v179
    v_mfma_f32_16x16x32_bf16 v[200:203], a[0:3], v[120:123], v[200:203]
    v_exp_f32 v180, v180
    v_mfma_f32_16x16x32_bf16 v[204:207], a[4:7], v[120:123], v[204:207]
    ds_read_b64_tr_b16 a[30:31], v6 offset:6144
    s_waitcnt lgkmcnt(8)
    v_mfma_f32_16x16x32_bf16 v[184:187], a[8:11], v[136:139], v[184:187]
    ds_read_b64_tr_b16 a[0:1], v3 offset:128
    v_exp_f32 v181, v181
    v_mfma_f32_16x16x32_bf16 v[188:191], a[12:15], v[136:139], v[188:191]
    v_exp_f32 v182, v182
    v_cvt_pk_bf16_f32 v59, v174, v175
    v_mfma_f32_16x16x32_bf16 v[196:199], a[12:15], v[140:143], v[196:199]
    ds_read_b64_tr_b16 a[2:3], v3 offset:6272
    v_exp_f32 v183, v183
    v_mfma_f32_16x16x32_bf16 v[192:195], a[8:11], v[140:143], v[192:195]
    ds_read_b64_tr_b16 a[4:5], v4 offset:128
    s_add_u32 m0, s42, 28672
    v_mfma_f32_16x16x32_bf16 v[200:203], a[8:11], v[144:147], v[200:203]
    buffer_load_dwordx4 v248, s[12:15], s38 offen offset:0 nt lds
    v_cvt_pk_bf16_f32 v60, v176, v177
    v_cvt_pk_bf16_f32 v61, v178, v179
    v_cvt_pk_bf16_f32 v62, v180, v181
    v_cvt_pk_bf16_f32 v63, v182, v183
    v_mfma_f32_16x16x32_bf16 v[204:207], a[12:15], v[144:147], v[204:207]
    ds_read_b64_tr_b16 a[6:7], v4 offset:6272
    s_waitcnt lgkmcnt(8)
    v_mfma_f32_16x16x32_bf16 a[32:35], a[16:19], v[52:55], a[32:35]
    ds_read_b64_tr_b16 a[8:9], v5 offset:128
    v_add_f32 v7, v7, v161
    v_mfma_f32_16x16x32_bf16 a[44:47], a[20:23], v[52:55], a[44:47]
    v_add_f32 v7, v7, v162
    v_mfma_f32_16x16x32_bf16 a[48:51], a[20:23], v[56:59], a[48:51]
    ds_read_b64_tr_b16 a[10:11], v5 offset:6272
    v_add_f32 v7, v7, v163
    v_mfma_f32_16x16x32_bf16 a[36:39], a[16:19], v[56:59], a[36:39]
    ds_read_b64_tr_b16 a[12:13], v6 offset:128
    v_mov_b32 v100, 98304
    v_mfma_f32_16x16x32_bf16 a[40:43], a[16:19], v[60:63], a[40:43]
    v_add_f32 v7, v7, v164
    v_mfma_f32_16x16x32_bf16 a[52:55], a[20:23], v[60:63], a[52:55]
    ds_read_b64_tr_b16 a[14:15], v6 offset:6272
    s_waitcnt lgkmcnt(8)
    v_mfma_f32_16x16x32_bf16 a[64:67], a[24:27], v[60:63], a[64:67]
    ds_read_b64_tr_b16 a[16:17], v3 offset:256
    buffer_load_dwordx4 v249, s[12:15], s38 offen offset:1024 nt lds
    v_mfma_f32_16x16x32_bf16 a[76:79], a[28:31], v[60:63], a[76:79]
    s_add_u32 s38, s38, 12288
    v_add_f32 v7, v7, v165
    v_mfma_f32_16x16x32_bf16 a[72:75], a[28:31], v[56:59], a[72:75]
    ds_read_b64_tr_b16 a[18:19], v3 offset:6400
    s_bfe_u32 s48, s50, 0x50000
    v_mfma_f32_16x16x32_bf16 a[60:63], a[24:27], v[56:59], a[60:63]
    ds_read_b64_tr_b16 a[20:21], v4 offset:256
    s_add_u32 s48, s48, s51
    v_mfma_f32_16x16x32_bf16 a[56:59], a[24:27], v[52:55], a[56:59]
    s_cmp_ge_u32 s48, 24
    s_cselect_b32 s52, 24, 0
    v_add_f32 v7, v7, v166
    v_mfma_f32_16x16x32_bf16 a[68:71], a[28:31], v[52:55], a[68:71]
    ds_read_b64_tr_b16 a[22:23], v4 offset:6400
    s_sub_u32 s48, s48, s52
    s_waitcnt lgkmcnt(8)
    v_mfma_f32_16x16x32_bf16 a[80:83], a[0:3], v[52:55], a[80:83]
    ds_read_b64_tr_b16 a[24:25], v5 offset:256
    s_mul_i32 s48, s48, 40960
    v_mfma_f32_16x16x32_bf16 a[92:95], a[4:7], v[52:55], a[92:95]
    s_add_u32 m0, s49, 122880
    v_mfma_f32_16x16x32_bf16 a[96:99], a[4:7], v[56:59], a[96:99]
    ds_read_b64_tr_b16 a[26:27], v5 offset:6400
    buffer_load_dwordx4 v232, s[16:19], s48 offen offset:0 lds
    v_mfma_f32_16x16x32_bf16 a[84:87], a[0:3], v[56:59], a[84:87]
    ds_read_b64_tr_b16 a[28:29], v6 offset:256
    v_add_f32 v7, v7, v167
    v_mfma_f32_16x16x32_bf16 a[88:91], a[0:3], v[60:63], a[88:91]
    v_add_f32 v8, v8, v168
    v_mfma_f32_16x16x32_bf16 a[100:103], a[4:7], v[60:63], a[100:103]
    ds_read_b64_tr_b16 a[30:31], v6 offset:6400
    s_waitcnt lgkmcnt(8)
    v_mfma_f32_16x16x32_bf16 a[112:115], a[8:11], v[60:63], a[112:115]
    ds_read_b128 a[0:3], v1 offset:24576
    v_add_f32 v8, v8, v169
    v_mfma_f32_16x16x32_bf16 a[124:127], a[12:15], v[60:63], a[124:127]
    v_add_f32 v8, v8, v170
    v_mfma_f32_16x16x32_bf16 a[120:123], a[12:15], v[56:59], a[120:123]
    v_add_f32 v8, v8, v171
    v_mfma_f32_16x16x32_bf16 a[108:111], a[8:11], v[56:59], a[108:111]
    ds_read_b128 a[4:7], v1 offset:30720
    v_add_f32 v8, v8, v172
    v_mfma_f32_16x16x32_bf16 a[104:107], a[8:11], v[52:55], a[104:107]
    buffer_load_dwordx4 v233, s[16:19], s48 offen offset:1024 lds
    v_mov_b32 v101, 0
    v_mfma_f32_16x16x32_bf16 a[116:119], a[12:15], v[52:55], a[116:119]
    v_add_f32 v8, v8, v173
    s_waitcnt lgkmcnt(6)
    v_mfma_f32_16x16x32_bf16 a[128:131], a[16:19], v[52:55], a[128:131]
    ds_read_b128 a[8:11], v2 offset:24576
    v_mfma_f32_16x16x32_bf16 a[140:143], a[20:23], v[52:55], a[140:143]
    v_add_f32 v8, v8, v174
    v_add_f32 v8, v8, v175
    v_mfma_f32_16x16x32_bf16 a[144:147], a[20:23], v[56:59], a[144:147]
    v_add_f32 v9, v9, v176
    v_mfma_f32_16x16x32_bf16 a[132:135], a[16:19], v[56:59], a[132:135]
    ds_read_b128 a[12:15], v2 offset:30720
    v_mfma_f32_16x16x32_bf16 a[136:139], a[16:19], v[60:63], a[136:139]
    v_add_f32 v9, v9, v177
    v_add_f32 v9, v9, v178
    v_mfma_f32_16x16x32_bf16 a[148:151], a[20:23], v[60:63], a[148:151]
    s_waitcnt lgkmcnt(4)
    v_mfma_f32_16x16x32_bf16 a[160:163], a[24:27], v[60:63], a[160:163]
    ds_read_b128 a[16:19], v1 offset:24704
    buffer_load_dwordx4 v234, s[16:19], s48 offen offset:2048 lds
    v_mfma_f32_16x16x32_bf16 a[172:175], a[28:31], v[60:63], a[172:175]
    v_add_f32 v9, v9, v179
    ds_write_b32 v100, v101
    v_mfma_f32_16x16x32_bf16 a[168:171], a[28:31], v[56:59], a[168:171]
    v_add_f32 v9, v9, v180
    v_add_f32 v9, v9, v181
    v_mfma_f32_16x16x32_bf16 a[156:159], a[24:27], v[56:59], a[156:159]
    ds_read_b128 a[20:23], v1 offset:30848
    v_mfma_f32_16x16x32_bf16 a[152:155], a[24:27], v[52:55], a[152:155]
    v_add_f32 v9, v9, v182
    v_mfma_f32_16x16x32_bf16 a[164:167], a[28:31], v[52:55], a[164:167]
    v_add_f32 v9, v9, v183
    v_max3_f32 v10, v184, v185, v186
    v_max3_f32 v10, v10, v187, v188
    v_max3_f32 v10, v10, v189, v190
    v_max_f32 v10, v10, v191
    v_max3_f32 v11, v192, v193, v194
    v_max3_f32 v11, v11, v195, v196
    v_max3_f32 v11, v11, v197, v198
    v_max_f32 v11, v11, v199
    v_max3_f32 v12, v200, v201, v202
    v_max3_f32 v12, v12, v203, v204
    v_max3_f32 v12, v12, v205, v206
    v_max_f32 v12, v12, v207
    v_max3_f32 v13, v10, v11, v12
    v_cmp_lt_f32 vcc, 0, v13
    s_nop 0
    s_cbranch_vccz L_safe_skip_c
    v_mov_b32 v13, v10
    v_mov_b32 v14, v11
    v_mov_b32 v15, v12
    v_permlane32_swap_b32 v10, v13
    v_permlane32_swap_b32 v11, v14
    v_permlane32_swap_b32 v12, v15
    v_max_f32 v10, v10, v13
    v_max_f32 v11, v11, v14
    v_max_f32 v12, v12, v15
    v_mov_b32 v13, v10
    v_mov_b32 v14, v11
    v_mov_b32 v15, v12
    v_permlane16_swap_b32 v10, v13
    v_permlane16_swap_b32 v11, v14
    v_permlane16_swap_b32 v12, v15
    v_max_f32 v10, v10, v13
    v_max_f32 v11, v11, v14
    v_max_f32 v12, v12, v15
    v_max_f32 v10, 0, v10
    v_max_f32 v11, 0, v11
    v_max_f32 v12, 0, v12
    v_sub_f32 v13, 0, v10
    v_sub_f32 v14, 0, v11
    v_sub_f32 v15, 0, v12
    v_exp_f32 v13, v13
    v_exp_f32 v14, v14
    v_exp_f32 v15, v15
    v_sub_f32 v184, v184, v10
    v_sub_f32 v185, v185, v10
    v_sub_f32 v186, v186, v10
    v_sub_f32 v187, v187, v10
    v_sub_f32 v188, v188, v10
    v_sub_f32 v189, v189, v10
    v_sub_f32 v190, v190, v10
    v_sub_f32 v191, v191, v10
    v_sub_f32 v28, v28, v10
    v_sub_f32 v29, v29, v10
    v_sub_f32 v30, v30, v10
    v_sub_f32 v31, v31, v10
    v_mul_f32 v7, v7, v13
    v_sub_f32 v192, v192, v11
    v_sub_f32 v193, v193, v11
    v_sub_f32 v194, v194, v11
    v_sub_f32 v195, v195, v11
    v_sub_f32 v196, v196, v11
    v_sub_f32 v197, v197, v11
    v_sub_f32 v198, v198, v11
    v_sub_f32 v199, v199, v11
    v_sub_f32 v32, v32, v11
    v_sub_f32 v33, v33, v11
    v_sub_f32 v34, v34, v11
    v_sub_f32 v35, v35, v11
    v_mul_f32 v8, v8, v14
    v_sub_f32 v200, v200, v12
    v_sub_f32 v201, v201, v12
    v_sub_f32 v202, v202, v12
    v_sub_f32 v203, v203, v12
    v_sub_f32 v204, v204, v12
    v_sub_f32 v205, v205, v12
    v_sub_f32 v206, v206, v12
    v_sub_f32 v207, v207, v12
    v_sub_f32 v36, v36, v12
    v_sub_f32 v37, v37, v12
    v_sub_f32 v38, v38, v12
    v_sub_f32 v39, v39, v12
    v_mul_f32 v9, v9, v15
    v_accvgpr_read_b32 v76, a32
    v_accvgpr_read_b32 v77, a33
    v_accvgpr_read_b32 v78, a34
    v_accvgpr_read_b32 v79, a35
    v_accvgpr_read_b32 v80, a36
    v_accvgpr_read_b32 v81, a37
    v_accvgpr_read_b32 v82, a38
    v_accvgpr_read_b32 v83, a39
    v_accvgpr_read_b32 v84, a40
    v_accvgpr_read_b32 v85, a41
    v_accvgpr_read_b32 v86, a42
    v_accvgpr_read_b32 v87, a43
    v_mul_f32 v76, v76, v13
    v_mul_f32 v77, v77, v13
    v_mul_f32 v78, v78, v13
    v_mul_f32 v79, v79, v13
    v_mul_f32 v80, v80, v14
    v_mul_f32 v81, v81, v14
    v_mul_f32 v82, v82, v14
    v_mul_f32 v83, v83, v14
    v_mul_f32 v84, v84, v15
    v_mul_f32 v85, v85, v15
    v_mul_f32 v86, v86, v15
    v_mul_f32 v87, v87, v15
    v_accvgpr_write_b32 a32, v76
    v_accvgpr_write_b32 a33, v77
    v_accvgpr_write_b32 a34, v78
    v_accvgpr_write_b32 a35, v79
    v_accvgpr_write_b32 a36, v80
    v_accvgpr_write_b32 a37, v81
    v_accvgpr_write_b32 a38, v82
    v_accvgpr_write_b32 a39, v83
    v_accvgpr_write_b32 a40, v84
    v_accvgpr_write_b32 a41, v85
    v_accvgpr_write_b32 a42, v86
    v_accvgpr_write_b32 a43, v87
    v_accvgpr_read_b32 v76, a44
    v_accvgpr_read_b32 v77, a45
    v_accvgpr_read_b32 v78, a46
    v_accvgpr_read_b32 v79, a47
    v_accvgpr_read_b32 v80, a48
    v_accvgpr_read_b32 v81, a49
    v_accvgpr_read_b32 v82, a50
    v_accvgpr_read_b32 v83, a51
    v_accvgpr_read_b32 v84, a52
    v_accvgpr_read_b32 v85, a53
    v_accvgpr_read_b32 v86, a54
    v_accvgpr_read_b32 v87, a55
    v_mul_f32 v76, v76, v13
    v_mul_f32 v77, v77, v13
    v_mul_f32 v78, v78, v13
    v_mul_f32 v79, v79, v13
    v_mul_f32 v80, v80, v14
    v_mul_f32 v81, v81, v14
    v_mul_f32 v82, v82, v14
    v_mul_f32 v83, v83, v14
    v_mul_f32 v84, v84, v15
    v_mul_f32 v85, v85, v15
    v_mul_f32 v86, v86, v15
    v_mul_f32 v87, v87, v15
    v_accvgpr_write_b32 a44, v76
    v_accvgpr_write_b32 a45, v77
    v_accvgpr_write_b32 a46, v78
    v_accvgpr_write_b32 a47, v79
    v_accvgpr_write_b32 a48, v80
    v_accvgpr_write_b32 a49, v81
    v_accvgpr_write_b32 a50, v82
    v_accvgpr_write_b32 a51, v83
    v_accvgpr_write_b32 a52, v84
    v_accvgpr_write_b32 a53, v85
    v_accvgpr_write_b32 a54, v86
    v_accvgpr_write_b32 a55, v87
    v_accvgpr_read_b32 v76, a56
    v_accvgpr_read_b32 v77, a57
    v_accvgpr_read_b32 v78, a58
    v_accvgpr_read_b32 v79, a59
    v_accvgpr_read_b32 v80, a60
    v_accvgpr_read_b32 v81, a61
    v_accvgpr_read_b32 v82, a62
    v_accvgpr_read_b32 v83, a63
    v_accvgpr_read_b32 v84, a64
    v_accvgpr_read_b32 v85, a65
    v_accvgpr_read_b32 v86, a66
    v_accvgpr_read_b32 v87, a67
    v_mul_f32 v76, v76, v13
    v_mul_f32 v77, v77, v13
    v_mul_f32 v78, v78, v13
    v_mul_f32 v79, v79, v13
    v_mul_f32 v80, v80, v14
    v_mul_f32 v81, v81, v14
    v_mul_f32 v82, v82, v14
    v_mul_f32 v83, v83, v14
    v_mul_f32 v84, v84, v15
    v_mul_f32 v85, v85, v15
    v_mul_f32 v86, v86, v15
    v_mul_f32 v87, v87, v15
    v_accvgpr_write_b32 a56, v76
    v_accvgpr_write_b32 a57, v77
    v_accvgpr_write_b32 a58, v78
    v_accvgpr_write_b32 a59, v79
    v_accvgpr_write_b32 a60, v80
    v_accvgpr_write_b32 a61, v81
    v_accvgpr_write_b32 a62, v82
    v_accvgpr_write_b32 a63, v83
    v_accvgpr_write_b32 a64, v84
    v_accvgpr_write_b32 a65, v85
    v_accvgpr_write_b32 a66, v86
    v_accvgpr_write_b32 a67, v87
    v_accvgpr_read_b32 v76, a68
    v_accvgpr_read_b32 v77, a69
    v_accvgpr_read_b32 v78, a70
    v_accvgpr_read_b32 v79, a71
    v_accvgpr_read_b32 v80, a72
    v_accvgpr_read_b32 v81, a73
    v_accvgpr_read_b32 v82, a74
    v_accvgpr_read_b32 v83, a75
    v_accvgpr_read_b32 v84, a76
    v_accvgpr_read_b32 v85, a77
    v_accvgpr_read_b32 v86, a78
    v_accvgpr_read_b32 v87, a79
    v_mul_f32 v76, v76, v13
    v_mul_f32 v77, v77, v13
    v_mul_f32 v78, v78, v13
    v_mul_f32 v79, v79, v13
    v_mul_f32 v80, v80, v14
    v_mul_f32 v81, v81, v14
    v_mul_f32 v82, v82, v14
    v_mul_f32 v83, v83, v14
    v_mul_f32 v84, v84, v15
    v_mul_f32 v85, v85, v15
    v_mul_f32 v86, v86, v15
    v_mul_f32 v87, v87, v15
    v_accvgpr_write_b32 a68, v76
    v_accvgpr_write_b32 a69, v77
    v_accvgpr_write_b32 a70, v78
    v_accvgpr_write_b32 a71, v79
    v_accvgpr_write_b32 a72, v80
    v_accvgpr_write_b32 a73, v81
    v_accvgpr_write_b32 a74, v82
    v_accvgpr_write_b32 a75, v83
    v_accvgpr_write_b32 a76, v84
    v_accvgpr_write_b32 a77, v85
    v_accvgpr_write_b32 a78, v86
    v_accvgpr_write_b32 a79, v87
    v_accvgpr_read_b32 v76, a80
    v_accvgpr_read_b32 v77, a81
    v_accvgpr_read_b32 v78, a82
    v_accvgpr_read_b32 v79, a83
    v_accvgpr_read_b32 v80, a84
    v_accvgpr_read_b32 v81, a85
    v_accvgpr_read_b32 v82, a86
    v_accvgpr_read_b32 v83, a87
    v_accvgpr_read_b32 v84, a88
    v_accvgpr_read_b32 v85, a89
    v_accvgpr_read_b32 v86, a90
    v_accvgpr_read_b32 v87, a91
    v_mul_f32 v76, v76, v13
    v_mul_f32 v77, v77, v13
    v_mul_f32 v78, v78, v13
    v_mul_f32 v79, v79, v13
    v_mul_f32 v80, v80, v14
    v_mul_f32 v81, v81, v14
    v_mul_f32 v82, v82, v14
    v_mul_f32 v83, v83, v14
    v_mul_f32 v84, v84, v15
    v_mul_f32 v85, v85, v15
    v_mul_f32 v86, v86, v15
    v_mul_f32 v87, v87, v15
    v_accvgpr_write_b32 a80, v76
    v_accvgpr_write_b32 a81, v77
    v_accvgpr_write_b32 a82, v78
    v_accvgpr_write_b32 a83, v79
    v_accvgpr_write_b32 a84, v80
    v_accvgpr_write_b32 a85, v81
    v_accvgpr_write_b32 a86, v82
    v_accvgpr_write_b32 a87, v83
    v_accvgpr_write_b32 a88, v84
    v_accvgpr_write_b32 a89, v85
    v_accvgpr_write_b32 a90, v86
    v_accvgpr_write_b32 a91, v87
    v_accvgpr_read_b32 v76, a92
    v_accvgpr_read_b32 v77, a93
    v_accvgpr_read_b32 v78, a94
    v_accvgpr_read_b32 v79, a95
    v_accvgpr_read_b32 v80, a96
    v_accvgpr_read_b32 v81, a97
    v_accvgpr_read_b32 v82, a98
    v_accvgpr_read_b32 v83, a99
    v_accvgpr_read_b32 v84, a100
    v_accvgpr_read_b32 v85, a101
    v_accvgpr_read_b32 v86, a102
    v_accvgpr_read_b32 v87, a103
    v_mul_f32 v76, v76, v13
    v_mul_f32 v77, v77, v13
    v_mul_f32 v78, v78, v13
    v_mul_f32 v79, v79, v13
    v_mul_f32 v80, v80, v14
    v_mul_f32 v81, v81, v14
    v_mul_f32 v82, v82, v14
    v_mul_f32 v83, v83, v14
    v_mul_f32 v84, v84, v15
    v_mul_f32 v85, v85, v15
    v_mul_f32 v86, v86, v15
    v_mul_f32 v87, v87, v15
    v_accvgpr_write_b32 a92, v76
    v_accvgpr_write_b32 a93, v77
    v_accvgpr_write_b32 a94, v78
    v_accvgpr_write_b32 a95, v79
    v_accvgpr_write_b32 a96, v80
    v_accvgpr_write_b32 a97, v81
    v_accvgpr_write_b32 a98, v82
    v_accvgpr_write_b32 a99, v83
    v_accvgpr_write_b32 a100, v84
    v_accvgpr_write_b32 a101, v85
    v_accvgpr_write_b32 a102, v86
    v_accvgpr_write_b32 a103, v87
    v_accvgpr_read_b32 v76, a104
    v_accvgpr_read_b32 v77, a105
    v_accvgpr_read_b32 v78, a106
    v_accvgpr_read_b32 v79, a107
    v_accvgpr_read_b32 v80, a108
    v_accvgpr_read_b32 v81, a109
    v_accvgpr_read_b32 v82, a110
    v_accvgpr_read_b32 v83, a111
    v_accvgpr_read_b32 v84, a112
    v_accvgpr_read_b32 v85, a113
    v_accvgpr_read_b32 v86, a114
    v_accvgpr_read_b32 v87, a115
    v_mul_f32 v76, v76, v13
    v_mul_f32 v77, v77, v13
    v_mul_f32 v78, v78, v13
    v_mul_f32 v79, v79, v13
    v_mul_f32 v80, v80, v14
    v_mul_f32 v81, v81, v14
    v_mul_f32 v82, v82, v14
    v_mul_f32 v83, v83, v14
    v_mul_f32 v84, v84, v15
    v_mul_f32 v85, v85, v15
    v_mul_f32 v86, v86, v15
    v_mul_f32 v87, v87, v15
    v_accvgpr_write_b32 a104, v76
    v_accvgpr_write_b32 a105, v77
    v_accvgpr_write_b32 a106, v78
    v_accvgpr_write_b32 a107, v79
    v_accvgpr_write_b32 a108, v80
    v_accvgpr_write_b32 a109, v81
    v_accvgpr_write_b32 a110, v82
    v_accvgpr_write_b32 a111, v83
    v_accvgpr_write_b32 a112, v84
    v_accvgpr_write_b32 a113, v85
    v_accvgpr_write_b32 a114, v86
    v_accvgpr_write_b32 a115, v87
    v_accvgpr_read_b32 v76, a116
    v_accvgpr_read_b32 v77, a117
    v_accvgpr_read_b32 v78, a118
    v_accvgpr_read_b32 v79, a119
    v_accvgpr_read_b32 v80, a120
    v_accvgpr_read_b32 v81, a121
    v_accvgpr_read_b32 v82, a122
    v_accvgpr_read_b32 v83, a123
    v_accvgpr_read_b32 v84, a124
    v_accvgpr_read_b32 v85, a125
    v_accvgpr_read_b32 v86, a126
    v_accvgpr_read_b32 v87, a127
    v_mul_f32 v76, v76, v13
    v_mul_f32 v77, v77, v13
    v_mul_f32 v78, v78, v13
    v_mul_f32 v79, v79, v13
    v_mul_f32 v80, v80, v14
    v_mul_f32 v81, v81, v14
    v_mul_f32 v82, v82, v14
    v_mul_f32 v83, v83, v14
    v_mul_f32 v84, v84, v15
    v_mul_f32 v85, v85, v15
    v_mul_f32 v86, v86, v15
    v_mul_f32 v87, v87, v15
    v_accvgpr_write_b32 a116, v76
    v_accvgpr_write_b32 a117, v77
    v_accvgpr_write_b32 a118, v78
    v_accvgpr_write_b32 a119, v79
    v_accvgpr_write_b32 a120, v80
    v_accvgpr_write_b32 a121, v81
    v_accvgpr_write_b32 a122, v82
    v_accvgpr_write_b32 a123, v83
    v_accvgpr_write_b32 a124, v84
    v_accvgpr_write_b32 a125, v85
    v_accvgpr_write_b32 a126, v86
    v_accvgpr_write_b32 a127, v87
    v_accvgpr_read_b32 v76, a128
    v_accvgpr_read_b32 v77, a129
    v_accvgpr_read_b32 v78, a130
    v_accvgpr_read_b32 v79, a131
    v_accvgpr_read_b32 v80, a132
    v_accvgpr_read_b32 v81, a133
    v_accvgpr_read_b32 v82, a134
    v_accvgpr_read_b32 v83, a135
    v_accvgpr_read_b32 v84, a136
    v_accvgpr_read_b32 v85, a137
    v_accvgpr_read_b32 v86, a138
    v_accvgpr_read_b32 v87, a139
    v_mul_f32 v76, v76, v13
    v_mul_f32 v77, v77, v13
    v_mul_f32 v78, v78, v13
    v_mul_f32 v79, v79, v13
    v_mul_f32 v80, v80, v14
    v_mul_f32 v81, v81, v14
    v_mul_f32 v82, v82, v14
    v_mul_f32 v83, v83, v14
    v_mul_f32 v84, v84, v15
    v_mul_f32 v85, v85, v15
    v_mul_f32 v86, v86, v15
    v_mul_f32 v87, v87, v15
    v_accvgpr_write_b32 a128, v76
    v_accvgpr_write_b32 a129, v77
    v_accvgpr_write_b32 a130, v78
    v_accvgpr_write_b32 a131, v79
    v_accvgpr_write_b32 a132, v80
    v_accvgpr_write_b32 a133, v81
    v_accvgpr_write_b32 a134, v82
    v_accvgpr_write_b32 a135, v83
    v_accvgpr_write_b32 a136, v84
    v_accvgpr_write_b32 a137, v85
    v_accvgpr_write_b32 a138, v86
    v_accvgpr_write_b32 a139, v87
    v_accvgpr_read_b32 v76, a140
    v_accvgpr_read_b32 v77, a141
    v_accvgpr_read_b32 v78, a142
    v_accvgpr_read_b32 v79, a143
    v_accvgpr_read_b32 v80, a144
    v_accvgpr_read_b32 v81, a145
    v_accvgpr_read_b32 v82, a146
    v_accvgpr_read_b32 v83, a147
    v_accvgpr_read_b32 v84, a148
    v_accvgpr_read_b32 v85, a149
    v_accvgpr_read_b32 v86, a150
    v_accvgpr_read_b32 v87, a151
    v_mul_f32 v76, v76, v13
    v_mul_f32 v77, v77, v13
    v_mul_f32 v78, v78, v13
    v_mul_f32 v79, v79, v13
    v_mul_f32 v80, v80, v14
    v_mul_f32 v81, v81, v14
    v_mul_f32 v82, v82, v14
    v_mul_f32 v83, v83, v14
    v_mul_f32 v84, v84, v15
    v_mul_f32 v85, v85, v15
    v_mul_f32 v86, v86, v15
    v_mul_f32 v87, v87, v15
    v_accvgpr_write_b32 a140, v76
    v_accvgpr_write_b32 a141, v77
    v_accvgpr_write_b32 a142, v78
    v_accvgpr_write_b32 a143, v79
    v_accvgpr_write_b32 a144, v80
    v_accvgpr_write_b32 a145, v81
    v_accvgpr_write_b32 a146, v82
    v_accvgpr_write_b32 a147, v83
    v_accvgpr_write_b32 a148, v84
    v_accvgpr_write_b32 a149, v85
    v_accvgpr_write_b32 a150, v86
    v_accvgpr_write_b32 a151, v87
    v_accvgpr_read_b32 v76, a152
    v_accvgpr_read_b32 v77, a153
    v_accvgpr_read_b32 v78, a154
    v_accvgpr_read_b32 v79, a155
    v_accvgpr_read_b32 v80, a156
    v_accvgpr_read_b32 v81, a157
    v_accvgpr_read_b32 v82, a158
    v_accvgpr_read_b32 v83, a159
    v_accvgpr_read_b32 v84, a160
    v_accvgpr_read_b32 v85, a161
    v_accvgpr_read_b32 v86, a162
    v_accvgpr_read_b32 v87, a163
    v_mul_f32 v76, v76, v13
    v_mul_f32 v77, v77, v13
    v_mul_f32 v78, v78, v13
    v_mul_f32 v79, v79, v13
    v_mul_f32 v80, v80, v14
    v_mul_f32 v81, v81, v14
    v_mul_f32 v82, v82, v14
    v_mul_f32 v83, v83, v14
    v_mul_f32 v84, v84, v15
    v_mul_f32 v85, v85, v15
    v_mul_f32 v86, v86, v15
    v_mul_f32 v87, v87, v15
    v_accvgpr_write_b32 a152, v76
    v_accvgpr_write_b32 a153, v77
    v_accvgpr_write_b32 a154, v78
    v_accvgpr_write_b32 a155, v79
    v_accvgpr_write_b32 a156, v80
    v_accvgpr_write_b32 a157, v81
    v_accvgpr_write_b32 a158, v82
    v_accvgpr_write_b32 a159, v83
    v_accvgpr_write_b32 a160, v84
    v_accvgpr_write_b32 a161, v85
    v_accvgpr_write_b32 a162, v86
    v_accvgpr_write_b32 a163, v87
    v_accvgpr_read_b32 v76, a164
    v_accvgpr_read_b32 v77, a165
    v_accvgpr_read_b32 v78, a166
    v_accvgpr_read_b32 v79, a167
    v_accvgpr_read_b32 v80, a168
    v_accvgpr_read_b32 v81, a169
    v_accvgpr_read_b32 v82, a170
    v_accvgpr_read_b32 v83, a171
    v_accvgpr_read_b32 v84, a172
    v_accvgpr_read_b32 v85, a173
    v_accvgpr_read_b32 v86, a174
    v_accvgpr_read_b32 v87, a175
    v_mul_f32 v76, v76, v13
    v_mul_f32 v77, v77, v13
    v_mul_f32 v78, v78, v13
    v_mul_f32 v79, v79, v13
    v_mul_f32 v80, v80, v14
    v_mul_f32 v81, v81, v14
    v_mul_f32 v82, v82, v14
    v_mul_f32 v83, v83, v14
    v_mul_f32 v84, v84, v15
    v_mul_f32 v85, v85, v15
    v_mul_f32 v86, v86, v15
    v_mul_f32 v87, v87, v15
    v_accvgpr_write_b32 a164, v76
    v_accvgpr_write_b32 a165, v77
    v_accvgpr_write_b32 a166, v78
    v_accvgpr_write_b32 a167, v79
    v_accvgpr_write_b32 a168, v80
    v_accvgpr_write_b32 a169, v81
    v_accvgpr_write_b32 a170, v82
    v_accvgpr_write_b32 a171, v83
    v_accvgpr_write_b32 a172, v84
    v_accvgpr_write_b32 a173, v85
    v_accvgpr_write_b32 a174, v86
    v_accvgpr_write_b32 a175, v87
L_safe_skip_c:
    s_nop 1
    s_waitcnt lgkmcnt(5)
    v_mfma_f32_16x16x32_bf16 v[160:163], a[0:3], v[16:19], v[28:31]
    ds_read_b128 a[24:27], v2 offset:24704
    v_exp_f32 v184, v184
    v_mfma_f32_16x16x32_bf16 v[164:167], a[4:7], v[16:19], v[28:31]
    v_exp_f32 v185, v185
    v_mfma_f32_16x16x32_bf16 v[172:175], a[4:7], v[20:23], v[32:35]
    buffer_load_dwordx4 v235, s[16:19], s48 offen offset:3072 lds
    v_cvt_pk_bf16_f32 v52, v184, v185
    v_mfma_f32_16x16x32_bf16 v[168:171], a[0:3], v[20:23], v[32:35]
    ds_read_b128 a[28:31], v2 offset:30848
    v_exp_f32 v186, v186
    v_mfma_f32_16x16x32_bf16 v[176:179], a[0:3], v[24:27], v[36:39]
    v_exp_f32 v187, v187
    v_mfma_f32_16x16x32_bf16 v[180:183], a[4:7], v[24:27], v[36:39]
    v_exp_f32 v188, v188
    s_waitcnt lgkmcnt(5)
    v_mfma_f32_16x16x32_bf16 v[160:163], a[8:11], v[40:43], v[160:163]
    ds_read_b128 a[0:3], v1 offset:24832
    v_cvt_pk_bf16_f32 v53, v186, v187
    v_mfma_f32_16x16x32_bf16 v[164:167], a[12:15], v[40:43], v[164:167]
    v_exp_f32 v189, v189
    v_mfma_f32_16x16x32_bf16 v[172:175], a[12:15], v[44:47], v[172:175]
    s_add_u32 m0, s49, 126976
    v_exp_f32 v190, v190
    v_mfma_f32_16x16x32_bf16 v[168:171], a[8:11], v[44:47], v[168:171]
    ds_read_b128 a[4:7], v1 offset:30976
    buffer_load_dwordx4 v236, s[16:19], s48 offen offset:0 lds
    v_mfma_f32_16x16x32_bf16 v[176:179], a[8:11], v[48:51], v[176:179]
    v_exp_f32 v191, v191
    v_mfma_f32_16x16x32_bf16 v[180:183], a[12:15], v[48:51], v[180:183]
    v_exp_f32 v192, v192
    s_waitcnt lgkmcnt(4)
    v_mfma_f32_16x16x32_bf16 v[160:163], a[16:19], v[64:67], v[160:163]
    ds_read_b128 a[8:11], v2 offset:24832
    v_exp_f32 v193, v193
    v_mfma_f32_16x16x32_bf16 v[164:167], a[20:23], v[64:67], v[164:167]
    v_exp_f32 v194, v194
    v_cvt_pk_bf16_f32 v54, v188, v189
    v_mfma_f32_16x16x32_bf16 v[172:175], a[20:23], v[68:71], v[172:175]
    v_exp_f32 v195, v195
    v_mfma_f32_16x16x32_bf16 v[168:171], a[16:19], v[68:71], v[168:171]
    ds_read_b128 a[12:15], v2 offset:30976
    v_exp_f32 v196, v196
    v_mfma_f32_16x16x32_bf16 v[176:179], a[16:19], v[72:75], v[176:179]
    buffer_load_dwordx4 v237, s[16:19], s48 offen offset:1024 lds
    v_cvt_pk_bf16_f32 v55, v190, v191
    v_mfma_f32_16x16x32_bf16 v[180:183], a[20:23], v[72:75], v[180:183]
    v_exp_f32 v197, v197
    s_waitcnt lgkmcnt(4)
    v_mfma_f32_16x16x32_bf16 v[160:163], a[24:27], v[88:91], v[160:163]
    ds_read_b64_tr_b16 a[16:17], v3 offset:24576
    v_cvt_pk_bf16_f32 v56, v192, v193
    v_mfma_f32_16x16x32_bf16 v[164:167], a[28:31], v[88:91], v[164:167]
    v_exp_f32 v198, v198
    v_mfma_f32_16x16x32_bf16 v[172:175], a[28:31], v[92:95], v[172:175]
    ds_read_b64_tr_b16 a[18:19], v3 offset:30720
    v_exp_f32 v199, v199
    v_mfma_f32_16x16x32_bf16 v[168:171], a[24:27], v[92:95], v[168:171]
    ds_read_b64_tr_b16 a[20:21], v4 offset:24576
    v_exp_f32 v200, v200
    v_mfma_f32_16x16x32_bf16 v[176:179], a[24:27], v[96:99], v[176:179]
    v_exp_f32 v201, v201
    v_cvt_pk_bf16_f32 v57, v194, v195
    v_mfma_f32_16x16x32_bf16 v[180:183], a[28:31], v[96:99], v[180:183]
    ds_read_b64_tr_b16 a[22:23], v4 offset:30720
    s_waitcnt lgkmcnt(6)
    v_mfma_f32_16x16x32_bf16 v[160:163], a[0:3], v[112:115], v[160:163]
    ds_read_b64_tr_b16 a[24:25], v5 offset:24576
    buffer_load_dwordx4 v238, s[16:19], s48 offen offset:2048 lds
    v_mfma_f32_16x16x32_bf16 v[164:167], a[4:7], v[112:115], v[164:167]
    v_exp_f32 v202, v202
    v_mfma_f32_16x16x32_bf16 v[172:175], a[4:7], v[116:119], v[172:175]
    ds_read_b64_tr_b16 a[26:27], v5 offset:30720
    v_exp_f32 v203, v203
    v_mfma_f32_16x16x32_bf16 v[168:171], a[0:3], v[116:119], v[168:171]
    ds_read_b64_tr_b16 a[28:29], v6 offset:24576
    v_exp_f32 v204, v204
    v_mfma_f32_16x16x32_bf16 v[176:179], a[0:3], v[120:123], v[176:179]
    v_exp_f32 v205, v205
    v_mfma_f32_16x16x32_bf16 v[180:183], a[4:7], v[120:123], v[180:183]
    ds_read_b64_tr_b16 a[30:31], v6 offset:30720
    v_cvt_pk_bf16_f32 v58, v196, v197
    s_waitcnt lgkmcnt(8)
    v_mfma_f32_16x16x32_bf16 v[160:163], a[8:11], v[136:139], v[160:163]
    ds_read_b64_tr_b16 a[0:1], v3 offset:24704
    v_exp_f32 v206, v206
    v_mfma_f32_16x16x32_bf16 v[164:167], a[12:15], v[136:139], v[164:167]
    buffer_load_dwordx4 v239, s[16:19], s48 offen offset:3072 lds
    v_exp_f32 v207, v207
    v_mfma_f32_16x16x32_bf16 v[172:175], a[12:15], v[140:143], v[172:175]
    ds_read_b64_tr_b16 a[2:3], v3 offset:30848
    v_cvt_pk_bf16_f32 v59, v198, v199
    v_mfma_f32_16x16x32_bf16 v[168:171], a[8:11], v[140:143], v[168:171]
    ds_read_b64_tr_b16 a[4:5], v4 offset:24704
    v_cvt_pk_bf16_f32 v60, v200, v201
    v_mfma_f32_16x16x32_bf16 v[176:179], a[8:11], v[144:147], v[176:179]
    v_cvt_pk_bf16_f32 v61, v202, v203
    v_cvt_pk_bf16_f32 v62, v204, v205
    v_cvt_pk_bf16_f32 v63, v206, v207
    v_mfma_f32_16x16x32_bf16 v[180:183], a[12:15], v[144:147], v[180:183]
    ds_read_b64_tr_b16 a[6:7], v4 offset:30848
    s_waitcnt lgkmcnt(8)
    v_mfma_f32_16x16x32_bf16 a[32:35], a[16:19], v[52:55], a[32:35]
    ds_read_b64_tr_b16 a[8:9], v5 offset:24704
    v_add_f32 v7, v7, v184
    v_mfma_f32_16x16x32_bf16 a[44:47], a[20:23], v[52:55], a[44:47]
    s_add_u32 m0, s49, 131072
    v_mfma_f32_16x16x32_bf16 a[48:51], a[20:23], v[56:59], a[48:51]
    ds_read_b64_tr_b16 a[10:11], v5 offset:30848
    buffer_load_dwordx4 v240, s[16:19], s48 offen offset:0 lds
    v_mfma_f32_16x16x32_bf16 a[36:39], a[16:19], v[56:59], a[36:39]
    ds_read_b64_tr_b16 a[12:13], v6 offset:24704
    v_add_f32 v7, v7, v185
    v_mfma_f32_16x16x32_bf16 a[40:43], a[16:19], v[60:63], a[40:43]
    v_add_f32 v7, v7, v186
    v_mfma_f32_16x16x32_bf16 a[52:55], a[20:23], v[60:63], a[52:55]
    ds_read_b64_tr_b16 a[14:15], v6 offset:30848
    s_waitcnt lgkmcnt(8)
    v_mfma_f32_16x16x32_bf16 a[64:67], a[24:27], v[60:63], a[64:67]
    ds_read_b64_tr_b16 a[16:17], v3 offset:24832
    v_add_f32 v7, v7, v187
    v_mfma_f32_16x16x32_bf16 a[76:79], a[28:31], v[60:63], a[76:79]
    v_add_f32 v7, v7, v188
    v_mfma_f32_16x16x32_bf16 a[72:75], a[28:31], v[56:59], a[72:75]
    ds_read_b64_tr_b16 a[18:19], v3 offset:30976
    v_add_f32 v7, v7, v189
    v_mfma_f32_16x16x32_bf16 a[60:63], a[24:27], v[56:59], a[60:63]
    ds_read_b64_tr_b16 a[20:21], v4 offset:24832
    v_add_f32 v7, v7, v190
    v_mfma_f32_16x16x32_bf16 a[56:59], a[24:27], v[52:55], a[56:59]
    buffer_load_dwordx4 v241, s[16:19], s48 offen offset:1024 lds
    v_add_f32 v7, v7, v191
    v_mfma_f32_16x16x32_bf16 a[68:71], a[28:31], v[52:55], a[68:71]
    ds_read_b64_tr_b16 a[22:23], v4 offset:30976
    s_waitcnt lgkmcnt(8)
    v_mfma_f32_16x16x32_bf16 a[80:83], a[0:3], v[52:55], a[80:83]
    ds_read_b64_tr_b16 a[24:25], v5 offset:24832
    s_sub_u32 s46, s42, s47
    v_mfma_f32_16x16x32_bf16 a[92:95], a[4:7], v[52:55], a[92:95]
    s_mov_b32 s42, s36
    v_mfma_f32_16x16x32_bf16 a[96:99], a[4:7], v[56:59], a[96:99]
    ds_read_b64_tr_b16 a[26:27], v5 offset:30976
    v_add_f32 v8, v8, v192
    v_mfma_f32_16x16x32_bf16 a[84:87], a[0:3], v[56:59], a[84:87]
    ds_read_b64_tr_b16 a[28:29], v6 offset:24832
    s_mov_b32 s36, s47
    v_mfma_f32_16x16x32_bf16 a[88:91], a[0:3], v[60:63], a[88:91]
    s_add_u32 s47, s47, s46
    v_add_f32 v8, v8, v193
    v_mfma_f32_16x16x32_bf16 a[100:103], a[4:7], v[60:63], a[100:103]
    ds_read_b64_tr_b16 a[30:31], v6 offset:30976
    s_waitcnt lgkmcnt(8)
    v_mfma_f32_16x16x32_bf16 a[112:115], a[8:11], v[60:63], a[112:115]
    v_add_u32 v1, s46, v1
    v_add_u32 v2, s46, v2
    v_mfma_f32_16x16x32_bf16 a[124:127], a[12:15], v[60:63], a[124:127]
    v_add_f32 v8, v8, v194
    v_mfma_f32_16x16x32_bf16 a[120:123], a[12:15], v[56:59], a[120:123]
    v_add_u32 v3, s46, v3
    v_add_u32 v4, s46, v4
    v_mfma_f32_16x16x32_bf16 a[108:111], a[8:11], v[56:59], a[108:111]
    v_add_u32 v5, s46, v5
    v_add_u32 v6, s46, v6
    v_mfma_f32_16x16x32_bf16 a[104:107], a[8:11], v[52:55], a[104:107]
    v_add_f32 v8, v8, v195
    v_mfma_f32_16x16x32_bf16 a[116:119], a[12:15], v[52:55], a[116:119]
    s_waitcnt lgkmcnt(0)
    s_waitcnt vmcnt(10)
    s_barrier
    v_mfma_f32_16x16x32_bf16 a[128:131], a[16:19], v[52:55], a[128:131]
    ds_read_b128 a[0:3], v1 offset:0
    ds_read_b128 a[4:7], v1 offset:6144
    v_mfma_f32_16x16x32_bf16 a[140:143], a[20:23], v[52:55], a[140:143]
    v_add_f32 v8, v8, v196
    v_add_f32 v8, v8, v197
    v_mfma_f32_16x16x32_bf16 a[144:147], a[20:23], v[56:59], a[144:147]
    ds_read_b128 a[8:11], v2 offset:0
    v_mfma_f32_16x16x32_bf16 a[132:135], a[16:19], v[56:59], a[132:135]
    ds_read_b128 a[12:15], v2 offset:6144
    v_add_f32 v8, v8, v198
    v_mfma_f32_16x16x32_bf16 a[136:139], a[16:19], v[60:63], a[136:139]
    v_add_f32 v8, v8, v199
    v_mfma_f32_16x16x32_bf16 a[148:151], a[20:23], v[60:63], a[148:151]
    v_add_f32 v9, v9, v200
    v_add_f32 v9, v9, v201
    v_mfma_f32_16x16x32_bf16 a[160:163], a[24:27], v[60:63], a[160:163]
    ds_read_b128 a[16:19], v1 offset:128
    v_add_f32 v9, v9, v202
    v_mfma_f32_16x16x32_bf16 a[172:175], a[28:31], v[60:63], a[172:175]
    v_add_f32 v9, v9, v203
    v_mfma_f32_16x16x32_bf16 a[168:171], a[28:31], v[56:59], a[168:171]
    v_add_f32 v9, v9, v204
    v_mfma_f32_16x16x32_bf16 a[156:159], a[24:27], v[56:59], a[156:159]
    ds_read_b128 a[20:23], v1 offset:6272
    v_add_f32 v9, v9, v205
    v_mfma_f32_16x16x32_bf16 a[152:155], a[24:27], v[52:55], a[152:155]
    v_add_f32 v9, v9, v206
    v_mfma_f32_16x16x32_bf16 a[164:167], a[28:31], v[52:55], a[164:167]
    v_add_f32 v9, v9, v207
    v_max3_f32 v10, v160, v161, v162
    v_max3_f32 v10, v10, v163, v164
    v_max3_f32 v10, v10, v165, v166
    v_max_f32 v10, v10, v167
    v_max3_f32 v11, v168, v169, v170
    v_max3_f32 v11, v11, v171, v172
    v_max3_f32 v11, v11, v173, v174
    v_max_f32 v11, v11, v175
    v_max3_f32 v12, v176, v177, v178
    v_max3_f32 v12, v12, v179, v180
    v_max3_f32 v12, v12, v181, v182
    v_max_f32 v12, v12, v183
    v_max3_f32 v13, v10, v11, v12
    v_cmp_lt_f32 vcc, 0, v13
    s_nop 0
    s_cbranch_vccz L_safe_skip_d
    v_mov_b32 v13, v10
    v_mov_b32 v14, v11
    v_mov_b32 v15, v12
    v_permlane32_swap_b32 v10, v13
    v_permlane32_swap_b32 v11, v14
    v_permlane32_swap_b32 v12, v15
    v_max_f32 v10, v10, v13
    v_max_f32 v11, v11, v14
    v_max_f32 v12, v12, v15
    v_mov_b32 v13, v10
    v_mov_b32 v14, v11
    v_mov_b32 v15, v12
    v_permlane16_swap_b32 v10, v13
    v_permlane16_swap_b32 v11, v14
    v_permlane16_swap_b32 v12, v15
    v_max_f32 v10, v10, v13
    v_max_f32 v11, v11, v14
    v_max_f32 v12, v12, v15
    v_max_f32 v10, 0, v10
    v_max_f32 v11, 0, v11
    v_max_f32 v12, 0, v12
    v_sub_f32 v13, 0, v10
    v_sub_f32 v14, 0, v11
    v_sub_f32 v15, 0, v12
    v_exp_f32 v13, v13
    v_exp_f32 v14, v14
    v_exp_f32 v15, v15
    v_sub_f32 v160, v160, v10
    v_sub_f32 v161, v161, v10
    v_sub_f32 v162, v162, v10
    v_sub_f32 v163, v163, v10
    v_sub_f32 v164, v164, v10
    v_sub_f32 v165, v165, v10
    v_sub_f32 v166, v166, v10
    v_sub_f32 v167, v167, v10
    v_sub_f32 v28, v28, v10
    v_sub_f32 v29, v29, v10
    v_sub_f32 v30, v30, v10
    v_sub_f32 v31, v31, v10
    v_mul_f32 v7, v7, v13
    v_sub_f32 v168, v168, v11
    v_sub_f32 v169, v169, v11
    v_sub_f32 v170, v170, v11
    v_sub_f32 v171, v171, v11
    v_sub_f32 v172, v172, v11
    v_sub_f32 v173, v173, v11
    v_sub_f32 v174, v174, v11
    v_sub_f32 v175, v175, v11
    v_sub_f32 v32, v32, v11
    v_sub_f32 v33, v33, v11
    v_sub_f32 v34, v34, v11
    v_sub_f32 v35, v35, v11
    v_mul_f32 v8, v8, v14
    v_sub_f32 v176, v176, v12
    v_sub_f32 v177, v177, v12
    v_sub_f32 v178, v178, v12
    v_sub_f32 v179, v179, v12
    v_sub_f32 v180, v180, v12
    v_sub_f32 v181, v181, v12
    v_sub_f32 v182, v182, v12
    v_sub_f32 v183, v183, v12
    v_sub_f32 v36, v36, v12
    v_sub_f32 v37, v37, v12
    v_sub_f32 v38, v38, v12
    v_sub_f32 v39, v39, v12
    v_mul_f32 v9, v9, v15
    v_accvgpr_read_b32 v76, a32
    v_accvgpr_read_b32 v77, a33
    v_accvgpr_read_b32 v78, a34
    v_accvgpr_read_b32 v79, a35
    v_accvgpr_read_b32 v80, a36
    v_accvgpr_read_b32 v81, a37
    v_accvgpr_read_b32 v82, a38
    v_accvgpr_read_b32 v83, a39
    v_accvgpr_read_b32 v84, a40
    v_accvgpr_read_b32 v85, a41
    v_accvgpr_read_b32 v86, a42
    v_accvgpr_read_b32 v87, a43
    v_mul_f32 v76, v76, v13
    v_mul_f32 v77, v77, v13
    v_mul_f32 v78, v78, v13
    v_mul_f32 v79, v79, v13
    v_mul_f32 v80, v80, v14
    v_mul_f32 v81, v81, v14
    v_mul_f32 v82, v82, v14
    v_mul_f32 v83, v83, v14
    v_mul_f32 v84, v84, v15
    v_mul_f32 v85, v85, v15
    v_mul_f32 v86, v86, v15
    v_mul_f32 v87, v87, v15
    v_accvgpr_write_b32 a32, v76
    v_accvgpr_write_b32 a33, v77
    v_accvgpr_write_b32 a34, v78
    v_accvgpr_write_b32 a35, v79
    v_accvgpr_write_b32 a36, v80
    v_accvgpr_write_b32 a37, v81
    v_accvgpr_write_b32 a38, v82
    v_accvgpr_write_b32 a39, v83
    v_accvgpr_write_b32 a40, v84
    v_accvgpr_write_b32 a41, v85
    v_accvgpr_write_b32 a42, v86
    v_accvgpr_write_b32 a43, v87
    v_accvgpr_read_b32 v76, a44
    v_accvgpr_read_b32 v77, a45
    v_accvgpr_read_b32 v78, a46
    v_accvgpr_read_b32 v79, a47
    v_accvgpr_read_b32 v80, a48
    v_accvgpr_read_b32 v81, a49
    v_accvgpr_read_b32 v82, a50
    v_accvgpr_read_b32 v83, a51
    v_accvgpr_read_b32 v84, a52
    v_accvgpr_read_b32 v85, a53
    v_accvgpr_read_b32 v86, a54
    v_accvgpr_read_b32 v87, a55
    v_mul_f32 v76, v76, v13
    v_mul_f32 v77, v77, v13
    v_mul_f32 v78, v78, v13
    v_mul_f32 v79, v79, v13
    v_mul_f32 v80, v80, v14
    v_mul_f32 v81, v81, v14
    v_mul_f32 v82, v82, v14
    v_mul_f32 v83, v83, v14
    v_mul_f32 v84, v84, v15
    v_mul_f32 v85, v85, v15
    v_mul_f32 v86, v86, v15
    v_mul_f32 v87, v87, v15
    v_accvgpr_write_b32 a44, v76
    v_accvgpr_write_b32 a45, v77
    v_accvgpr_write_b32 a46, v78
    v_accvgpr_write_b32 a47, v79
    v_accvgpr_write_b32 a48, v80
    v_accvgpr_write_b32 a49, v81
    v_accvgpr_write_b32 a50, v82
    v_accvgpr_write_b32 a51, v83
    v_accvgpr_write_b32 a52, v84
    v_accvgpr_write_b32 a53, v85
    v_accvgpr_write_b32 a54, v86
    v_accvgpr_write_b32 a55, v87
    v_accvgpr_read_b32 v76, a56
    v_accvgpr_read_b32 v77, a57
    v_accvgpr_read_b32 v78, a58
    v_accvgpr_read_b32 v79, a59
    v_accvgpr_read_b32 v80, a60
    v_accvgpr_read_b32 v81, a61
    v_accvgpr_read_b32 v82, a62
    v_accvgpr_read_b32 v83, a63
    v_accvgpr_read_b32 v84, a64
    v_accvgpr_read_b32 v85, a65
    v_accvgpr_read_b32 v86, a66
    v_accvgpr_read_b32 v87, a67
    v_mul_f32 v76, v76, v13
    v_mul_f32 v77, v77, v13
    v_mul_f32 v78, v78, v13
    v_mul_f32 v79, v79, v13
    v_mul_f32 v80, v80, v14
    v_mul_f32 v81, v81, v14
    v_mul_f32 v82, v82, v14
    v_mul_f32 v83, v83, v14
    v_mul_f32 v84, v84, v15
    v_mul_f32 v85, v85, v15
    v_mul_f32 v86, v86, v15
    v_mul_f32 v87, v87, v15
    v_accvgpr_write_b32 a56, v76
    v_accvgpr_write_b32 a57, v77
    v_accvgpr_write_b32 a58, v78
    v_accvgpr_write_b32 a59, v79
    v_accvgpr_write_b32 a60, v80
    v_accvgpr_write_b32 a61, v81
    v_accvgpr_write_b32 a62, v82
    v_accvgpr_write_b32 a63, v83
    v_accvgpr_write_b32 a64, v84
    v_accvgpr_write_b32 a65, v85
    v_accvgpr_write_b32 a66, v86
    v_accvgpr_write_b32 a67, v87
    v_accvgpr_read_b32 v76, a68
    v_accvgpr_read_b32 v77, a69
    v_accvgpr_read_b32 v78, a70
    v_accvgpr_read_b32 v79, a71
    v_accvgpr_read_b32 v80, a72
    v_accvgpr_read_b32 v81, a73
    v_accvgpr_read_b32 v82, a74
    v_accvgpr_read_b32 v83, a75
    v_accvgpr_read_b32 v84, a76
    v_accvgpr_read_b32 v85, a77
    v_accvgpr_read_b32 v86, a78
    v_accvgpr_read_b32 v87, a79
    v_mul_f32 v76, v76, v13
    v_mul_f32 v77, v77, v13
    v_mul_f32 v78, v78, v13
    v_mul_f32 v79, v79, v13
    v_mul_f32 v80, v80, v14
    v_mul_f32 v81, v81, v14
    v_mul_f32 v82, v82, v14
    v_mul_f32 v83, v83, v14
    v_mul_f32 v84, v84, v15
    v_mul_f32 v85, v85, v15
    v_mul_f32 v86, v86, v15
    v_mul_f32 v87, v87, v15
    v_accvgpr_write_b32 a68, v76
    v_accvgpr_write_b32 a69, v77
    v_accvgpr_write_b32 a70, v78
    v_accvgpr_write_b32 a71, v79
    v_accvgpr_write_b32 a72, v80
    v_accvgpr_write_b32 a73, v81
    v_accvgpr_write_b32 a74, v82
    v_accvgpr_write_b32 a75, v83
    v_accvgpr_write_b32 a76, v84
    v_accvgpr_write_b32 a77, v85
    v_accvgpr_write_b32 a78, v86
    v_accvgpr_write_b32 a79, v87
    v_accvgpr_read_b32 v76, a80
    v_accvgpr_read_b32 v77, a81
    v_accvgpr_read_b32 v78, a82
    v_accvgpr_read_b32 v79, a83
    v_accvgpr_read_b32 v80, a84
    v_accvgpr_read_b32 v81, a85
    v_accvgpr_read_b32 v82, a86
    v_accvgpr_read_b32 v83, a87
    v_accvgpr_read_b32 v84, a88
    v_accvgpr_read_b32 v85, a89
    v_accvgpr_read_b32 v86, a90
    v_accvgpr_read_b32 v87, a91
    v_mul_f32 v76, v76, v13
    v_mul_f32 v77, v77, v13
    v_mul_f32 v78, v78, v13
    v_mul_f32 v79, v79, v13
    v_mul_f32 v80, v80, v14
    v_mul_f32 v81, v81, v14
    v_mul_f32 v82, v82, v14
    v_mul_f32 v83, v83, v14
    v_mul_f32 v84, v84, v15
    v_mul_f32 v85, v85, v15
    v_mul_f32 v86, v86, v15
    v_mul_f32 v87, v87, v15
    v_accvgpr_write_b32 a80, v76
    v_accvgpr_write_b32 a81, v77
    v_accvgpr_write_b32 a82, v78
    v_accvgpr_write_b32 a83, v79
    v_accvgpr_write_b32 a84, v80
    v_accvgpr_write_b32 a85, v81
    v_accvgpr_write_b32 a86, v82
    v_accvgpr_write_b32 a87, v83
    v_accvgpr_write_b32 a88, v84
    v_accvgpr_write_b32 a89, v85
    v_accvgpr_write_b32 a90, v86
    v_accvgpr_write_b32 a91, v87
    v_accvgpr_read_b32 v76, a92
    v_accvgpr_read_b32 v77, a93
    v_accvgpr_read_b32 v78, a94
    v_accvgpr_read_b32 v79, a95
    v_accvgpr_read_b32 v80, a96
    v_accvgpr_read_b32 v81, a97
    v_accvgpr_read_b32 v82, a98
    v_accvgpr_read_b32 v83, a99
    v_accvgpr_read_b32 v84, a100
    v_accvgpr_read_b32 v85, a101
    v_accvgpr_read_b32 v86, a102
    v_accvgpr_read_b32 v87, a103
    v_mul_f32 v76, v76, v13
    v_mul_f32 v77, v77, v13
    v_mul_f32 v78, v78, v13
    v_mul_f32 v79, v79, v13
    v_mul_f32 v80, v80, v14
    v_mul_f32 v81, v81, v14
    v_mul_f32 v82, v82, v14
    v_mul_f32 v83, v83, v14
    v_mul_f32 v84, v84, v15
    v_mul_f32 v85, v85, v15
    v_mul_f32 v86, v86, v15
    v_mul_f32 v87, v87, v15
    v_accvgpr_write_b32 a92, v76
    v_accvgpr_write_b32 a93, v77
    v_accvgpr_write_b32 a94, v78
    v_accvgpr_write_b32 a95, v79
    v_accvgpr_write_b32 a96, v80
    v_accvgpr_write_b32 a97, v81
    v_accvgpr_write_b32 a98, v82
    v_accvgpr_write_b32 a99, v83
    v_accvgpr_write_b32 a100, v84
    v_accvgpr_write_b32 a101, v85
    v_accvgpr_write_b32 a102, v86
    v_accvgpr_write_b32 a103, v87
    v_accvgpr_read_b32 v76, a104
    v_accvgpr_read_b32 v77, a105
    v_accvgpr_read_b32 v78, a106
    v_accvgpr_read_b32 v79, a107
    v_accvgpr_read_b32 v80, a108
    v_accvgpr_read_b32 v81, a109
    v_accvgpr_read_b32 v82, a110
    v_accvgpr_read_b32 v83, a111
    v_accvgpr_read_b32 v84, a112
    v_accvgpr_read_b32 v85, a113
    v_accvgpr_read_b32 v86, a114
    v_accvgpr_read_b32 v87, a115
    v_mul_f32 v76, v76, v13
    v_mul_f32 v77, v77, v13
    v_mul_f32 v78, v78, v13
    v_mul_f32 v79, v79, v13
    v_mul_f32 v80, v80, v14
    v_mul_f32 v81, v81, v14
    v_mul_f32 v82, v82, v14
    v_mul_f32 v83, v83, v14
    v_mul_f32 v84, v84, v15
    v_mul_f32 v85, v85, v15
    v_mul_f32 v86, v86, v15
    v_mul_f32 v87, v87, v15
    v_accvgpr_write_b32 a104, v76
    v_accvgpr_write_b32 a105, v77
    v_accvgpr_write_b32 a106, v78
    v_accvgpr_write_b32 a107, v79
    v_accvgpr_write_b32 a108, v80
    v_accvgpr_write_b32 a109, v81
    v_accvgpr_write_b32 a110, v82
    v_accvgpr_write_b32 a111, v83
    v_accvgpr_write_b32 a112, v84
    v_accvgpr_write_b32 a113, v85
    v_accvgpr_write_b32 a114, v86
    v_accvgpr_write_b32 a115, v87
    v_accvgpr_read_b32 v76, a116
    v_accvgpr_read_b32 v77, a117
    v_accvgpr_read_b32 v78, a118
    v_accvgpr_read_b32 v79, a119
    v_accvgpr_read_b32 v80, a120
    v_accvgpr_read_b32 v81, a121
    v_accvgpr_read_b32 v82, a122
    v_accvgpr_read_b32 v83, a123
    v_accvgpr_read_b32 v84, a124
    v_accvgpr_read_b32 v85, a125
    v_accvgpr_read_b32 v86, a126
    v_accvgpr_read_b32 v87, a127
    v_mul_f32 v76, v76, v13
    v_mul_f32 v77, v77, v13
    v_mul_f32 v78, v78, v13
    v_mul_f32 v79, v79, v13
    v_mul_f32 v80, v80, v14
    v_mul_f32 v81, v81, v14
    v_mul_f32 v82, v82, v14
    v_mul_f32 v83, v83, v14
    v_mul_f32 v84, v84, v15
    v_mul_f32 v85, v85, v15
    v_mul_f32 v86, v86, v15
    v_mul_f32 v87, v87, v15
    v_accvgpr_write_b32 a116, v76
    v_accvgpr_write_b32 a117, v77
    v_accvgpr_write_b32 a118, v78
    v_accvgpr_write_b32 a119, v79
    v_accvgpr_write_b32 a120, v80
    v_accvgpr_write_b32 a121, v81
    v_accvgpr_write_b32 a122, v82
    v_accvgpr_write_b32 a123, v83
    v_accvgpr_write_b32 a124, v84
    v_accvgpr_write_b32 a125, v85
    v_accvgpr_write_b32 a126, v86
    v_accvgpr_write_b32 a127, v87
    v_accvgpr_read_b32 v76, a128
    v_accvgpr_read_b32 v77, a129
    v_accvgpr_read_b32 v78, a130
    v_accvgpr_read_b32 v79, a131
    v_accvgpr_read_b32 v80, a132
    v_accvgpr_read_b32 v81, a133
    v_accvgpr_read_b32 v82, a134
    v_accvgpr_read_b32 v83, a135
    v_accvgpr_read_b32 v84, a136
    v_accvgpr_read_b32 v85, a137
    v_accvgpr_read_b32 v86, a138
    v_accvgpr_read_b32 v87, a139
    v_mul_f32 v76, v76, v13
    v_mul_f32 v77, v77, v13
    v_mul_f32 v78, v78, v13
    v_mul_f32 v79, v79, v13
    v_mul_f32 v80, v80, v14
    v_mul_f32 v81, v81, v14
    v_mul_f32 v82, v82, v14
    v_mul_f32 v83, v83, v14
    v_mul_f32 v84, v84, v15
    v_mul_f32 v85, v85, v15
    v_mul_f32 v86, v86, v15
    v_mul_f32 v87, v87, v15
    v_accvgpr_write_b32 a128, v76
    v_accvgpr_write_b32 a129, v77
    v_accvgpr_write_b32 a130, v78
    v_accvgpr_write_b32 a131, v79
    v_accvgpr_write_b32 a132, v80
    v_accvgpr_write_b32 a133, v81
    v_accvgpr_write_b32 a134, v82
    v_accvgpr_write_b32 a135, v83
    v_accvgpr_write_b32 a136, v84
    v_accvgpr_write_b32 a137, v85
    v_accvgpr_write_b32 a138, v86
    v_accvgpr_write_b32 a139, v87
    v_accvgpr_read_b32 v76, a140
    v_accvgpr_read_b32 v77, a141
    v_accvgpr_read_b32 v78, a142
    v_accvgpr_read_b32 v79, a143
    v_accvgpr_read_b32 v80, a144
    v_accvgpr_read_b32 v81, a145
    v_accvgpr_read_b32 v82, a146
    v_accvgpr_read_b32 v83, a147
    v_accvgpr_read_b32 v84, a148
    v_accvgpr_read_b32 v85, a149
    v_accvgpr_read_b32 v86, a150
    v_accvgpr_read_b32 v87, a151
    v_mul_f32 v76, v76, v13
    v_mul_f32 v77, v77, v13
    v_mul_f32 v78, v78, v13
    v_mul_f32 v79, v79, v13
    v_mul_f32 v80, v80, v14
    v_mul_f32 v81, v81, v14
    v_mul_f32 v82, v82, v14
    v_mul_f32 v83, v83, v14
    v_mul_f32 v84, v84, v15
    v_mul_f32 v85, v85, v15
    v_mul_f32 v86, v86, v15
    v_mul_f32 v87, v87, v15
    v_accvgpr_write_b32 a140, v76
    v_accvgpr_write_b32 a141, v77
    v_accvgpr_write_b32 a142, v78
    v_accvgpr_write_b32 a143, v79
    v_accvgpr_write_b32 a144, v80
    v_accvgpr_write_b32 a145, v81
    v_accvgpr_write_b32 a146, v82
    v_accvgpr_write_b32 a147, v83
    v_accvgpr_write_b32 a148, v84
    v_accvgpr_write_b32 a149, v85
    v_accvgpr_write_b32 a150, v86
    v_accvgpr_write_b32 a151, v87
    v_accvgpr_read_b32 v76, a152
    v_accvgpr_read_b32 v77, a153
    v_accvgpr_read_b32 v78, a154
    v_accvgpr_read_b32 v79, a155
    v_accvgpr_read_b32 v80, a156
    v_accvgpr_read_b32 v81, a157
    v_accvgpr_read_b32 v82, a158
    v_accvgpr_read_b32 v83, a159
    v_accvgpr_read_b32 v84, a160
    v_accvgpr_read_b32 v85, a161
    v_accvgpr_read_b32 v86, a162
    v_accvgpr_read_b32 v87, a163
    v_mul_f32 v76, v76, v13
    v_mul_f32 v77, v77, v13
    v_mul_f32 v78, v78, v13
    v_mul_f32 v79, v79, v13
    v_mul_f32 v80, v80, v14
    v_mul_f32 v81, v81, v14
    v_mul_f32 v82, v82, v14
    v_mul_f32 v83, v83, v14
    v_mul_f32 v84, v84, v15
    v_mul_f32 v85, v85, v15
    v_mul_f32 v86, v86, v15
    v_mul_f32 v87, v87, v15
    v_accvgpr_write_b32 a152, v76
    v_accvgpr_write_b32 a153, v77
    v_accvgpr_write_b32 a154, v78
    v_accvgpr_write_b32 a155, v79
    v_accvgpr_write_b32 a156, v80
    v_accvgpr_write_b32 a157, v81
    v_accvgpr_write_b32 a158, v82
    v_accvgpr_write_b32 a159, v83
    v_accvgpr_write_b32 a160, v84
    v_accvgpr_write_b32 a161, v85
    v_accvgpr_write_b32 a162, v86
    v_accvgpr_write_b32 a163, v87
    v_accvgpr_read_b32 v76, a164
    v_accvgpr_read_b32 v77, a165
    v_accvgpr_read_b32 v78, a166
    v_accvgpr_read_b32 v79, a167
    v_accvgpr_read_b32 v80, a168
    v_accvgpr_read_b32 v81, a169
    v_accvgpr_read_b32 v82, a170
    v_accvgpr_read_b32 v83, a171
    v_accvgpr_read_b32 v84, a172
    v_accvgpr_read_b32 v85, a173
    v_accvgpr_read_b32 v86, a174
    v_accvgpr_read_b32 v87, a175
    v_mul_f32 v76, v76, v13
    v_mul_f32 v77, v77, v13
    v_mul_f32 v78, v78, v13
    v_mul_f32 v79, v79, v13
    v_mul_f32 v80, v80, v14
    v_mul_f32 v81, v81, v14
    v_mul_f32 v82, v82, v14
    v_mul_f32 v83, v83, v14
    v_mul_f32 v84, v84, v15
    v_mul_f32 v85, v85, v15
    v_mul_f32 v86, v86, v15
    v_mul_f32 v87, v87, v15
    v_accvgpr_write_b32 a164, v76
    v_accvgpr_write_b32 a165, v77
    v_accvgpr_write_b32 a166, v78
    v_accvgpr_write_b32 a167, v79
    v_accvgpr_write_b32 a168, v80
    v_accvgpr_write_b32 a169, v81
    v_accvgpr_write_b32 a170, v82
    v_accvgpr_write_b32 a171, v83
    v_accvgpr_write_b32 a172, v84
    v_accvgpr_write_b32 a173, v85
    v_accvgpr_write_b32 a174, v86
    v_accvgpr_write_b32 a175, v87
L_safe_skip_d:
    s_nop 1
    s_waitcnt lgkmcnt(4)
    v_mfma_f32_16x16x32_bf16 v[184:187], a[0:3], v[16:19], v[28:31]
    ds_read_b128 a[24:27], v2 offset:128
    v_exp_f32 v160, v160
    v_mfma_f32_16x16x32_bf16 v[188:191], a[4:7], v[16:19], v[28:31]
    v_exp_f32 v161, v161
    v_mfma_f32_16x16x32_bf16 v[196:199], a[4:7], v[20:23], v[32:35]
    buffer_load_dword v243, off, s[76:79], 0 sc1
    s_bfe_u32 s48, s50, 0x50005
    v_mfma_f32_16x16x32_bf16 v[192:195], a[0:3], v[20:23], v[32:35]
    ds_read_b128 a[28:31], v2 offset:6272
    s_add_u32 s48, s48, s51
    v_mfma_f32_16x16x32_bf16 v[200:203], a[0:3], v[24:27], v[36:39]
    s_cmp_ge_u32 s48, 24
    s_cselect_b32 s52, 24, 0
    v_exp_f32 v162, v162
    v_mfma_f32_16x16x32_bf16 v[204:207], a[4:7], v[24:27], v[36:39]
    s_sub_u32 s48, s48, s52
    v_cvt_pk_bf16_f32 v52, v160, v161
    s_waitcnt lgkmcnt(4)
    v_mfma_f32_16x16x32_bf16 v[184:187], a[8:11], v[40:43], v[184:187]
    ds_read_b128 a[0:3], v1 offset:256
    s_mul_i32 s48, s48, 40960
    v_mfma_f32_16x16x32_bf16 v[188:191], a[12:15], v[40:43], v[188:191]
    s_add_u32 m0, s49, 0
    v_exp_f32 v163, v163
    v_mfma_f32_16x16x32_bf16 v[196:199], a[12:15], v[44:47], v[196:199]
    buffer_load_dwordx4 v232, s[16:19], s48 offen offset:0 lds
    v_exp_f32 v164, v164
    v_mfma_f32_16x16x32_bf16 v[192:195], a[8:11], v[44:47], v[192:195]
    ds_read_b128 a[4:7], v1 offset:6400
    v_exp_f32 v165, v165
    v_mfma_f32_16x16x32_bf16 v[200:203], a[8:11], v[48:51], v[200:203]
    v_exp_f32 v166, v166
    v_cvt_pk_bf16_f32 v53, v162, v163
    v_mfma_f32_16x16x32_bf16 v[204:207], a[12:15], v[48:51], v[204:207]
    v_cvt_pk_bf16_f32 v54, v164, v165
    s_waitcnt lgkmcnt(4)
    v_mfma_f32_16x16x32_bf16 v[184:187], a[16:19], v[64:67], v[184:187]
    ds_read_b128 a[8:11], v2 offset:256
    v_exp_f32 v167, v167
    v_mfma_f32_16x16x32_bf16 v[188:191], a[20:23], v[64:67], v[188:191]
    v_exp_f32 v168, v168
    v_cvt_pk_bf16_f32 v55, v166, v167
    v_mfma_f32_16x16x32_bf16 v[196:199], a[20:23], v[68:71], v[196:199]
    buffer_load_dwordx4 v233, s[16:19], s48 offen offset:1024 lds
    v_exp_f32 v169, v169
    v_mfma_f32_16x16x32_bf16 v[192:195], a[16:19], v[68:71], v[192:195]
    ds_read_b128 a[12:15], v2 offset:6400
    v_exp_f32 v170, v170
    v_mfma_f32_16x16x32_bf16 v[200:203], a[16:19], v[72:75], v[200:203]
    v_exp_f32 v171, v171
    v_mfma_f32_16x16x32_bf16 v[204:207], a[20:23], v[72:75], v[204:207]
    v_cvt_pk_bf16_f32 v56, v168, v169
    v_cvt_pk_bf16_f32 v57, v170, v171
    s_waitcnt lgkmcnt(4)
    v_mfma_f32_16x16x32_bf16 v[184:187], a[24:27], v[88:91], v[184:187]
    ds_read_b64_tr_b16 a[16:17], v3 offset:0
    v_exp_f32 v172, v172
    v_mfma_f32_16x16x32_bf16 v[188:191], a[28:31], v[88:91], v[188:191]
    v_exp_f32 v173, v173
    v_mfma_f32_16x16x32_bf16 v[196:199], a[28:31], v[92:95], v[196:199]
    ds_read_b64_tr_b16 a[18:19], v3 offset:6144
    v_exp_f32 v174, v174
    v_mfma_f32_16x16x32_bf16 v[192:195], a[24:27], v[92:95], v[192:195]
    ds_read_b64_tr_b16 a[20:21], v4 offset:0
    buffer_load_dwordx4 v234, s[16:19], s48 offen offset:2048 lds
    v_cvt_pk_bf16_f32 v58, v172, v173
    v_mfma_f32_16x16x32_bf16 v[200:203], a[24:27], v[96:99], v[200:203]
    v_exp_f32 v175, v175
    v_mfma_f32_16x16x32_bf16 v[204:207], a[28:31], v[96:99], v[204:207]
    ds_read_b64_tr_b16 a[22:23], v4 offset:6144
    s_waitcnt lgkmcnt(6)
    v_mfma_f32_16x16x32_bf16 v[184:187], a[0:3], v[112:115], v[184:187]
    ds_read_b64_tr_b16 a[24:25], v5 offset:0
    v_exp_f32 v176, v176
    v_mfma_f32_16x16x32_bf16 v[188:191], a[4:7], v[112:115], v[188:191]
    v_exp_f32 v177, v177
    v_cvt_pk_bf16_f32 v59, v174, v175
    v_mfma_f32_16x16x32_bf16 v[196:199], a[4:7], v[116:119], v[196:199]
    ds_read_b64_tr_b16 a[26:27], v5 offset:6144
    v_exp_f32 v178, v178
    v_mfma_f32_16x16x32_bf16 v[192:195], a[0:3], v[116:119], v[192:195]
    ds_read_b64_tr_b16 a[28:29], v6 offset:0
    buffer_load_dwordx4 v235, s[16:19], s48 offen offset:3072 lds
    v_exp_f32 v179, v179
    v_mfma_f32_16x16x32_bf16 v[200:203], a[0:3], v[120:123], v[200:203]
    v_exp_f32 v180, v180
    v_mfma_f32_16x16x32_bf16 v[204:207], a[4:7], v[120:123], v[204:207]
    ds_read_b64_tr_b16 a[30:31], v6 offset:6144
    v_cvt_pk_bf16_f32 v60, v176, v177
    s_waitcnt lgkmcnt(8)
    v_mfma_f32_16x16x32_bf16 v[184:187], a[8:11], v[136:139], v[184:187]
    ds_read_b64_tr_b16 a[0:1], v3 offset:128
    v_exp_f32 v181, v181
    v_mfma_f32_16x16x32_bf16 v[188:191], a[12:15], v[136:139], v[188:191]
    v_exp_f32 v182, v182
    v_mfma_f32_16x16x32_bf16 v[196:199], a[12:15], v[140:143], v[196:199]
    ds_read_b64_tr_b16 a[2:3], v3 offset:6272
    v_exp_f32 v183, v183
    v_mfma_f32_16x16x32_bf16 v[192:195], a[8:11], v[140:143], v[192:195]
    ds_read_b64_tr_b16 a[4:5], v4 offset:128
    s_add_u32 m0, s49, 4096
    v_cvt_pk_bf16_f32 v61, v178, v179
    v_mfma_f32_16x16x32_bf16 v[200:203], a[8:11], v[144:147], v[200:203]
    buffer_load_dwordx4 v236, s[16:19], s48 offen offset:0 lds
    v_cvt_pk_bf16_f32 v62, v180, v181
    v_cvt_pk_bf16_f32 v63, v182, v183
    v_mfma_f32_16x16x32_bf16 v[204:207], a[12:15], v[144:147], v[204:207]
    ds_read_b64_tr_b16 a[6:7], v4 offset:6272
    s_waitcnt lgkmcnt(8)
    v_mfma_f32_16x16x32_bf16 a[32:35], a[16:19], v[52:55], a[32:35]
    ds_read_b64_tr_b16 a[8:9], v5 offset:128
    v_add_f32 v7, v7, v160
    v_mfma_f32_16x16x32_bf16 a[44:47], a[20:23], v[52:55], a[44:47]
    v_add_f32 v7, v7, v161
    v_mfma_f32_16x16x32_bf16 a[48:51], a[20:23], v[56:59], a[48:51]
    ds_read_b64_tr_b16 a[10:11], v5 offset:6272
    v_add_f32 v7, v7, v162
    v_mfma_f32_16x16x32_bf16 a[36:39], a[16:19], v[56:59], a[36:39]
    ds_read_b64_tr_b16 a[12:13], v6 offset:128
    v_mfma_f32_16x16x32_bf16 a[40:43], a[16:19], v[60:63], a[40:43]
    buffer_load_dwordx4 v237, s[16:19], s48 offen offset:1024 lds
    v_add_f32 v7, v7, v163
    v_mfma_f32_16x16x32_bf16 a[52:55], a[20:23], v[60:63], a[52:55]
    ds_read_b64_tr_b16 a[14:15], v6 offset:6272
    s_waitcnt lgkmcnt(8)
    v_mfma_f32_16x16x32_bf16 a[64:67], a[24:27], v[60:63], a[64:67]
    ds_read_b64_tr_b16 a[16:17], v3 offset:256
    v_mfma_f32_16x16x32_bf16 a[76:79], a[28:31], v[60:63], a[76:79]
    v_add_f32 v7, v7, v164
    v_add_f32 v7, v7, v165
    v_mfma_f32_16x16x32_bf16 a[72:75], a[28:31], v[56:59], a[72:75]
    ds_read_b64_tr_b16 a[18:19], v3 offset:6400
    v_mfma_f32_16x16x32_bf16 a[60:63], a[24:27], v[56:59], a[60:63]
    ds_read_b64_tr_b16 a[20:21], v4 offset:256
    v_add_f32 v7, v7, v166
    v_mfma_f32_16x16x32_bf16 a[56:59], a[24:27], v[52:55], a[56:59]
    buffer_load_dwordx4 v238, s[16:19], s48 offen offset:2048 lds
    v_add_f32 v7, v7, v167
    v_mfma_f32_16x16x32_bf16 a[68:71], a[28:31], v[52:55], a[68:71]
    ds_read_b64_tr_b16 a[22:23], v4 offset:6400
    s_waitcnt lgkmcnt(8)
    v_mfma_f32_16x16x32_bf16 a[80:83], a[0:3], v[52:55], a[80:83]
    ds_read_b64_tr_b16 a[24:25], v5 offset:256
    v_mfma_f32_16x16x32_bf16 a[92:95], a[4:7], v[52:55], a[92:95]
    v_add_f32 v8, v8, v168
    v_mfma_f32_16x16x32_bf16 a[96:99], a[4:7], v[56:59], a[96:99]
    ds_read_b64_tr_b16 a[26:27], v5 offset:6400
    v_add_f32 v8, v8, v169
    v_mfma_f32_16x16x32_bf16 a[84:87], a[0:3], v[56:59], a[84:87]
    ds_read_b64_tr_b16 a[28:29], v6 offset:256
    v_add_f32 v8, v8, v170
    v_mfma_f32_16x16x32_bf16 a[88:91], a[0:3], v[60:63], a[88:91]
    v_add_f32 v8, v8, v171
    v_mfma_f32_16x16x32_bf16 a[100:103], a[4:7], v[60:63], a[100:103]
    ds_read_b64_tr_b16 a[30:31], v6 offset:6400
    buffer_load_dwordx4 v239, s[16:19], s48 offen offset:3072 lds
    s_waitcnt lgkmcnt(8)
    v_mfma_f32_16x16x32_bf16 a[112:115], a[8:11], v[60:63], a[112:115]
    ds_read_b64_tr_b16 a[0:1], v3 offset:24576
    v_add_f32 v8, v8, v172
    v_mfma_f32_16x16x32_bf16 a[124:127], a[12:15], v[60:63], a[124:127]
    v_add_f32 v8, v8, v173
    v_mfma_f32_16x16x32_bf16 a[120:123], a[12:15], v[56:59], a[120:123]
    ds_read_b64_tr_b16 a[2:3], v3 offset:30720
    v_add_f32 v8, v8, v174
    v_mfma_f32_16x16x32_bf16 a[108:111], a[8:11], v[56:59], a[108:111]
    ds_read_b64_tr_b16 a[4:5], v4 offset:24576
    v_mfma_f32_16x16x32_bf16 a[104:107], a[8:11], v[52:55], a[104:107]
    s_add_u32 m0, s49, 8192
    v_add_f32 v8, v8, v175
    v_mfma_f32_16x16x32_bf16 a[116:119], a[12:15], v[52:55], a[116:119]
    ds_read_b64_tr_b16 a[6:7], v4 offset:30720
    buffer_load_dwordx4 v240, s[16:19], s48 offen offset:0 lds
    s_waitcnt lgkmcnt(8)
    v_mfma_f32_16x16x32_bf16 a[128:131], a[16:19], v[52:55], a[128:131]
    ds_read_b64_tr_b16 a[8:9], v5 offset:24576
    v_mfma_f32_16x16x32_bf16 a[140:143], a[20:23], v[52:55], a[140:143]
    v_add_f32 v9, v9, v176
    v_add_f32 v9, v9, v177
    v_mfma_f32_16x16x32_bf16 a[144:147], a[20:23], v[56:59], a[144:147]
    ds_read_b64_tr_b16 a[10:11], v5 offset:30720
    v_mfma_f32_16x16x32_bf16 a[132:135], a[16:19], v[56:59], a[132:135]
    ds_read_b64_tr_b16 a[12:13], v6 offset:24576
    v_add_f32 v9, v9, v178
    v_mfma_f32_16x16x32_bf16 a[136:139], a[16:19], v[60:63], a[136:139]
    v_add_f32 v9, v9, v179
    v_mfma_f32_16x16x32_bf16 a[148:151], a[20:23], v[60:63], a[148:151]
    ds_read_b64_tr_b16 a[14:15], v6 offset:30720
    s_waitcnt lgkmcnt(8)
    v_mfma_f32_16x16x32_bf16 a[160:163], a[24:27], v[60:63], a[160:163]
    ds_read_b64_tr_b16 a[16:17], v3 offset:24704
    buffer_load_dwordx4 v241, s[16:19], s48 offen offset:1024 lds
    v_mfma_f32_16x16x32_bf16 a[172:175], a[28:31], v[60:63], a[172:175]
    v_add_f32 v9, v9, v180
    v_mfma_f32_16x16x32_bf16 a[168:171], a[28:31], v[56:59], a[168:171]
    ds_read_b64_tr_b16 a[18:19], v3 offset:30848
    v_add_f32 v9, v9, v181
    v_mfma_f32_16x16x32_bf16 a[156:159], a[24:27], v[56:59], a[156:159]
    ds_read_b64_tr_b16 a[20:21], v4 offset:24704
    v_add_f32 v9, v9, v182
    v_mfma_f32_16x16x32_bf16 a[152:155], a[24:27], v[52:55], a[152:155]
    v_add_f32 v9, v9, v183
    v_mfma_f32_16x16x32_bf16 a[164:167], a[28:31], v[52:55], a[164:167]
    ds_read_b64_tr_b16 a[22:23], v4 offset:30848
    v_max3_f32 v10, v184, v185, v186
    v_max3_f32 v10, v10, v187, v188
    v_max3_f32 v10, v10, v189, v190
    v_max_f32 v10, v10, v191
    v_max3_f32 v11, v192, v193, v194
    v_max3_f32 v11, v11, v195, v196
    v_max3_f32 v11, v11, v197, v198
    v_max_f32 v11, v11, v199
    v_max3_f32 v12, v200, v201, v202
    v_max3_f32 v12, v12, v203, v204
    v_max3_f32 v12, v12, v205, v206
    v_max_f32 v12, v12, v207
    v_max3_f32 v13, v10, v11, v12
    v_cmp_lt_f32 vcc, 0, v13
    s_nop 0
    s_cbranch_vccz L_safe_skip_e
    v_mov_b32 v13, v10
    v_mov_b32 v14, v11
    v_mov_b32 v15, v12
    v_permlane32_swap_b32 v10, v13
    v_permlane32_swap_b32 v11, v14
    v_permlane32_swap_b32 v12, v15
    v_max_f32 v10, v10, v13
    v_max_f32 v11, v11, v14
    v_max_f32 v12, v12, v15
    v_mov_b32 v13, v10
    v_mov_b32 v14, v11
    v_mov_b32 v15, v12
    v_permlane16_swap_b32 v10, v13
    v_permlane16_swap_b32 v11, v14
    v_permlane16_swap_b32 v12, v15
    v_max_f32 v10, v10, v13
    v_max_f32 v11, v11, v14
    v_max_f32 v12, v12, v15
    v_max_f32 v10, 0, v10
    v_max_f32 v11, 0, v11
    v_max_f32 v12, 0, v12
    v_sub_f32 v13, 0, v10
    v_sub_f32 v14, 0, v11
    v_sub_f32 v15, 0, v12
    v_exp_f32 v13, v13
    v_exp_f32 v14, v14
    v_exp_f32 v15, v15
    v_sub_f32 v184, v184, v10
    v_sub_f32 v185, v185, v10
    v_sub_f32 v186, v186, v10
    v_sub_f32 v187, v187, v10
    v_sub_f32 v188, v188, v10
    v_sub_f32 v189, v189, v10
    v_sub_f32 v190, v190, v10
    v_sub_f32 v191, v191, v10
    v_sub_f32 v28, v28, v10
    v_sub_f32 v29, v29, v10
    v_sub_f32 v30, v30, v10
    v_sub_f32 v31, v31, v10
    v_mul_f32 v7, v7, v13
    v_sub_f32 v192, v192, v11
    v_sub_f32 v193, v193, v11
    v_sub_f32 v194, v194, v11
    v_sub_f32 v195, v195, v11
    v_sub_f32 v196, v196, v11
    v_sub_f32 v197, v197, v11
    v_sub_f32 v198, v198, v11
    v_sub_f32 v199, v199, v11
    v_sub_f32 v32, v32, v11
    v_sub_f32 v33, v33, v11
    v_sub_f32 v34, v34, v11
    v_sub_f32 v35, v35, v11
    v_mul_f32 v8, v8, v14
    v_sub_f32 v200, v200, v12
    v_sub_f32 v201, v201, v12
    v_sub_f32 v202, v202, v12
    v_sub_f32 v203, v203, v12
    v_sub_f32 v204, v204, v12
    v_sub_f32 v205, v205, v12
    v_sub_f32 v206, v206, v12
    v_sub_f32 v207, v207, v12
    v_sub_f32 v36, v36, v12
    v_sub_f32 v37, v37, v12
    v_sub_f32 v38, v38, v12
    v_sub_f32 v39, v39, v12
    v_mul_f32 v9, v9, v15
    v_accvgpr_read_b32 v76, a32
    v_accvgpr_read_b32 v77, a33
    v_accvgpr_read_b32 v78, a34
    v_accvgpr_read_b32 v79, a35
    v_accvgpr_read_b32 v80, a36
    v_accvgpr_read_b32 v81, a37
    v_accvgpr_read_b32 v82, a38
    v_accvgpr_read_b32 v83, a39
    v_accvgpr_read_b32 v84, a40
    v_accvgpr_read_b32 v85, a41
    v_accvgpr_read_b32 v86, a42
    v_accvgpr_read_b32 v87, a43
    v_mul_f32 v76, v76, v13
    v_mul_f32 v77, v77, v13
    v_mul_f32 v78, v78, v13
    v_mul_f32 v79, v79, v13
    v_mul_f32 v80, v80, v14
    v_mul_f32 v81, v81, v14
    v_mul_f32 v82, v82, v14
    v_mul_f32 v83, v83, v14
    v_mul_f32 v84, v84, v15
    v_mul_f32 v85, v85, v15
    v_mul_f32 v86, v86, v15
    v_mul_f32 v87, v87, v15
    v_accvgpr_write_b32 a32, v76
    v_accvgpr_write_b32 a33, v77
    v_accvgpr_write_b32 a34, v78
    v_accvgpr_write_b32 a35, v79
    v_accvgpr_write_b32 a36, v80
    v_accvgpr_write_b32 a37, v81
    v_accvgpr_write_b32 a38, v82
    v_accvgpr_write_b32 a39, v83
    v_accvgpr_write_b32 a40, v84
    v_accvgpr_write_b32 a41, v85
    v_accvgpr_write_b32 a42, v86
    v_accvgpr_write_b32 a43, v87
    v_accvgpr_read_b32 v76, a44
    v_accvgpr_read_b32 v77, a45
    v_accvgpr_read_b32 v78, a46
    v_accvgpr_read_b32 v79, a47
    v_accvgpr_read_b32 v80, a48
    v_accvgpr_read_b32 v81, a49
    v_accvgpr_read_b32 v82, a50
    v_accvgpr_read_b32 v83, a51
    v_accvgpr_read_b32 v84, a52
    v_accvgpr_read_b32 v85, a53
    v_accvgpr_read_b32 v86, a54
    v_accvgpr_read_b32 v87, a55
    v_mul_f32 v76, v76, v13
    v_mul_f32 v77, v77, v13
    v_mul_f32 v78, v78, v13
    v_mul_f32 v79, v79, v13
    v_mul_f32 v80, v80, v14
    v_mul_f32 v81, v81, v14
    v_mul_f32 v82, v82, v14
    v_mul_f32 v83, v83, v14
    v_mul_f32 v84, v84, v15
    v_mul_f32 v85, v85, v15
    v_mul_f32 v86, v86, v15
    v_mul_f32 v87, v87, v15
    v_accvgpr_write_b32 a44, v76
    v_accvgpr_write_b32 a45, v77
    v_accvgpr_write_b32 a46, v78
    v_accvgpr_write_b32 a47, v79
    v_accvgpr_write_b32 a48, v80
    v_accvgpr_write_b32 a49, v81
    v_accvgpr_write_b32 a50, v82
    v_accvgpr_write_b32 a51, v83
    v_accvgpr_write_b32 a52, v84
    v_accvgpr_write_b32 a53, v85
    v_accvgpr_write_b32 a54, v86
    v_accvgpr_write_b32 a55, v87
    v_accvgpr_read_b32 v76, a56
    v_accvgpr_read_b32 v77, a57
    v_accvgpr_read_b32 v78, a58
    v_accvgpr_read_b32 v79, a59
    v_accvgpr_read_b32 v80, a60
    v_accvgpr_read_b32 v81, a61
    v_accvgpr_read_b32 v82, a62
    v_accvgpr_read_b32 v83, a63
    v_accvgpr_read_b32 v84, a64
    v_accvgpr_read_b32 v85, a65
    v_accvgpr_read_b32 v86, a66
    v_accvgpr_read_b32 v87, a67
    v_mul_f32 v76, v76, v13
    v_mul_f32 v77, v77, v13
    v_mul_f32 v78, v78, v13
    v_mul_f32 v79, v79, v13
    v_mul_f32 v80, v80, v14
    v_mul_f32 v81, v81, v14
    v_mul_f32 v82, v82, v14
    v_mul_f32 v83, v83, v14
    v_mul_f32 v84, v84, v15
    v_mul_f32 v85, v85, v15
    v_mul_f32 v86, v86, v15
    v_mul_f32 v87, v87, v15
    v_accvgpr_write_b32 a56, v76
    v_accvgpr_write_b32 a57, v77
    v_accvgpr_write_b32 a58, v78
    v_accvgpr_write_b32 a59, v79
    v_accvgpr_write_b32 a60, v80
    v_accvgpr_write_b32 a61, v81
    v_accvgpr_write_b32 a62, v82
    v_accvgpr_write_b32 a63, v83
    v_accvgpr_write_b32 a64, v84
    v_accvgpr_write_b32 a65, v85
    v_accvgpr_write_b32 a66, v86
    v_accvgpr_write_b32 a67, v87
    v_accvgpr_read_b32 v76, a68
    v_accvgpr_read_b32 v77, a69
    v_accvgpr_read_b32 v78, a70
    v_accvgpr_read_b32 v79, a71
    v_accvgpr_read_b32 v80, a72
    v_accvgpr_read_b32 v81, a73
    v_accvgpr_read_b32 v82, a74
    v_accvgpr_read_b32 v83, a75
    v_accvgpr_read_b32 v84, a76
    v_accvgpr_read_b32 v85, a77
    v_accvgpr_read_b32 v86, a78
    v_accvgpr_read_b32 v87, a79
    v_mul_f32 v76, v76, v13
    v_mul_f32 v77, v77, v13
    v_mul_f32 v78, v78, v13
    v_mul_f32 v79, v79, v13
    v_mul_f32 v80, v80, v14
    v_mul_f32 v81, v81, v14
    v_mul_f32 v82, v82, v14
    v_mul_f32 v83, v83, v14
    v_mul_f32 v84, v84, v15
    v_mul_f32 v85, v85, v15
    v_mul_f32 v86, v86, v15
    v_mul_f32 v87, v87, v15
    v_accvgpr_write_b32 a68, v76
    v_accvgpr_write_b32 a69, v77
    v_accvgpr_write_b32 a70, v78
    v_accvgpr_write_b32 a71, v79
    v_accvgpr_write_b32 a72, v80
    v_accvgpr_write_b32 a73, v81
    v_accvgpr_write_b32 a74, v82
    v_accvgpr_write_b32 a75, v83
    v_accvgpr_write_b32 a76, v84
    v_accvgpr_write_b32 a77, v85
    v_accvgpr_write_b32 a78, v86
    v_accvgpr_write_b32 a79, v87
    v_accvgpr_read_b32 v76, a80
    v_accvgpr_read_b32 v77, a81
    v_accvgpr_read_b32 v78, a82
    v_accvgpr_read_b32 v79, a83
    v_accvgpr_read_b32 v80, a84
    v_accvgpr_read_b32 v81, a85
    v_accvgpr_read_b32 v82, a86
    v_accvgpr_read_b32 v83, a87
    v_accvgpr_read_b32 v84, a88
    v_accvgpr_read_b32 v85, a89
    v_accvgpr_read_b32 v86, a90
    v_accvgpr_read_b32 v87, a91
    v_mul_f32 v76, v76, v13
    v_mul_f32 v77, v77, v13
    v_mul_f32 v78, v78, v13
    v_mul_f32 v79, v79, v13
    v_mul_f32 v80, v80, v14
    v_mul_f32 v81, v81, v14
    v_mul_f32 v82, v82, v14
    v_mul_f32 v83, v83, v14
    v_mul_f32 v84, v84, v15
    v_mul_f32 v85, v85, v15
    v_mul_f32 v86, v86, v15
    v_mul_f32 v87, v87, v15
    v_accvgpr_write_b32 a80, v76
    v_accvgpr_write_b32 a81, v77
    v_accvgpr_write_b32 a82, v78
    v_accvgpr_write_b32 a83, v79
    v_accvgpr_write_b32 a84, v80
    v_accvgpr_write_b32 a85, v81
    v_accvgpr_write_b32 a86, v82
    v_accvgpr_write_b32 a87, v83
    v_accvgpr_write_b32 a88, v84
    v_accvgpr_write_b32 a89, v85
    v_accvgpr_write_b32 a90, v86
    v_accvgpr_write_b32 a91, v87
    v_accvgpr_read_b32 v76, a92
    v_accvgpr_read_b32 v77, a93
    v_accvgpr_read_b32 v78, a94
    v_accvgpr_read_b32 v79, a95
    v_accvgpr_read_b32 v80, a96
    v_accvgpr_read_b32 v81, a97
    v_accvgpr_read_b32 v82, a98
    v_accvgpr_read_b32 v83, a99
    v_accvgpr_read_b32 v84, a100
    v_accvgpr_read_b32 v85, a101
    v_accvgpr_read_b32 v86, a102
    v_accvgpr_read_b32 v87, a103
    v_mul_f32 v76, v76, v13
    v_mul_f32 v77, v77, v13
    v_mul_f32 v78, v78, v13
    v_mul_f32 v79, v79, v13
    v_mul_f32 v80, v80, v14
    v_mul_f32 v81, v81, v14
    v_mul_f32 v82, v82, v14
    v_mul_f32 v83, v83, v14
    v_mul_f32 v84, v84, v15
    v_mul_f32 v85, v85, v15
    v_mul_f32 v86, v86, v15
    v_mul_f32 v87, v87, v15
    v_accvgpr_write_b32 a92, v76
    v_accvgpr_write_b32 a93, v77
    v_accvgpr_write_b32 a94, v78
    v_accvgpr_write_b32 a95, v79
    v_accvgpr_write_b32 a96, v80
    v_accvgpr_write_b32 a97, v81
    v_accvgpr_write_b32 a98, v82
    v_accvgpr_write_b32 a99, v83
    v_accvgpr_write_b32 a100, v84
    v_accvgpr_write_b32 a101, v85
    v_accvgpr_write_b32 a102, v86
    v_accvgpr_write_b32 a103, v87
    v_accvgpr_read_b32 v76, a104
    v_accvgpr_read_b32 v77, a105
    v_accvgpr_read_b32 v78, a106
    v_accvgpr_read_b32 v79, a107
    v_accvgpr_read_b32 v80, a108
    v_accvgpr_read_b32 v81, a109
    v_accvgpr_read_b32 v82, a110
    v_accvgpr_read_b32 v83, a111
    v_accvgpr_read_b32 v84, a112
    v_accvgpr_read_b32 v85, a113
    v_accvgpr_read_b32 v86, a114
    v_accvgpr_read_b32 v87, a115
    v_mul_f32 v76, v76, v13
    v_mul_f32 v77, v77, v13
    v_mul_f32 v78, v78, v13
    v_mul_f32 v79, v79, v13
    v_mul_f32 v80, v80, v14
    v_mul_f32 v81, v81, v14
    v_mul_f32 v82, v82, v14
    v_mul_f32 v83, v83, v14
    v_mul_f32 v84, v84, v15
    v_mul_f32 v85, v85, v15
    v_mul_f32 v86, v86, v15
    v_mul_f32 v87, v87, v15
    v_accvgpr_write_b32 a104, v76
    v_accvgpr_write_b32 a105, v77
    v_accvgpr_write_b32 a106, v78
    v_accvgpr_write_b32 a107, v79
    v_accvgpr_write_b32 a108, v80
    v_accvgpr_write_b32 a109, v81
    v_accvgpr_write_b32 a110, v82
    v_accvgpr_write_b32 a111, v83
    v_accvgpr_write_b32 a112, v84
    v_accvgpr_write_b32 a113, v85
    v_accvgpr_write_b32 a114, v86
    v_accvgpr_write_b32 a115, v87
    v_accvgpr_read_b32 v76, a116
    v_accvgpr_read_b32 v77, a117
    v_accvgpr_read_b32 v78, a118
    v_accvgpr_read_b32 v79, a119
    v_accvgpr_read_b32 v80, a120
    v_accvgpr_read_b32 v81, a121
    v_accvgpr_read_b32 v82, a122
    v_accvgpr_read_b32 v83, a123
    v_accvgpr_read_b32 v84, a124
    v_accvgpr_read_b32 v85, a125
    v_accvgpr_read_b32 v86, a126
    v_accvgpr_read_b32 v87, a127
    v_mul_f32 v76, v76, v13
    v_mul_f32 v77, v77, v13
    v_mul_f32 v78, v78, v13
    v_mul_f32 v79, v79, v13
    v_mul_f32 v80, v80, v14
    v_mul_f32 v81, v81, v14
    v_mul_f32 v82, v82, v14
    v_mul_f32 v83, v83, v14
    v_mul_f32 v84, v84, v15
    v_mul_f32 v85, v85, v15
    v_mul_f32 v86, v86, v15
    v_mul_f32 v87, v87, v15
    v_accvgpr_write_b32 a116, v76
    v_accvgpr_write_b32 a117, v77
    v_accvgpr_write_b32 a118, v78
    v_accvgpr_write_b32 a119, v79
    v_accvgpr_write_b32 a120, v80
    v_accvgpr_write_b32 a121, v81
    v_accvgpr_write_b32 a122, v82
    v_accvgpr_write_b32 a123, v83
    v_accvgpr_write_b32 a124, v84
    v_accvgpr_write_b32 a125, v85
    v_accvgpr_write_b32 a126, v86
    v_accvgpr_write_b32 a127, v87
    v_accvgpr_read_b32 v76, a128
    v_accvgpr_read_b32 v77, a129
    v_accvgpr_read_b32 v78, a130
    v_accvgpr_read_b32 v79, a131
    v_accvgpr_read_b32 v80, a132
    v_accvgpr_read_b32 v81, a133
    v_accvgpr_read_b32 v82, a134
    v_accvgpr_read_b32 v83, a135
    v_accvgpr_read_b32 v84, a136
    v_accvgpr_read_b32 v85, a137
    v_accvgpr_read_b32 v86, a138
    v_accvgpr_read_b32 v87, a139
    v_mul_f32 v76, v76, v13
    v_mul_f32 v77, v77, v13
    v_mul_f32 v78, v78, v13
    v_mul_f32 v79, v79, v13
    v_mul_f32 v80, v80, v14
    v_mul_f32 v81, v81, v14
    v_mul_f32 v82, v82, v14
    v_mul_f32 v83, v83, v14
    v_mul_f32 v84, v84, v15
    v_mul_f32 v85, v85, v15
    v_mul_f32 v86, v86, v15
    v_mul_f32 v87, v87, v15
    v_accvgpr_write_b32 a128, v76
    v_accvgpr_write_b32 a129, v77
    v_accvgpr_write_b32 a130, v78
    v_accvgpr_write_b32 a131, v79
    v_accvgpr_write_b32 a132, v80
    v_accvgpr_write_b32 a133, v81
    v_accvgpr_write_b32 a134, v82
    v_accvgpr_write_b32 a135, v83
    v_accvgpr_write_b32 a136, v84
    v_accvgpr_write_b32 a137, v85
    v_accvgpr_write_b32 a138, v86
    v_accvgpr_write_b32 a139, v87
    v_accvgpr_read_b32 v76, a140
    v_accvgpr_read_b32 v77, a141
    v_accvgpr_read_b32 v78, a142
    v_accvgpr_read_b32 v79, a143
    v_accvgpr_read_b32 v80, a144
    v_accvgpr_read_b32 v81, a145
    v_accvgpr_read_b32 v82, a146
    v_accvgpr_read_b32 v83, a147
    v_accvgpr_read_b32 v84, a148
    v_accvgpr_read_b32 v85, a149
    v_accvgpr_read_b32 v86, a150
    v_accvgpr_read_b32 v87, a151
    v_mul_f32 v76, v76, v13
    v_mul_f32 v77, v77, v13
    v_mul_f32 v78, v78, v13
    v_mul_f32 v79, v79, v13
    v_mul_f32 v80, v80, v14
    v_mul_f32 v81, v81, v14
    v_mul_f32 v82, v82, v14
    v_mul_f32 v83, v83, v14
    v_mul_f32 v84, v84, v15
    v_mul_f32 v85, v85, v15
    v_mul_f32 v86, v86, v15
    v_mul_f32 v87, v87, v15
    v_accvgpr_write_b32 a140, v76
    v_accvgpr_write_b32 a141, v77
    v_accvgpr_write_b32 a142, v78
    v_accvgpr_write_b32 a143, v79
    v_accvgpr_write_b32 a144, v80
    v_accvgpr_write_b32 a145, v81
    v_accvgpr_write_b32 a146, v82
    v_accvgpr_write_b32 a147, v83
    v_accvgpr_write_b32 a148, v84
    v_accvgpr_write_b32 a149, v85
    v_accvgpr_write_b32 a150, v86
    v_accvgpr_write_b32 a151, v87
    v_accvgpr_read_b32 v76, a152
    v_accvgpr_read_b32 v77, a153
    v_accvgpr_read_b32 v78, a154
    v_accvgpr_read_b32 v79, a155
    v_accvgpr_read_b32 v80, a156
    v_accvgpr_read_b32 v81, a157
    v_accvgpr_read_b32 v82, a158
    v_accvgpr_read_b32 v83, a159
    v_accvgpr_read_b32 v84, a160
    v_accvgpr_read_b32 v85, a161
    v_accvgpr_read_b32 v86, a162
    v_accvgpr_read_b32 v87, a163
    v_mul_f32 v76, v76, v13
    v_mul_f32 v77, v77, v13
    v_mul_f32 v78, v78, v13
    v_mul_f32 v79, v79, v13
    v_mul_f32 v80, v80, v14
    v_mul_f32 v81, v81, v14
    v_mul_f32 v82, v82, v14
    v_mul_f32 v83, v83, v14
    v_mul_f32 v84, v84, v15
    v_mul_f32 v85, v85, v15
    v_mul_f32 v86, v86, v15
    v_mul_f32 v87, v87, v15
    v_accvgpr_write_b32 a152, v76
    v_accvgpr_write_b32 a153, v77
    v_accvgpr_write_b32 a154, v78
    v_accvgpr_write_b32 a155, v79
    v_accvgpr_write_b32 a156, v80
    v_accvgpr_write_b32 a157, v81
    v_accvgpr_write_b32 a158, v82
    v_accvgpr_write_b32 a159, v83
    v_accvgpr_write_b32 a160, v84
    v_accvgpr_write_b32 a161, v85
    v_accvgpr_write_b32 a162, v86
    v_accvgpr_write_b32 a163, v87
    v_accvgpr_read_b32 v76, a164
    v_accvgpr_read_b32 v77, a165
    v_accvgpr_read_b32 v78, a166
    v_accvgpr_read_b32 v79, a167
    v_accvgpr_read_b32 v80, a168
    v_accvgpr_read_b32 v81, a169
    v_accvgpr_read_b32 v82, a170
    v_accvgpr_read_b32 v83, a171
    v_accvgpr_read_b32 v84, a172
    v_accvgpr_read_b32 v85, a173
    v_accvgpr_read_b32 v86, a174
    v_accvgpr_read_b32 v87, a175
    v_mul_f32 v76, v76, v13
    v_mul_f32 v77, v77, v13
    v_mul_f32 v78, v78, v13
    v_mul_f32 v79, v79, v13
    v_mul_f32 v80, v80, v14
    v_mul_f32 v81, v81, v14
    v_mul_f32 v82, v82, v14
    v_mul_f32 v83, v83, v14
    v_mul_f32 v84, v84, v15
    v_mul_f32 v85, v85, v15
    v_mul_f32 v86, v86, v15
    v_mul_f32 v87, v87, v15
    v_accvgpr_write_b32 a164, v76
    v_accvgpr_write_b32 a165, v77
    v_accvgpr_write_b32 a166, v78
    v_accvgpr_write_b32 a167, v79
    v_accvgpr_write_b32 a168, v80
    v_accvgpr_write_b32 a169, v81
    v_accvgpr_write_b32 a170, v82
    v_accvgpr_write_b32 a171, v83
    v_accvgpr_write_b32 a172, v84
    v_accvgpr_write_b32 a173, v85
    v_accvgpr_write_b32 a174, v86
    v_accvgpr_write_b32 a175, v87
L_safe_skip_e:
    s_nop 1
    v_exp_f32 v184, v184
    v_exp_f32 v185, v185
    v_exp_f32 v186, v186
    v_exp_f32 v187, v187
    v_exp_f32 v188, v188
    v_exp_f32 v189, v189
    v_exp_f32 v190, v190
    v_exp_f32 v191, v191
    v_exp_f32 v192, v192
    v_exp_f32 v193, v193
    v_exp_f32 v194, v194
    v_exp_f32 v195, v195
    v_exp_f32 v196, v196
    v_exp_f32 v197, v197
    v_exp_f32 v198, v198
    v_exp_f32 v199, v199
    v_exp_f32 v200, v200
    v_exp_f32 v201, v201
    v_exp_f32 v202, v202
    v_exp_f32 v203, v203
    v_exp_f32 v204, v204
    v_exp_f32 v205, v205
    v_exp_f32 v206, v206
    v_exp_f32 v207, v207
    v_cvt_pk_bf16_f32 v52, v184, v185
    v_cvt_pk_bf16_f32 v53, v186, v187
    v_cvt_pk_bf16_f32 v54, v188, v189
    v_cvt_pk_bf16_f32 v55, v190, v191
    v_cvt_pk_bf16_f32 v56, v192, v193
    v_cvt_pk_bf16_f32 v57, v194, v195
    v_cvt_pk_bf16_f32 v58, v196, v197
    v_cvt_pk_bf16_f32 v59, v198, v199
    v_cvt_pk_bf16_f32 v60, v200, v201
    v_cvt_pk_bf16_f32 v61, v202, v203
    v_cvt_pk_bf16_f32 v62, v204, v205
    v_cvt_pk_bf16_f32 v63, v206, v207
    s_waitcnt lgkmcnt(8)
    v_mfma_f32_16x16x32_bf16 a[32:35], a[0:3], v[52:55], a[32:35]
    ds_read_b64_tr_b16 a[24:25], v5 offset:24704
    v_mfma_f32_16x16x32_bf16 a[44:47], a[4:7], v[52:55], a[44:47]
    v_add_f32 v7, v7, v184
    v_mfma_f32_16x16x32_bf16 a[48:51], a[4:7], v[56:59], a[48:51]
    ds_read_b64_tr_b16 a[26:27], v5 offset:30848
    v_add_f32 v7, v7, v185
    v_mfma_f32_16x16x32_bf16 a[36:39], a[0:3], v[56:59], a[36:39]
    ds_read_b64_tr_b16 a[28:29], v6 offset:24704
    v_mfma_f32_16x16x32_bf16 a[40:43], a[0:3], v[60:63], a[40:43]
    v_add_f32 v7, v7, v186
    v_mfma_f32_16x16x32_bf16 a[52:55], a[4:7], v[60:63], a[52:55]
    ds_read_b64_tr_b16 a[30:31], v6 offset:30848
    s_waitcnt lgkmcnt(8)
    v_mfma_f32_16x16x32_bf16 a[64:67], a[8:11], v[60:63], a[64:67]
    ds_read_b64_tr_b16 a[0:1], v3 offset:24832
    v_add_f32 v7, v7, v187
    v_mfma_f32_16x16x32_bf16 a[76:79], a[12:15], v[60:63], a[76:79]
    v_mfma_f32_16x16x32_bf16 a[72:75], a[12:15], v[56:59], a[72:75]
    ds_read_b64_tr_b16 a[2:3], v3 offset:30976
    v_add_f32 v7, v7, v188
    v_mfma_f32_16x16x32_bf16 a[60:63], a[8:11], v[56:59], a[60:63]
    ds_read_b64_tr_b16 a[4:5], v4 offset:24832
    v_mfma_f32_16x16x32_bf16 a[56:59], a[8:11], v[52:55], a[56:59]
    v_add_f32 v7, v7, v189
    v_mfma_f32_16x16x32_bf16 a[68:71], a[12:15], v[52:55], a[68:71]
    ds_read_b64_tr_b16 a[6:7], v4 offset:30976
    s_waitcnt lgkmcnt(8)
    v_mfma_f32_16x16x32_bf16 a[80:83], a[16:19], v[52:55], a[80:83]
    ds_read_b64_tr_b16 a[8:9], v5 offset:24832
    v_add_f32 v7, v7, v190
    v_mfma_f32_16x16x32_bf16 a[92:95], a[20:23], v[52:55], a[92:95]
    v_add_f32 v7, v7, v191
    v_mfma_f32_16x16x32_bf16 a[96:99], a[20:23], v[56:59], a[96:99]
    ds_read_b64_tr_b16 a[10:11], v5 offset:30976
    v_mfma_f32_16x16x32_bf16 a[84:87], a[16:19], v[56:59], a[84:87]
    ds_read_b64_tr_b16 a[12:13], v6 offset:24832
    v_mfma_f32_16x16x32_bf16 a[88:91], a[16:19], v[60:63], a[88:91]
    v_add_f32 v8, v8, v192
    v_mfma_f32_16x16x32_bf16 a[100:103], a[20:23], v[60:63], a[100:103]
    ds_read_b64_tr_b16 a[14:15], v6 offset:30976
    s_waitcnt lgkmcnt(8)
    v_mfma_f32_16x16x32_bf16 a[112:115], a[24:27], v[60:63], a[112:115]
    v_add_f32 v8, v8, v193
    v_mfma_f32_16x16x32_bf16 a[124:127], a[28:31], v[60:63], a[124:127]
    v_add_f32 v8, v8, v194
    v_mfma_f32_16x16x32_bf16 a[120:123], a[28:31], v[56:59], a[120:123]
    v_add_f32 v8, v8, v195
    v_mfma_f32_16x16x32_bf16 a[108:111], a[24:27], v[56:59], a[108:111]
    v_add_f32 v8, v8, v196
    v_mfma_f32_16x16x32_bf16 a[104:107], a[24:27], v[52:55], a[104:107]
    v_add_f32 v8, v8, v197
    v_mfma_f32_16x16x32_bf16 a[116:119], a[28:31], v[52:55], a[116:119]
    s_waitcnt lgkmcnt(4)
    v_mfma_f32_16x16x32_bf16 a[128:131], a[0:3], v[52:55], a[128:131]
    v_add_f32 v8, v8, v198
    v_mfma_f32_16x16x32_bf16 a[140:143], a[4:7], v[52:55], a[140:143]
    v_add_f32 v8, v8, v199
    v_mfma_f32_16x16x32_bf16 a[144:147], a[4:7], v[56:59], a[144:147]
    v_add_f32 v9, v9, v200
    v_mfma_f32_16x16x32_bf16 a[132:135], a[0:3], v[56:59], a[132:135]
    v_add_f32 v9, v9, v201
    v_mfma_f32_16x16x32_bf16 a[136:139], a[0:3], v[60:63], a[136:139]
    v_add_f32 v9, v9, v202
    v_mfma_f32_16x16x32_bf16 a[148:151], a[4:7], v[60:63], a[148:151]
    s_waitcnt lgkmcnt(0)
    v_mfma_f32_16x16x32_bf16 a[160:163], a[8:11], v[60:63], a[160:163]
    v_add_f32 v9, v9, v203
    v_mfma_f32_16x16x32_bf16 a[172:175], a[12:15], v[60:63], a[172:175]
    v_add_f32 v9, v9, v204
    v_mfma_f32_16x16x32_bf16 a[168:171], a[12:15], v[56:59], a[168:171]
    v_add_f32 v9, v9, v205
    v_mfma_f32_16x16x32_bf16 a[156:159], a[8:11], v[56:59], a[156:159]
    v_add_f32 v9, v9, v206
    v_mfma_f32_16x16x32_bf16 a[152:155], a[8:11], v[52:55], a[152:155]
    v_add_f32 v9, v9, v207
    v_mfma_f32_16x16x32_bf16 a[164:167], a[12:15], v[52:55], a[164:167]
    s_nop 7
    v_mov_b32 v10, v7
    v_mov_b32 v11, v8
    v_mov_b32 v12, v9
    v_permlane32_swap_b32 v7, v10
    v_permlane32_swap_b32 v8, v11
    v_permlane32_swap_b32 v9, v12
    v_add_f32 v7, v7, v10
    v_add_f32 v8, v8, v11
    v_add_f32 v9, v9, v12
    v_mov_b32 v10, v7
    v_mov_b32 v11, v8
    v_mov_b32 v12, v9
    v_permlane16_swap_b32 v7, v10
    v_permlane16_swap_b32 v8, v11
    v_permlane16_swap_b32 v9, v12
    v_add_f32 v7, v7, v10
    v_add_f32 v8, v8, v11
    v_add_f32 v9, v9, v12
    s_mov_b32 s43, 0x53800000
    v_cmp_ngt_f32 vcc, s43, v7
    v_cmp_ngt_f32 s[72:73], s43, v8
    v_cmp_ngt_f32 s[74:75], s43, v9
    v_rcp_f32 v10, v7
    v_rcp_f32 v12, v8
    v_rcp_f32 v14, v9
    s_or_b64 s[72:73], s[72:73], vcc
    s_or_b64 s[72:73], s[72:73], s[74:75]
    s_cbranch_scc0 L_vote_oks
    v_mov_b32 v7, 98304
    v_mov_b32 v8, 1
    ds_write_b32 v7, v8
    s_waitcnt lgkmcnt(0)
L_vote_oks:
    v_mov_b32 v11, v10
    v_mov_b32 v13, v12
    v_mov_b32 v15, v14
    v_and_b32 v7, 63, v0
    v_lshlrev_b32 v7, 4, v7
    v_add_u32 v8, 6144, v7
    v_add_u32 v9, 12288, v7
    s_mul_i32 s39, s81, 73728
    s_add_u32 s39, s39, s83
    s_add_u32 s40, s39, 3072
    s_lshl_b32 s54, s81, 7
    s_add_u32 s54, s54, s100
    v_accvgpr_read_b32 v76, a32
    v_accvgpr_read_b32 v77, a33
    v_accvgpr_read_b32 v78, a34
    v_accvgpr_read_b32 v79, a35
    v_accvgpr_read_b32 v80, a44
    v_accvgpr_read_b32 v81, a45
    v_accvgpr_read_b32 v82, a46
    v_accvgpr_read_b32 v83, a47
    v_pk_mul_f32 v[76:77], v[76:77], v[10:11]
    v_pk_mul_f32 v[78:79], v[78:79], v[10:11]
    v_pk_mul_f32 v[80:81], v[80:81], v[10:11]
    v_pk_mul_f32 v[82:83], v[82:83], v[10:11]
    v_cvt_pk_bf16_f32 v160, v76, v77
    v_cvt_pk_bf16_f32 v161, v78, v79
    v_cvt_pk_bf16_f32 v162, v80, v81
    v_cvt_pk_bf16_f32 v163, v82, v83
    buffer_store_dwordx4 v[160:163], v7, s[24:27], s39 offen offset:0 sc1
    v_accvgpr_read_b32 v100, a36
    v_accvgpr_read_b32 v101, a37
    v_accvgpr_read_b32 v102, a38
    v_accvgpr_read_b32 v103, a39
    v_accvgpr_read_b32 v104, a48
    v_accvgpr_read_b32 v105, a49
    v_accvgpr_read_b32 v106, a50
    v_accvgpr_read_b32 v107, a51
    v_pk_mul_f32 v[100:101], v[100:101], v[12:13]
    v_pk_mul_f32 v[102:103], v[102:103], v[12:13]
    v_pk_mul_f32 v[104:105], v[104:105], v[12:13]
    v_pk_mul_f32 v[106:107], v[106:107], v[12:13]
    v_cvt_pk_bf16_f32 v164, v100, v101
    v_cvt_pk_bf16_f32 v165, v102, v103
    v_cvt_pk_bf16_f32 v166, v104, v105
    v_cvt_pk_bf16_f32 v167, v106, v107
    buffer_store_dwordx4 v[164:167], v7, s[24:27], s39 offen offset:1024 sc1
    v_accvgpr_read_b32 v76, a40
    v_accvgpr_read_b32 v77, a41
    v_accvgpr_read_b32 v78, a42
    v_accvgpr_read_b32 v79, a43
    v_accvgpr_read_b32 v80, a52
    v_accvgpr_read_b32 v81, a53
    v_accvgpr_read_b32 v82, a54
    v_accvgpr_read_b32 v83, a55
    v_pk_mul_f32 v[76:77], v[76:77], v[14:15]
    v_pk_mul_f32 v[78:79], v[78:79], v[14:15]
    v_pk_mul_f32 v[80:81], v[80:81], v[14:15]
    v_pk_mul_f32 v[82:83], v[82:83], v[14:15]
    v_cvt_pk_bf16_f32 v168, v76, v77
    v_cvt_pk_bf16_f32 v169, v78, v79
    v_cvt_pk_bf16_f32 v170, v80, v81
    v_cvt_pk_bf16_f32 v171, v82, v83
    buffer_store_dwordx4 v[168:171], v7, s[24:27], s39 offen offset:2048 sc1
    v_accvgpr_read_b32 v76, a56
    v_accvgpr_read_b32 v77, a57
    v_accvgpr_read_b32 v78, a58
    v_accvgpr_read_b32 v79, a59
    v_accvgpr_read_b32 v80, a68
    v_accvgpr_read_b32 v81, a69
    v_accvgpr_read_b32 v82, a70
    v_accvgpr_read_b32 v83, a71
    v_pk_mul_f32 v[76:77], v[76:77], v[10:11]
    v_pk_mul_f32 v[78:79], v[78:79], v[10:11]
    v_pk_mul_f32 v[80:81], v[80:81], v[10:11]
    v_pk_mul_f32 v[82:83], v[82:83], v[10:11]
    v_cvt_pk_bf16_f32 v172, v76, v77
    v_cvt_pk_bf16_f32 v173, v78, v79
    v_cvt_pk_bf16_f32 v174, v80, v81
    v_cvt_pk_bf16_f32 v175, v82, v83
    buffer_store_dwordx4 v[172:175], v7, s[24:27], s40 offen offset:0 sc1
    v_accvgpr_read_b32 v100, a60
    v_accvgpr_read_b32 v101, a61
    v_accvgpr_read_b32 v102, a62
    v_accvgpr_read_b32 v103, a63
    v_accvgpr_read_b32 v104, a72
    v_accvgpr_read_b32 v105, a73
    v_accvgpr_read_b32 v106, a74
    v_accvgpr_read_b32 v107, a75
    v_pk_mul_f32 v[100:101], v[100:101], v[12:13]
    v_pk_mul_f32 v[102:103], v[102:103], v[12:13]
    v_pk_mul_f32 v[104:105], v[104:105], v[12:13]
    v_pk_mul_f32 v[106:107], v[106:107], v[12:13]
    v_cvt_pk_bf16_f32 v176, v100, v101
    v_cvt_pk_bf16_f32 v177, v102, v103
    v_cvt_pk_bf16_f32 v178, v104, v105
    v_cvt_pk_bf16_f32 v179, v106, v107
    buffer_store_dwordx4 v[176:179], v7, s[24:27], s40 offen offset:1024 sc1
    v_accvgpr_read_b32 v76, a64
    v_accvgpr_read_b32 v77, a65
    v_accvgpr_read_b32 v78, a66
    v_accvgpr_read_b32 v79, a67
    v_accvgpr_read_b32 v80, a76
    v_accvgpr_read_b32 v81, a77
    v_accvgpr_read_b32 v82, a78
    v_accvgpr_read_b32 v83, a79
    v_pk_mul_f32 v[76:77], v[76:77], v[14:15]
    v_pk_mul_f32 v[78:79], v[78:79], v[14:15]
    v_pk_mul_f32 v[80:81], v[80:81], v[14:15]
    v_pk_mul_f32 v[82:83], v[82:83], v[14:15]
    v_cvt_pk_bf16_f32 v180, v76, v77
    v_cvt_pk_bf16_f32 v181, v78, v79
    v_cvt_pk_bf16_f32 v182, v80, v81
    v_cvt_pk_bf16_f32 v183, v82, v83
    buffer_store_dwordx4 v[180:183], v7, s[24:27], s40 offen offset:2048 sc1
    s_waitcnt vmcnt(0)
    s_branch L_join
L_end:
    s_endpgm
.section .rodata,"a"
.p2align 6
.amdhsa_kernel standalone__gqa_block_cached__near_ridge_kernel
  .amdhsa_next_free_vgpr 512
  .amdhsa_next_free_sgpr 102
  .amdhsa_accum_offset 256
  .amdhsa_group_segment_fixed_size 0
  .amdhsa_kernarg_size 64
  .amdhsa_user_sgpr_count 2
  .amdhsa_user_sgpr_kernarg_segment_ptr 1
  .amdhsa_system_sgpr_workgroup_id_x 1
.end_amdhsa_kernel
```
